```python
import torch

def _softmax(x, axis=-1):
    return torch.softmax(x, dim=axis)
def _gelu(x):
    return torch.nn.functional.gelu(x, approximate="tanh")
def _silu(x):
    return torch.nn.functional.silu(x)
def _sigmoid(x):
    return torch.sigmoid(x)
def _layernorm(x, axis=-1, eps=1e-5):
    m = x.mean(dim=axis, keepdim=True)
    v = x.var(dim=axis, keepdim=True, unbiased=False)
    return (x - m) / torch.sqrt(v + eps)
def _scatter_add(tgt, idx, src, axis=0):
    return tgt.clone().index_add_(axis, idx, src)
def _segment_sum(src, seg, n):
    out = torch.zeros((n,) + src.shape[1:], dtype=src.dtype)
    return out.index_add_(0, seg, src)
def _pad(x, pw):
    flat = tuple(v for pair in reversed(pw) for v in pair)
    return torch.nn.functional.pad(x, flat)

kernel_name = 'parallel_sum__softmax_full_mha__glu_gated_glu__prompt'

def setup_inputs():

    _w = (lambda a: (lambda t: t.to(torch.bfloat16) if t.is_floating_point() else t)(torch.as_tensor(a)))
    def _A_setup():
        B, S, D = 1, 2048, 1024
        return {
            "x": _w((lambda *s: torch.randn(*s, dtype=torch.bfloat16) * 0.05)(B, S, D)),
            "wqkv": _w((lambda *s: torch.randn(*s, dtype=torch.bfloat16) * 0.05)(D, 3 * D)),
            "wo": _w((lambda *s: torch.randn(*s, dtype=torch.bfloat16) * 0.05)(D, D)),
        }
    _A_in = _A_setup()

    def _B_setup():
        B, S, D, F = 1, 2048, 1024, 3584
        return {
            "x": _w((lambda *s: torch.randn(*s, dtype=torch.bfloat16) * 0.05)(B, S, D)),
            "w_gate": _w((lambda *s: torch.randn(*s, dtype=torch.bfloat16) * 0.05)(D, F)),
            "w_up": _w((lambda *s: torch.randn(*s, dtype=torch.bfloat16) * 0.05)(D, F)),
            "w_down": _w((lambda *s: torch.randn(*s, dtype=torch.bfloat16) * 0.05)(F, D)),
        }
    _B_in = _B_setup()

    return {
        "A_x": _A_in["x"],
        "A_wqkv": _A_in["wqkv"],
        "A_wo": _A_in["wo"],
        "B_x": _B_in["x"],
        "B_w_gate": _B_in["w_gate"],
        "B_w_up": _B_in["w_up"],
        "B_w_down": _B_in["w_down"],
    }

def reference(A_x, A_wqkv, A_wo, B_x, B_w_gate, B_w_up, B_w_down):
    def _A_ref(x, wqkv, wo):
        B, S, D = x.shape
        H = 32; Dh = D // H
        qkv = (lambda x, *d: x.permute(*d))((x @ wqkv).reshape(B, S, 3, H, Dh), 2, 0, 3, 1, 4)
        q, k, v = qkv[0], qkv[1], qkv[2]
        scale = Dh ** -0.5
        scores = torch.einsum("bhqd,bhkd->bhqk", q, k) * scale
        p = _softmax(scores, axis=-1)
        o = torch.einsum("bhqk,bhkd->bhqd", p, v)
        return (lambda x, *d: x.permute(*d))(o, 0, 2, 1, 3).reshape(B, S, D) @ wo

    def _B_ref(x, w_gate, w_up, w_down):
        g = torch.einsum("bsd,df->bsf", x, w_gate)
        u = torch.einsum("bsd,df->bsf", x, w_up)
        h = _sigmoid(g) * u
        return torch.einsum("bsf,fd->bsd", h, w_down)

    x = A_x
    xn = _layernorm(x, axis=-1)
    return x + _A_ref(xn, A_wqkv, A_wo) + _B_ref(xn, B_w_gate, B_w_up, B_w_down)
```

```asm
; @launch kernel=g1_kernel grid=(256,1,1) block=(256,1,1) lds=150784
; @launch kernel=s3_kernel grid=(256,1,1) block=(512,1,1) lds=155712
.amdgcn_target "amdgcn-amd-amdhsa--gfx950"
.text
.globl g1_kernel
.p2align 8
.type g1_kernel,@function
g1_kernel:
    s_cmp_ge_u32 s2, 256
    s_cbranch_scc1 L_g1_end
    s_load_dwordx2 s[20:21], s[0:1], 0
    s_load_dwordx2 s[8:9], s[0:1], 8
    s_load_dwordx2 s[12:13], s[0:1], 32
    s_load_dwordx2 s[16:17], s[0:1], 40
    s_load_dwordx2 s[4:5], s[0:1], 72
    s_load_dwordx2 s[24:25], s[0:1], 64
    s_getpc_b64 s[36:37]
L_g1_pc:
    s_and_b32 s56, s2, 31
    s_cmp_ge_u32 s56, 28
    s_cselect_b32 s38, L_g1_T2-L_g1_pc, 0
    s_add_u32 s36, s36, s38
    s_addc_u32 s37, s37, 0
    v_lshlrev_b32 v76, 7, v0
    v_mov_b32 v77, s37
    v_add_co_u32 v76, vcc, s36, v76
    v_addc_co_u32 v77, vcc, 0, v77, vcc
    global_load_dword v78, v[76:77], off
    v_mov_b64 v[72:73], 0
    v_mov_b64 v[74:75], 0
    v_lshrrev_b32 v15, 6, v0
    v_and_b32 v1, 63, v0
    v_readfirstlane_b32 s28, v15
    s_and_b32 s56, s2, 31
    s_lshr_b32 s57, s2, 5
    v_lshrrev_b32 v15, 3, v1
    v_and_b32 v16, 7, v1
    v_lshrrev_b32 v17, 1, v15
    v_xor_b32 v18, v16, v17
    v_lshlrev_b32 v18, 4, v18
    v_lshl_add_u32 v2, v15, 11, v18
    v_xor_b32 v3, 64, v2
    s_lshl_b32 s42, s28, 14
    s_add_u32 s42, s42, 81920
    s_cmp_ge_u32 s57, 5
    s_cselect_b32 s75, s57, 0
    s_lshl_b32 s34, s57, 19
    s_lshl_b32 s58, s28, 17
    s_add_u32 s34, s34, s58
    s_lshl_b32 s58, s75, 8
    s_add_u32 s34, s34, s58
    s_mov_b32 s22, 0x400000
    s_mov_b32 s23, 0x00020000
    s_waitcnt lgkmcnt(0)
    s_mov_b32 m0, s42
    s_nop 0
    buffer_load_dwordx4 v2, s[20:23], s34 offen offset:0 lds
    s_add_u32 s35, s34, 15360
    buffer_load_dwordx4 v3, s[20:23], s35 offen offset:1024 lds
    s_add_u32 s35, s34, 30720
    buffer_load_dwordx4 v2, s[20:23], s35 offen offset:2048 lds
    s_add_u32 s35, s34, 46080
    buffer_load_dwordx4 v3, s[20:23], s35 offen offset:3072 lds
    s_add_u32 m0, s42, 4096
    s_add_u32 s35, s34, 65536
    buffer_load_dwordx4 v2, s[20:23], s35 offen offset:0 lds
    s_add_u32 s35, s34, 80896
    buffer_load_dwordx4 v3, s[20:23], s35 offen offset:1024 lds
    s_add_u32 s35, s34, 96256
    buffer_load_dwordx4 v2, s[20:23], s35 offen offset:2048 lds
    s_add_u32 s35, s34, 111616
    buffer_load_dwordx4 v3, s[20:23], s35 offen offset:3072 lds
    v_lshlrev_b32 v17, 1, v17
    v_xor_b32 v18, v16, v17
    v_lshlrev_b32 v18, 4, v18
    v_lshrrev_b32 v19, 2, v15
    v_and_b32 v20, 3, v15
    v_lshl_add_u32 v19, v19, 3, v20
    s_lshr_b32 s58, s28, 1
    s_lshl_b32 s58, s58, 4
    s_and_b32 s59, s28, 1
    s_lshl_b32 s59, s59, 2
    s_add_u32 s58, s58, s59
    v_add_u32 v19, s58, v19
    v_mul_u32_u24 v20, 6144, v19
    v_add_u32 v20, v20, v18
    s_lshl_b32 s58, s56, 7
    v_add_u32 v4, s58, v20
    v_mul_u32_u24 v21, 7168, v19
    v_add_u32 v21, v21, v18
    s_lshl_b32 s58, s56, 8
    v_add_u32 v5, s58, v21
    s_lshl_b32 s58, s56, 9
    s_sub_u32 s58, s58, 10240
    v_add_u32 v6, s58, v20
    s_mul_i32 s30, s75, 917504
    s_mul_i32 s33, s75, 786432
    s_lshl_b32 s41, s28, 10
    s_mov_b32 s10, 0x600000
    s_mov_b32 s11, s23
    s_mov_b32 s14, 0x700000
    s_mov_b32 s15, s23
    s_mov_b32 s18, 0x700000
    s_mov_b32 s19, s23
    s_add_u32 s34, s34, 128
    s_cmp_ge_u32 s56, 28
    s_cbranch_scc1 L_g1_T2
    s_add_u32 m0, s41, 0
    s_nop 0
    buffer_load_dwordx4 v4, s[8:11], s33 offen lds
    s_add_u32 m0, s41, 4096
    s_nop 0
    buffer_load_dwordx4 v5, s[12:15], s30 offen lds
    s_add_u32 m0, s41, 8064
    s_nop 0
    buffer_load_dwordx4 v5, s[12:15], s30 offen offset:128 lds
    s_add_u32 m0, s41, 12288
    s_nop 0
    buffer_load_dwordx4 v5, s[16:19], s30 offen lds
    s_add_u32 m0, s41, 16256
    s_nop 0
    buffer_load_dwordx4 v5, s[16:19], s30 offen offset:128 lds
    s_add_u32 s33, s33, 196608
    s_add_u32 s30, s30, 229376
    s_mov_b32 s6, 0x3700000
    s_mov_b32 s7, s23
    s_mov_b32 s26, 0x100
    s_mov_b32 s27, s23
    s_lshl_b32 s58, s2, 3
    s_lshl_b32 s59, s28, 1
    s_add_u32 s58, s58, s59
    s_lshr_b32 s79, s58, 6
    s_lshl_b32 s79, s79, 8
    s_lshl_b32 s59, s58, 2
    s_add_u32 s79, s79, s59
    s_lshl_b32 s58, s58, 11
    v_and_b32 v20, 31, v1
    v_lshrrev_b32 v21, 5, v1
    v_lshlrev_b32 v20, 4, v20
    v_lshl_add_u32 v20, v21, 11, v20
    s_lshl_b32 s59, s2, 9
    s_add_u32 s59, s59, 0x3500000
    v_lshlrev_b32 v21, 3, v1
    buffer_load_dwordx4 v[32:35], v20, s[20:23], s58 offen offset:0
    buffer_load_dwordx4 v[36:39], v20, s[20:23], s58 offen offset:512
    buffer_load_dwordx4 v[40:43], v20, s[20:23], s58 offen offset:1024
    buffer_load_dwordx4 v[44:47], v20, s[20:23], s58 offen offset:1536
    buffer_store_dword v72, v21, s[4:7], s59 offen
    s_add_u32 m0, s41, 20480
    s_nop 0
    buffer_load_dwordx4 v4, s[8:11], s33 offen lds
    v_lshrrev_b32 v18, 5, v1
    v_bfe_u32 v19, v1, 2, 3
    v_and_b32 v20, 3, v1
    v_mfma_f32_32x32x16_bf16 v[80:95], v[72:75], v[72:75], 0
    v_lshlrev_b32 v21, 11, v18
    v_lshl_add_u32 v21, v19, 7, v21
    v_lshl_add_u32 v21, v20, 3, v21
    v_mfma_f32_32x32x16_bf16 v[96:111], v[72:75], v[72:75], 0
    v_lshrrev_b32 v19, 1, v19
    v_xor_b32 v20, 0, v19
    v_lshl_add_u32 v8, v20, 5, v21
    v_mfma_f32_32x32x16_bf16 v[112:127], v[72:75], v[72:75], 0
    s_add_u32 m0, s41, 24576
    s_nop 0
    buffer_load_dwordx4 v5, s[12:15], s30 offen lds
    v_add_u32 v12, 40960, v8
    v_xor_b32 v20, 1, v19
    v_lshl_add_u32 v9, v20, 5, v21
    v_mfma_f32_32x32x16_bf16 v[128:143], v[72:75], v[72:75], 0
    v_add_u32 v13, 40960, v9
    v_xor_b32 v20, 2, v19
    v_lshl_add_u32 v10, v20, 5, v21
    v_mfma_f32_32x32x16_bf16 v[144:159], v[72:75], v[72:75], 0
    v_add_u32 v14, 40960, v10
    v_xor_b32 v20, 3, v19
    v_lshl_add_u32 v11, v20, 5, v21
    v_mfma_f32_32x32x16_bf16 v[160:175], v[72:75], v[72:75], 0
    s_add_u32 m0, s41, 28544
    s_nop 0
    buffer_load_dwordx4 v5, s[12:15], s30 offen offset:128 lds
    v_add_u32 v15, 40960, v11
    v_and_b32 v20, 15, v1
    v_lshrrev_b32 v21, 1, v20
    v_mfma_f32_32x32x16_bf16 v[176:191], v[72:75], v[72:75], 0
    v_lshrrev_b32 v18, 4, v1
    v_xor_b32 v21, v21, v18
    v_lshlrev_b32 v20, 7, v20
    v_mfma_f32_32x32x16_bf16 v[192:207], v[72:75], v[72:75], 0
    v_add_u32 v20, s42, v20
    v_lshl_add_u32 v16, v21, 4, v20
    v_xor_b32 v17, 64, v16
    s_add_u32 m0, s41, 32768
    s_nop 0
    buffer_load_dwordx4 v5, s[16:19], s30 offen lds
    v_mfma_f32_32x32x16_bf16 v[208:223], v[72:75], v[72:75], 0
    v_mov_b32 v28, 0x3f803f80
    v_mov_b32 v29, 0x3f803f80
    v_mov_b32 v30, 0x3f803f80
    v_mfma_f32_32x32x16_bf16 v[224:239], v[72:75], v[72:75], 0
    v_mov_b32 v31, 0x3f803f80
    v_mov_b32 v7, 1
    v_mov_b32 v19, 1.0
    v_mfma_f32_32x32x16_bf16 v[240:255], v[72:75], v[72:75], 0
    s_sub_u32 s75, s57, s75
    s_sub_u32 s76, 6, s75
    s_sub_u32 s75, 7, s75
    s_add_u32 m0, s41, 36736
    s_nop 0
    buffer_load_dwordx4 v5, s[16:19], s30 offen offset:128 lds
    s_add_u32 s33, s33, 196608
    s_add_u32 s30, s30, 229376
    v_mfma_f32_32x32x16_bf16 a[0:15], v[72:75], v[72:75], 0
    s_cmp_ge_u32 s57, 8
    s_cselect_b32 s75, -1, s75
    s_cselect_b32 s76, 7, s76
    v_mfma_f32_32x32x16_bf16 a[16:31], v[72:75], v[72:75], 0
    s_cmp_lg_u32 s28, 0
    s_cselect_b32 s76, -1, s76
    s_cmp_eq_u32 s75, 7
    v_mfma_f32_32x32x16_bf16 a[32:47], v[72:75], v[72:75], 0
    s_cselect_b32 s74, 1, 0
    s_lshl_b32 s78, s56, 3
    s_add_u32 s78, s78, s57
    s_add_u32 m0, s42, 8192
    s_add_u32 s35, s34, 0
    buffer_load_dwordx4 v2, s[20:23], s35 offen lds
    v_mfma_f32_32x32x16_bf16 a[48:63], v[72:75], v[72:75], 0
    s_mul_i32 s78, s78, 1280
    s_mul_i32 s77, s28, 320
    s_add_u32 s78, s78, s77
    v_mfma_f32_32x32x16_bf16 a[64:79], v[72:75], v[72:75], 0
    s_add_u32 s78, s78, 0x10000
    s_mov_b32 s77, 0xffff0000
    s_mov_b32 s29, 7
    v_mfma_f32_32x32x16_bf16 a[80:95], v[72:75], v[72:75], 0
    v_mfma_f32_32x32x16_bf16 a[208:223], v[72:75], v[72:75], 0
    v_mfma_f32_16x16x32_bf16 a[224:227], v[72:75], v[72:75], 0
    s_add_u32 m0, s42, 9216
    s_add_u32 s35, s34, 16384
    buffer_load_dwordx4 v3, s[20:23], s35 offen lds
    s_add_u32 m0, s42, 10240
    s_add_u32 s35, s34, 32768
    buffer_load_dwordx4 v2, s[20:23], s35 offen lds
    s_add_u32 m0, s42, 11264
    s_add_u32 s35, s34, 49152
    buffer_load_dwordx4 v3, s[20:23], s35 offen lds
    s_waitcnt vmcnt(10)
    s_add_u32 m0, s42, 12288
    s_add_u32 s35, s34, 65536
    buffer_load_dwordx4 v2, s[20:23], s35 offen lds
    v_lshlrev_b32 v48, 16, v32
    v_and_b32 v49, s77, v32
    v_lshlrev_b32 v50, 16, v33
    v_and_b32 v51, s77, v33
    v_lshlrev_b32 v52, 16, v34
    v_and_b32 v53, s77, v34
    v_lshlrev_b32 v54, 16, v35
    v_and_b32 v55, s77, v35
    v_lshlrev_b32 v56, 16, v36
    v_and_b32 v57, s77, v36
    v_lshlrev_b32 v58, 16, v37
    v_and_b32 v59, s77, v37
    v_lshlrev_b32 v60, 16, v38
    v_and_b32 v61, s77, v38
    v_lshlrev_b32 v62, 16, v39
    v_and_b32 v63, s77, v39
    v_lshlrev_b32 v64, 16, v40
    v_and_b32 v65, s77, v40
    v_lshlrev_b32 v66, 16, v41
    s_add_u32 m0, s41, 40960
    s_nop 0
    buffer_load_dwordx4 v4, s[8:11], s33 offen lds
    v_and_b32 v67, s77, v41
    v_lshlrev_b32 v68, 16, v42
    v_and_b32 v69, s77, v42
    v_lshlrev_b32 v70, 16, v43
    v_and_b32 v71, s77, v43
    v_lshlrev_b32 v72, 16, v44
    v_and_b32 v73, s77, v44
    v_lshlrev_b32 v74, 16, v45
    v_and_b32 v75, s77, v45
    v_lshlrev_b32 v76, 16, v46
    v_and_b32 v77, s77, v46
    v_lshlrev_b32 v78, 16, v47
    v_and_b32 v79, s77, v47
    v_pk_add_f32 v[32:33], v[48:49], v[50:51]
    v_pk_add_f32 v[34:35], v[52:53], v[54:55]
    v_pk_add_f32 v[32:33], v[32:33], v[56:57]
    v_pk_add_f32 v[34:35], v[34:35], v[58:59]
    v_pk_add_f32 v[32:33], v[32:33], v[60:61]
    v_pk_add_f32 v[34:35], v[34:35], v[62:63]
    v_pk_add_f32 v[32:33], v[32:33], v[64:65]
    s_add_u32 m0, s41, 45056
    s_nop 0
    buffer_load_dwordx4 v5, s[12:15], s30 offen lds
    v_pk_add_f32 v[34:35], v[34:35], v[66:67]
    v_pk_add_f32 v[32:33], v[32:33], v[68:69]
    v_pk_add_f32 v[34:35], v[34:35], v[70:71]
    v_pk_add_f32 v[32:33], v[32:33], v[72:73]
    v_pk_add_f32 v[34:35], v[34:35], v[74:75]
    v_pk_add_f32 v[32:33], v[32:33], v[76:77]
    v_pk_add_f32 v[34:35], v[34:35], v[78:79]
    v_pk_add_f32 v[32:33], v[32:33], v[34:35]
    v_add_f32 v32, v32, v33
    s_nop 1
    v_add_f32_dpp v32, v32, v32 quad_perm:[1,0,3,2] row_mask:0xf bank_mask:0xf
    s_nop 1
    v_add_f32_dpp v32, v32, v32 quad_perm:[2,3,0,1] row_mask:0xf bank_mask:0xf
    s_nop 1
    v_add_f32_dpp v32, v32, v32 row_half_mirror row_mask:0xf bank_mask:0xf
    s_nop 1
    v_add_f32_dpp v32, v32, v32 row_mirror row_mask:0xf bank_mask:0xf
    v_mov_b32 v33, v32
    s_nop 1
    s_add_u32 m0, s41, 49024
    s_nop 0
    buffer_load_dwordx4 v5, s[12:15], s30 offen offset:128 lds
    v_permlane16_swap_b32 v32, v33
    s_nop 1
    v_add_f32 v32, v32, v33
    v_mul_f32 v32, 0xba800000, v32
    v_pk_add_f32 v[48:49], v[48:49], v[32:33] op_sel_hi:[1,0]
    v_pk_add_f32 v[50:51], v[50:51], v[32:33] op_sel_hi:[1,0]
    v_pk_add_f32 v[52:53], v[52:53], v[32:33] op_sel_hi:[1,0]
    v_pk_add_f32 v[54:55], v[54:55], v[32:33] op_sel_hi:[1,0]
    v_pk_add_f32 v[56:57], v[56:57], v[32:33] op_sel_hi:[1,0]
    v_pk_add_f32 v[58:59], v[58:59], v[32:33] op_sel_hi:[1,0]
    v_pk_add_f32 v[60:61], v[60:61], v[32:33] op_sel_hi:[1,0]
    v_pk_add_f32 v[62:63], v[62:63], v[32:33] op_sel_hi:[1,0]
    v_pk_add_f32 v[64:65], v[64:65], v[32:33] op_sel_hi:[1,0]
    v_pk_add_f32 v[66:67], v[66:67], v[32:33] op_sel_hi:[1,0]
    v_pk_add_f32 v[68:69], v[68:69], v[32:33] op_sel_hi:[1,0]
    v_pk_add_f32 v[70:71], v[70:71], v[32:33] op_sel_hi:[1,0]
    v_pk_add_f32 v[72:73], v[72:73], v[32:33] op_sel_hi:[1,0]
    v_pk_add_f32 v[74:75], v[74:75], v[32:33] op_sel_hi:[1,0]
    v_pk_add_f32 v[76:77], v[76:77], v[32:33] op_sel_hi:[1,0]
    v_pk_add_f32 v[78:79], v[78:79], v[32:33] op_sel_hi:[1,0]
    s_add_u32 m0, s41, 53248
    s_nop 0
    buffer_load_dwordx4 v5, s[16:19], s30 offen lds
    v_pk_mul_f32 v[24:25], v[48:49], v[48:49]
    v_pk_mul_f32 v[26:27], v[50:51], v[50:51]
    v_pk_fma_f32 v[24:25], v[52:53], v[52:53], v[24:25]
    v_pk_fma_f32 v[26:27], v[54:55], v[54:55], v[26:27]
    v_pk_fma_f32 v[24:25], v[56:57], v[56:57], v[24:25]
    v_pk_fma_f32 v[26:27], v[58:59], v[58:59], v[26:27]
    v_pk_fma_f32 v[24:25], v[60:61], v[60:61], v[24:25]
    v_pk_fma_f32 v[26:27], v[62:63], v[62:63], v[26:27]
    v_pk_fma_f32 v[24:25], v[64:65], v[64:65], v[24:25]
    v_pk_fma_f32 v[26:27], v[66:67], v[66:67], v[26:27]
    v_pk_fma_f32 v[24:25], v[68:69], v[68:69], v[24:25]
    v_pk_fma_f32 v[26:27], v[70:71], v[70:71], v[26:27]
    v_pk_fma_f32 v[24:25], v[72:73], v[72:73], v[24:25]
    v_pk_fma_f32 v[26:27], v[74:75], v[74:75], v[26:27]
    v_pk_fma_f32 v[24:25], v[76:77], v[76:77], v[24:25]
    v_pk_fma_f32 v[26:27], v[78:79], v[78:79], v[26:27]
    v_mov_b32 v22, v32
    v_mfma_f32_32x32x16_bf16 v[32:47], v[80:83], v[80:83], 0
    v_mfma_f32_32x32x16_bf16 v[48:63], v[80:83], v[80:83], 0
    s_add_u32 m0, s41, 57216
    s_nop 0
    buffer_load_dwordx4 v5, s[16:19], s30 offen offset:128 lds
    s_add_u32 s33, s33, 196608
    s_add_u32 s30, s30, 229376
    v_mfma_f32_32x32x16_bf16 v[64:79], v[80:83], v[80:83], 0
    v_pk_add_f32 v[24:25], v[24:25], v[26:27]
    v_add_f32 v24, v24, v25
    s_nop 1
    v_add_f32_dpp v24, v24, v24 quad_perm:[1,0,3,2] row_mask:0xf bank_mask:0xf
    s_nop 1
    v_add_f32_dpp v24, v24, v24 quad_perm:[2,3,0,1] row_mask:0xf bank_mask:0xf
    s_nop 1
    v_add_f32_dpp v24, v24, v24 row_half_mirror row_mask:0xf bank_mask:0xf
    s_nop 1
    v_add_f32_dpp v24, v24, v24 row_mirror row_mask:0xf bank_mask:0xf
    v_mov_b32 v25, v24
    s_nop 1
    v_permlane16_swap_b32 v24, v25
    s_nop 1
    v_add_f32 v24, v24, v25
    v_mul_f32 v24, 0x3a800000, v24
    v_cvt_pk_bf16_f32 v23, v22, v24
    v_cvt_pk_bf16_f32 v20, v22, v22
    v_and_b32 v24, s77, v23
    v_add_f32 v24, 0x3727c5ac, v24
    v_cvt_pk_bf16_f32 v24, v24, v24
    v_and_b32 v24, s77, v24
    v_sqrt_f32 v24, v24
    v_lshrrev_b32 v18, 5, v1
    v_cvt_pk_bf16_f32 v24, v24, v24
    v_and_b32 v24, s77, v24
    v_rcp_f32 v21, v24
    v_lshlrev_b32 v18, 2, v18
    s_mov_b32 exec_lo, 1
    s_mov_b32 exec_hi, 1
    buffer_store_dword v20, v18, s[4:7], s79 offen offset:0 sc1
    buffer_store_dword v21, v18, s[4:7], s79 offen offset:256 sc1
    s_mov_b64 exec, -1
    s_barrier
    ds_read_b128 a[176:179], v16 offset:0
    ds_read_b128 a[180:183], v16 offset:2048
    ds_read_b128 a[184:187], v16 offset:4096
    ds_read_b128 a[188:191], v16 offset:6144
    ds_read_b64_tr_b16 a[96:97], v8 offset:0
    ds_read_b64_tr_b16 a[98:99], v8 offset:1024
    ds_read_b64_tr_b16 a[100:101], v9 offset:0
    ds_read_b64_tr_b16 a[102:103], v9 offset:1024
    ds_read_b64_tr_b16 a[104:105], v10 offset:0
    ds_read_b64_tr_b16 a[106:107], v10 offset:1024
    ds_read_b64_tr_b16 a[108:109], v11 offset:0
    ds_read_b64_tr_b16 a[110:111], v11 offset:1024
    ds_read_b64_tr_b16 a[112:113], v8 offset:4096
    ds_read_b64_tr_b16 a[114:115], v8 offset:5120
    ds_read_b64_tr_b16 a[116:117], v9 offset:4096
    ds_read_b64_tr_b16 a[118:119], v9 offset:5120
    ds_read_b64_tr_b16 a[120:121], v10 offset:4096
    ds_read_b64_tr_b16 a[122:123], v10 offset:5120
    ds_read_b64_tr_b16 a[124:125], v11 offset:4096
    ds_read_b64_tr_b16 a[126:127], v11 offset:5120
    ds_read_b64_tr_b16 a[128:129], v8 offset:8192
    ds_read_b64_tr_b16 a[130:131], v8 offset:9216
    ds_read_b64_tr_b16 a[132:133], v9 offset:8192
    ds_read_b64_tr_b16 a[134:135], v9 offset:9216
    ds_read_b64_tr_b16 a[136:137], v10 offset:8192
    ds_read_b64_tr_b16 a[138:139], v10 offset:9216
    ds_read_b64_tr_b16 a[140:141], v11 offset:8192
    ds_read_b64_tr_b16 a[142:143], v11 offset:9216
    ds_read_b64_tr_b16 a[144:145], v8 offset:12288
    ds_read_b64_tr_b16 a[146:147], v8 offset:13312
    ds_read_b64_tr_b16 a[148:149], v9 offset:12288
    ds_read_b64_tr_b16 a[150:151], v9 offset:13312
    ds_read_b64_tr_b16 a[152:153], v10 offset:12288
    ds_read_b64_tr_b16 a[154:155], v10 offset:13312
    ds_read_b64_tr_b16 a[156:157], v11 offset:12288
    ds_read_b64_tr_b16 a[158:159], v11 offset:13312
    ds_read_b64_tr_b16 a[160:161], v8 offset:16384
    ds_read_b64_tr_b16 a[162:163], v8 offset:17408
    ds_read_b64_tr_b16 a[164:165], v9 offset:16384
    ds_read_b64_tr_b16 a[166:167], v9 offset:17408
    ds_read_b64_tr_b16 a[168:169], v10 offset:16384
    ds_read_b64_tr_b16 a[170:171], v10 offset:17408
    ds_read_b64_tr_b16 a[172:173], v11 offset:16384
    ds_read_b64_tr_b16 a[174:175], v11 offset:17408
L_g1_loop1:
    s_waitcnt lgkmcnt(8)
    v_mfma_f32_16x16x32_bf16 v[32:35], a[96:99], a[176:179], v[32:35]
    v_mfma_f32_16x16x32_bf16 v[40:43], a[96:99], a[180:183], v[40:43]
    v_mfma_f32_16x16x32_bf16 v[48:51], a[96:99], a[184:187], v[48:51]
    v_mfma_f32_16x16x32_bf16 v[56:59], a[96:99], a[188:191], v[56:59]
    s_waitcnt lgkmcnt(8)
    v_mfma_f32_16x16x32_bf16 v[60:63], a[100:103], a[188:191], v[60:63]
    s_cmp_lg_u32 s74, 0
    s_cbranch_scc1 L_cs1_0
L_csr1_0:
    s_waitcnt vmcnt(11)
    s_barrier
    v_mfma_f32_16x16x32_bf16 v[52:55], a[100:103], a[184:187], v[52:55]
    ds_read_b128 a[192:195], v17 offset:0
    v_mfma_f32_16x16x32_bf16 v[44:47], a[100:103], a[180:183], v[44:47]
    ds_read_b128 a[196:199], v17 offset:2048
    v_mfma_f32_16x16x32_bf16 v[36:39], a[100:103], a[176:179], v[36:39]
    ds_read_b128 a[200:203], v17 offset:4096
    v_mfma_f32_16x16x32_bf16 v[64:67], a[104:107], a[176:179], v[64:67]
    ds_read_b128 a[204:207], v17 offset:6144
    v_mfma_f32_16x16x32_bf16 v[72:75], a[104:107], a[180:183], v[72:75]
    ds_read_b64_tr_b16 a[96:97], v8 offset:20480
    v_mfma_f32_16x16x32_bf16 v[80:83], a[104:107], a[184:187], v[80:83]
    ds_read_b64_tr_b16 a[98:99], v8 offset:21504
    v_mfma_f32_16x16x32_bf16 v[88:91], a[104:107], a[188:191], v[88:91]
    ds_read_b64_tr_b16 a[100:101], v9 offset:20480
    v_mfma_f32_16x16x32_bf16 v[92:95], a[108:111], a[188:191], v[92:95]
    ds_read_b64_tr_b16 a[102:103], v9 offset:21504
    v_mfma_f32_16x16x32_bf16 v[84:87], a[108:111], a[184:187], v[84:87]
    s_add_u32 m0, s42, 13312
    s_add_u32 s35, s34, 81920
    v_mfma_f32_16x16x32_bf16 v[76:79], a[108:111], a[180:183], v[76:79]
    buffer_load_dwordx4 v3, s[20:23], s35 offen lds
    v_mfma_f32_16x16x32_bf16 v[68:71], a[108:111], a[176:179], v[68:71]
    ds_read_b64_tr_b16 a[104:105], v10 offset:20480
    v_mfma_f32_16x16x32_bf16 v[96:99], a[112:115], a[176:179], v[96:99]
    ds_read_b64_tr_b16 a[106:107], v10 offset:21504
    v_mfma_f32_16x16x32_bf16 v[104:107], a[112:115], a[180:183], v[104:107]
    ds_read_b64_tr_b16 a[108:109], v11 offset:20480
    v_mfma_f32_16x16x32_bf16 v[112:115], a[112:115], a[184:187], v[112:115]
    ds_read_b64_tr_b16 a[110:111], v11 offset:21504
    v_mfma_f32_16x16x32_bf16 v[120:123], a[112:115], a[188:191], v[120:123]
    ds_read_b64_tr_b16 a[112:113], v8 offset:24576
    v_mfma_f32_16x16x32_bf16 v[124:127], a[116:119], a[188:191], v[124:127]
    ds_read_b64_tr_b16 a[114:115], v8 offset:25600
    v_mfma_f32_16x16x32_bf16 v[116:119], a[116:119], a[184:187], v[116:119]
    s_add_u32 m0, s41, 61440
    v_mfma_f32_16x16x32_bf16 v[108:111], a[116:119], a[180:183], v[108:111]
    buffer_load_dwordx4 v4, s[8:11], s33 offen lds
    v_mfma_f32_16x16x32_bf16 v[100:103], a[116:119], a[176:179], v[100:103]
    ds_read_b64_tr_b16 a[116:117], v9 offset:24576
    s_waitcnt lgkmcnt(8)
    v_mfma_f32_16x16x32_bf16 v[128:131], a[120:123], a[176:179], v[128:131]
    ds_read_b64_tr_b16 a[118:119], v9 offset:25600
    v_mfma_f32_16x16x32_bf16 v[136:139], a[120:123], a[180:183], v[136:139]
    v_mfma_f32_16x16x32_bf16 v[144:147], a[120:123], a[184:187], v[144:147]
    v_mfma_f32_16x16x32_bf16 v[152:155], a[120:123], a[188:191], v[152:155]
    ds_read_b64_tr_b16 a[120:121], v10 offset:24576
    v_mfma_f32_16x16x32_bf16 v[156:159], a[124:127], a[188:191], v[156:159]
    ds_read_b64_tr_b16 a[122:123], v10 offset:25600
    v_mfma_f32_16x16x32_bf16 v[148:151], a[124:127], a[184:187], v[148:151]
    s_add_u32 m0, s42, 14336
    s_add_u32 s35, s34, 98304
    v_mfma_f32_16x16x32_bf16 v[140:143], a[124:127], a[180:183], v[140:143]
    buffer_load_dwordx4 v2, s[20:23], s35 offen lds
    v_mfma_f32_16x16x32_bf16 v[132:135], a[124:127], a[176:179], v[132:135]
    ds_read_b64_tr_b16 a[124:125], v11 offset:24576
    v_mfma_f32_16x16x32_bf16 v[160:163], a[128:131], a[176:179], v[160:163]
    ds_read_b64_tr_b16 a[126:127], v11 offset:25600
    v_mfma_f32_16x16x32_bf16 v[168:171], a[128:131], a[180:183], v[168:171]
    v_mfma_f32_16x16x32_bf16 v[176:179], a[128:131], a[184:187], v[176:179]
    v_mfma_f32_16x16x32_bf16 v[184:187], a[128:131], a[188:191], v[184:187]
    ds_read_b64_tr_b16 a[128:129], v8 offset:28672
    v_mfma_f32_16x16x32_bf16 v[188:191], a[132:135], a[188:191], v[188:191]
    ds_read_b64_tr_b16 a[130:131], v8 offset:29696
    v_mfma_f32_16x16x32_bf16 v[180:183], a[132:135], a[184:187], v[180:183]
    s_add_u32 m0, s41, 65536
    v_mfma_f32_16x16x32_bf16 v[172:175], a[132:135], a[180:183], v[172:175]
    buffer_load_dwordx4 v5, s[12:15], s30 offen lds
    v_mfma_f32_16x16x32_bf16 v[164:167], a[132:135], a[176:179], v[164:167]
    ds_read_b64_tr_b16 a[132:133], v9 offset:28672
    v_mfma_f32_16x16x32_bf16 v[192:195], a[136:139], a[176:179], v[192:195]
    ds_read_b64_tr_b16 a[134:135], v9 offset:29696
    v_mfma_f32_16x16x32_bf16 v[200:203], a[136:139], a[180:183], v[200:203]
    v_mfma_f32_16x16x32_bf16 v[208:211], a[136:139], a[184:187], v[208:211]
    v_mfma_f32_16x16x32_bf16 v[216:219], a[136:139], a[188:191], v[216:219]
    ds_read_b64_tr_b16 a[136:137], v10 offset:28672
    s_waitcnt lgkmcnt(8)
    v_mfma_f32_16x16x32_bf16 v[220:223], a[140:143], a[188:191], v[220:223]
    ds_read_b64_tr_b16 a[138:139], v10 offset:29696
    v_mfma_f32_16x16x32_bf16 v[212:215], a[140:143], a[184:187], v[212:215]
    s_add_u32 m0, s42, 15360
    s_add_u32 s35, s34, 114688
    v_mfma_f32_16x16x32_bf16 v[204:207], a[140:143], a[180:183], v[204:207]
    buffer_load_dwordx4 v3, s[20:23], s35 offen lds
    s_add_u32 s34, s34, 128
    s_and_b32 s35, s34, 0x7ff
    s_cselect_b32 s35, 0, 0x800
    s_sub_u32 s34, s34, s35
    v_mfma_f32_16x16x32_bf16 v[196:199], a[140:143], a[176:179], v[196:199]
    ds_read_b64_tr_b16 a[140:141], v11 offset:28672
    v_mfma_f32_16x16x32_bf16 a[0:3], a[144:147], a[176:179], a[0:3]
    ds_read_b64_tr_b16 a[142:143], v11 offset:29696
    v_mfma_f32_16x16x32_bf16 a[8:11], a[144:147], a[180:183], a[8:11]
    v_mfma_f32_16x16x32_bf16 a[16:19], a[144:147], a[184:187], a[16:19]
    v_mfma_f32_16x16x32_bf16 a[24:27], a[144:147], a[188:191], a[24:27]
    ds_read_b64_tr_b16 a[144:145], v8 offset:32768
    v_mfma_f32_16x16x32_bf16 a[28:31], a[148:151], a[188:191], a[28:31]
    ds_read_b64_tr_b16 a[146:147], v8 offset:33792
    v_mfma_f32_16x16x32_bf16 a[20:23], a[148:151], a[184:187], a[20:23]
    s_add_u32 m0, s41, 69504
    v_mfma_f32_16x16x32_bf16 a[12:15], a[148:151], a[180:183], a[12:15]
    buffer_load_dwordx4 v5, s[12:15], s30 offen offset:128 lds
    v_mfma_f32_16x16x32_bf16 a[4:7], a[148:151], a[176:179], a[4:7]
    ds_read_b64_tr_b16 a[148:149], v9 offset:32768
    v_mfma_f32_16x16x32_bf16 a[32:35], a[152:155], a[176:179], a[32:35]
    ds_read_b64_tr_b16 a[150:151], v9 offset:33792
    v_mfma_f32_16x16x32_bf16 a[40:43], a[152:155], a[180:183], a[40:43]
    v_mfma_f32_16x16x32_bf16 a[48:51], a[152:155], a[184:187], a[48:51]
    v_mfma_f32_16x16x32_bf16 a[56:59], a[152:155], a[188:191], a[56:59]
    ds_read_b64_tr_b16 a[152:153], v10 offset:32768
    v_mfma_f32_16x16x32_bf16 a[60:63], a[156:159], a[188:191], a[60:63]
    ds_read_b64_tr_b16 a[154:155], v10 offset:33792
    v_mfma_f32_16x16x32_bf16 a[52:55], a[156:159], a[184:187], a[52:55]
    s_add_u32 m0, s41, 73728
    v_mfma_f32_16x16x32_bf16 a[44:47], a[156:159], a[180:183], a[44:47]
    buffer_load_dwordx4 v5, s[16:19], s30 offen lds
    v_mfma_f32_16x16x32_bf16 a[36:39], a[156:159], a[176:179], a[36:39]
    ds_read_b64_tr_b16 a[156:157], v11 offset:32768
    s_waitcnt lgkmcnt(8)
    v_mfma_f32_16x16x32_bf16 a[64:67], a[160:163], a[176:179], a[64:67]
    ds_read_b64_tr_b16 a[158:159], v11 offset:33792
    v_mfma_f32_16x16x32_bf16 a[72:75], a[160:163], a[180:183], a[72:75]
    v_mfma_f32_16x16x32_bf16 a[80:83], a[160:163], a[184:187], a[80:83]
    v_mfma_f32_16x16x32_bf16 a[88:91], a[160:163], a[188:191], a[88:91]
    ds_read_b64_tr_b16 a[160:161], v8 offset:36864
    v_mfma_f32_16x16x32_bf16 a[92:95], a[164:167], a[188:191], a[92:95]
    ds_read_b64_tr_b16 a[162:163], v8 offset:37888
    v_mfma_f32_16x16x32_bf16 a[84:87], a[164:167], a[184:187], a[84:87]
    s_add_u32 m0, s41, 77696
    v_mfma_f32_16x16x32_bf16 a[76:79], a[164:167], a[180:183], a[76:79]
    buffer_load_dwordx4 v5, s[16:19], s30 offen offset:128 lds
    s_add_u32 s33, s33, 196608
    s_add_u32 s30, s30, 229376
    s_cmp_eq_u32 s33, 6291456
    s_cselect_b32 s33, 0, s33
    s_cselect_b32 s30, 0, s30
    v_mfma_f32_16x16x32_bf16 a[68:71], a[164:167], a[176:179], a[68:71]
    ds_read_b64_tr_b16 a[164:165], v9 offset:36864
    v_mfma_f32_16x16x32_bf16 v[224:227], a[168:171], a[176:179], v[224:227]
    ds_read_b64_tr_b16 a[166:167], v9 offset:37888
    v_mfma_f32_16x16x32_bf16 v[232:235], a[168:171], a[180:183], v[232:235]
    v_mfma_f32_16x16x32_bf16 v[240:243], a[168:171], a[184:187], v[240:243]
    v_mfma_f32_16x16x32_bf16 v[248:251], a[168:171], a[188:191], v[248:251]
    ds_read_b64_tr_b16 a[168:169], v10 offset:36864
    v_mfma_f32_16x16x32_bf16 v[252:255], a[172:175], a[188:191], v[252:255]
    ds_read_b64_tr_b16 a[170:171], v10 offset:37888
    v_mfma_f32_16x16x32_bf16 v[244:247], a[172:175], a[184:187], v[244:247]
    v_mfma_f32_16x16x32_bf16 v[236:239], a[172:175], a[180:183], v[236:239]
    v_mfma_f32_16x16x32_bf16 v[228:231], a[172:175], a[176:179], v[228:231]
    ds_read_b64_tr_b16 a[172:173], v11 offset:36864
    ds_read_b64_tr_b16 a[174:175], v11 offset:37888
    v_mfma_f32_16x16x32_bf16 v[32:35], a[96:99], a[192:195], v[32:35]
    v_mfma_f32_16x16x32_bf16 v[40:43], a[96:99], a[196:199], v[40:43]
    v_mfma_f32_16x16x32_bf16 v[48:51], a[96:99], a[200:203], v[48:51]
    v_mfma_f32_16x16x32_bf16 v[56:59], a[96:99], a[204:207], v[56:59]
    s_waitcnt lgkmcnt(8)
    v_mfma_f32_16x16x32_bf16 v[60:63], a[100:103], a[204:207], v[60:63]
    s_cmp_lg_u32 s74, 0
    s_cbranch_scc1 L_cs1_1
L_csr1_1:
    s_waitcnt vmcnt(3)
    s_barrier
    v_mfma_f32_16x16x32_bf16 v[52:55], a[100:103], a[200:203], v[52:55]
    ds_read_b128 a[176:179], v16 offset:8192
    v_mfma_f32_16x16x32_bf16 v[44:47], a[100:103], a[196:199], v[44:47]
    ds_read_b128 a[180:183], v16 offset:10240
    v_mfma_f32_16x16x32_bf16 v[36:39], a[100:103], a[192:195], v[36:39]
    ds_read_b128 a[184:187], v16 offset:12288
    v_mfma_f32_16x16x32_bf16 v[64:67], a[104:107], a[192:195], v[64:67]
    ds_read_b128 a[188:191], v16 offset:14336
    v_mfma_f32_16x16x32_bf16 v[72:75], a[104:107], a[196:199], v[72:75]
    ds_read_b64_tr_b16 a[96:97], v12 offset:0
    v_mfma_f32_16x16x32_bf16 v[80:83], a[104:107], a[200:203], v[80:83]
    ds_read_b64_tr_b16 a[98:99], v12 offset:1024
    v_mfma_f32_16x16x32_bf16 v[88:91], a[104:107], a[204:207], v[88:91]
    ds_read_b64_tr_b16 a[100:101], v13 offset:0
    v_mfma_f32_16x16x32_bf16 v[92:95], a[108:111], a[204:207], v[92:95]
    ds_read_b64_tr_b16 a[102:103], v13 offset:1024
    v_mfma_f32_16x16x32_bf16 v[84:87], a[108:111], a[200:203], v[84:87]
    s_add_u32 m0, s42, 0
    s_add_u32 s35, s34, 0
    v_mfma_f32_16x16x32_bf16 v[76:79], a[108:111], a[196:199], v[76:79]
    buffer_load_dwordx4 v2, s[20:23], s35 offen lds
    v_mfma_f32_16x16x32_bf16 v[68:71], a[108:111], a[192:195], v[68:71]
    ds_read_b64_tr_b16 a[104:105], v14 offset:0
    v_mfma_f32_16x16x32_bf16 v[96:99], a[112:115], a[192:195], v[96:99]
    ds_read_b64_tr_b16 a[106:107], v14 offset:1024
    v_mfma_f32_16x16x32_bf16 v[104:107], a[112:115], a[196:199], v[104:107]
    s_add_u32 m0, s41, 0
    v_mfma_f32_16x16x32_bf16 v[112:115], a[112:115], a[200:203], v[112:115]
    buffer_load_dwordx4 v4, s[8:11], s33 offen lds
    v_mfma_f32_16x16x32_bf16 v[120:123], a[112:115], a[204:207], v[120:123]
    ds_read_b64_tr_b16 a[108:109], v15 offset:0
    v_mfma_f32_16x16x32_bf16 v[124:127], a[116:119], a[204:207], v[124:127]
    ds_read_b64_tr_b16 a[110:111], v15 offset:1024
    v_mfma_f32_16x16x32_bf16 v[116:119], a[116:119], a[200:203], v[116:119]
    ds_read_b64_tr_b16 a[112:113], v12 offset:4096
    v_mfma_f32_16x16x32_bf16 v[108:111], a[116:119], a[196:199], v[108:111]
    ds_read_b64_tr_b16 a[114:115], v12 offset:5120
    v_mfma_f32_16x16x32_bf16 v[100:103], a[116:119], a[192:195], v[100:103]
    ds_read_b64_tr_b16 a[116:117], v13 offset:4096
    s_waitcnt lgkmcnt(8)
    v_mfma_f32_16x16x32_bf16 v[128:131], a[120:123], a[192:195], v[128:131]
    ds_read_b64_tr_b16 a[118:119], v13 offset:5120
    v_mfma_f32_16x16x32_bf16 v[136:139], a[120:123], a[196:199], v[136:139]
    s_add_u32 m0, s42, 1024
    s_add_u32 s35, s34, 16384
    v_mfma_f32_16x16x32_bf16 v[144:147], a[120:123], a[200:203], v[144:147]
    buffer_load_dwordx4 v3, s[20:23], s35 offen lds
    v_mfma_f32_16x16x32_bf16 v[152:155], a[120:123], a[204:207], v[152:155]
    ds_read_b64_tr_b16 a[120:121], v14 offset:4096
    v_mfma_f32_16x16x32_bf16 v[156:159], a[124:127], a[204:207], v[156:159]
    ds_read_b64_tr_b16 a[122:123], v14 offset:5120
    v_mfma_f32_16x16x32_bf16 v[148:151], a[124:127], a[200:203], v[148:151]
    v_mfma_f32_16x16x32_bf16 v[140:143], a[124:127], a[196:199], v[140:143]
    v_mfma_f32_16x16x32_bf16 v[132:135], a[124:127], a[192:195], v[132:135]
    ds_read_b64_tr_b16 a[124:125], v15 offset:4096
    v_mfma_f32_16x16x32_bf16 v[160:163], a[128:131], a[192:195], v[160:163]
    ds_read_b64_tr_b16 a[126:127], v15 offset:5120
    v_mfma_f32_16x16x32_bf16 v[168:171], a[128:131], a[196:199], v[168:171]
    s_add_u32 m0, s41, 4096
    v_mfma_f32_16x16x32_bf16 v[176:179], a[128:131], a[200:203], v[176:179]
    buffer_load_dwordx4 v5, s[12:15], s30 offen lds
    v_mfma_f32_16x16x32_bf16 v[184:187], a[128:131], a[204:207], v[184:187]
    ds_read_b64_tr_b16 a[128:129], v12 offset:8192
    v_mfma_f32_16x16x32_bf16 v[188:191], a[132:135], a[204:207], v[188:191]
    ds_read_b64_tr_b16 a[130:131], v12 offset:9216
    v_mfma_f32_16x16x32_bf16 v[180:183], a[132:135], a[200:203], v[180:183]
    s_add_u32 m0, s42, 2048
    s_add_u32 s35, s34, 32768
    v_mfma_f32_16x16x32_bf16 v[172:175], a[132:135], a[196:199], v[172:175]
    buffer_load_dwordx4 v2, s[20:23], s35 offen lds
    v_mfma_f32_16x16x32_bf16 v[164:167], a[132:135], a[192:195], v[164:167]
    ds_read_b64_tr_b16 a[132:133], v13 offset:8192
    v_mfma_f32_16x16x32_bf16 v[192:195], a[136:139], a[192:195], v[192:195]
    ds_read_b64_tr_b16 a[134:135], v13 offset:9216
    v_mfma_f32_16x16x32_bf16 v[200:203], a[136:139], a[196:199], v[200:203]
    v_mfma_f32_16x16x32_bf16 v[208:211], a[136:139], a[200:203], v[208:211]
    v_mfma_f32_16x16x32_bf16 v[216:219], a[136:139], a[204:207], v[216:219]
    ds_read_b64_tr_b16 a[136:137], v14 offset:8192
    s_waitcnt lgkmcnt(8)
    v_mfma_f32_16x16x32_bf16 v[220:223], a[140:143], a[204:207], v[220:223]
    ds_read_b64_tr_b16 a[138:139], v14 offset:9216
    v_mfma_f32_16x16x32_bf16 v[212:215], a[140:143], a[200:203], v[212:215]
    s_add_u32 m0, s41, 8064
    v_mfma_f32_16x16x32_bf16 v[204:207], a[140:143], a[196:199], v[204:207]
    buffer_load_dwordx4 v5, s[12:15], s30 offen offset:128 lds
    v_mfma_f32_16x16x32_bf16 v[196:199], a[140:143], a[192:195], v[196:199]
    ds_read_b64_tr_b16 a[140:141], v15 offset:8192
    v_mfma_f32_16x16x32_bf16 a[0:3], a[144:147], a[192:195], a[0:3]
    ds_read_b64_tr_b16 a[142:143], v15 offset:9216
    v_mfma_f32_16x16x32_bf16 a[8:11], a[144:147], a[196:199], a[8:11]
    v_mfma_f32_16x16x32_bf16 a[16:19], a[144:147], a[200:203], a[16:19]
    v_mfma_f32_16x16x32_bf16 a[24:27], a[144:147], a[204:207], a[24:27]
    ds_read_b64_tr_b16 a[144:145], v12 offset:12288
    v_mfma_f32_16x16x32_bf16 a[28:31], a[148:151], a[204:207], a[28:31]
    ds_read_b64_tr_b16 a[146:147], v12 offset:13312
    v_mfma_f32_16x16x32_bf16 a[20:23], a[148:151], a[200:203], a[20:23]
    s_add_u32 m0, s42, 3072
    s_add_u32 s35, s34, 49152
    v_mfma_f32_16x16x32_bf16 a[12:15], a[148:151], a[196:199], a[12:15]
    buffer_load_dwordx4 v3, s[20:23], s35 offen lds
    v_mfma_f32_16x16x32_bf16 a[4:7], a[148:151], a[192:195], a[4:7]
    ds_read_b64_tr_b16 a[148:149], v13 offset:12288
    v_mfma_f32_16x16x32_bf16 a[32:35], a[152:155], a[192:195], a[32:35]
    ds_read_b64_tr_b16 a[150:151], v13 offset:13312
    v_mfma_f32_16x16x32_bf16 a[40:43], a[152:155], a[196:199], a[40:43]
    s_add_u32 m0, s41, 12288
    v_mfma_f32_16x16x32_bf16 a[48:51], a[152:155], a[200:203], a[48:51]
    buffer_load_dwordx4 v5, s[16:19], s30 offen lds
    v_mfma_f32_16x16x32_bf16 a[56:59], a[152:155], a[204:207], a[56:59]
    ds_read_b64_tr_b16 a[152:153], v14 offset:12288
    v_mfma_f32_16x16x32_bf16 a[60:63], a[156:159], a[204:207], a[60:63]
    ds_read_b64_tr_b16 a[154:155], v14 offset:13312
    v_mfma_f32_16x16x32_bf16 a[52:55], a[156:159], a[200:203], a[52:55]
    v_mfma_f32_16x16x32_bf16 a[44:47], a[156:159], a[196:199], a[44:47]
    v_mfma_f32_16x16x32_bf16 a[36:39], a[156:159], a[192:195], a[36:39]
    ds_read_b64_tr_b16 a[156:157], v15 offset:12288
    s_waitcnt lgkmcnt(8)
    v_mfma_f32_16x16x32_bf16 a[64:67], a[160:163], a[192:195], a[64:67]
    ds_read_b64_tr_b16 a[158:159], v15 offset:13312
    v_mfma_f32_16x16x32_bf16 a[72:75], a[160:163], a[196:199], a[72:75]
    s_add_u32 m0, s42, 4096
    s_add_u32 s35, s34, 65536
    v_mfma_f32_16x16x32_bf16 a[80:83], a[160:163], a[200:203], a[80:83]
    buffer_load_dwordx4 v2, s[20:23], s35 offen lds
    v_mfma_f32_16x16x32_bf16 a[88:91], a[160:163], a[204:207], a[88:91]
    ds_read_b64_tr_b16 a[160:161], v12 offset:16384
    v_mfma_f32_16x16x32_bf16 a[92:95], a[164:167], a[204:207], a[92:95]
    ds_read_b64_tr_b16 a[162:163], v12 offset:17408
    v_mfma_f32_16x16x32_bf16 a[84:87], a[164:167], a[200:203], a[84:87]
    v_mfma_f32_16x16x32_bf16 a[76:79], a[164:167], a[196:199], a[76:79]
    v_mfma_f32_16x16x32_bf16 a[68:71], a[164:167], a[192:195], a[68:71]
    ds_read_b64_tr_b16 a[164:165], v13 offset:16384
    v_mfma_f32_16x16x32_bf16 v[224:227], a[168:171], a[192:195], v[224:227]
    ds_read_b64_tr_b16 a[166:167], v13 offset:17408
    v_mfma_f32_16x16x32_bf16 v[232:235], a[168:171], a[196:199], v[232:235]
    s_add_u32 m0, s41, 16256
    v_mfma_f32_16x16x32_bf16 v[240:243], a[168:171], a[200:203], v[240:243]
    buffer_load_dwordx4 v5, s[16:19], s30 offen offset:128 lds
    s_add_u32 s33, s33, 196608
    s_add_u32 s30, s30, 229376
    v_mfma_f32_16x16x32_bf16 v[248:251], a[168:171], a[204:207], v[248:251]
    ds_read_b64_tr_b16 a[168:169], v14 offset:16384
    v_mfma_f32_16x16x32_bf16 v[252:255], a[172:175], a[204:207], v[252:255]
    ds_read_b64_tr_b16 a[170:171], v14 offset:17408
    v_mfma_f32_16x16x32_bf16 v[244:247], a[172:175], a[200:203], v[244:247]
    v_mfma_f32_16x16x32_bf16 v[236:239], a[172:175], a[196:199], v[236:239]
    v_mfma_f32_16x16x32_bf16 v[228:231], a[172:175], a[192:195], v[228:231]
    ds_read_b64_tr_b16 a[172:173], v15 offset:16384
    ds_read_b64_tr_b16 a[174:175], v15 offset:17408
    v_mfma_f32_16x16x32_bf16 v[32:35], a[96:99], a[176:179], v[32:35]
    v_mfma_f32_16x16x32_bf16 v[40:43], a[96:99], a[180:183], v[40:43]
    v_mfma_f32_16x16x32_bf16 v[48:51], a[96:99], a[184:187], v[48:51]
    v_mfma_f32_16x16x32_bf16 v[56:59], a[96:99], a[188:191], v[56:59]
    s_waitcnt lgkmcnt(8)
    v_mfma_f32_16x16x32_bf16 v[60:63], a[100:103], a[188:191], v[60:63]
    s_cmp_lg_u32 s74, 0
    s_cbranch_scc1 L_cs1_2
L_csr1_2:
    s_waitcnt vmcnt(10)
    s_barrier
    s_cmp_eq_u32 s29, s76
    s_cbranch_scc1 L_sig1
L_sigr1:
    v_mfma_f32_16x16x32_bf16 v[52:55], a[100:103], a[184:187], v[52:55]
    ds_read_b128 a[192:195], v17 offset:8192
    v_mfma_f32_16x16x32_bf16 v[44:47], a[100:103], a[180:183], v[44:47]
    ds_read_b128 a[196:199], v17 offset:10240
    v_mfma_f32_16x16x32_bf16 v[36:39], a[100:103], a[176:179], v[36:39]
    ds_read_b128 a[200:203], v17 offset:12288
    v_mfma_f32_16x16x32_bf16 v[64:67], a[104:107], a[176:179], v[64:67]
    ds_read_b128 a[204:207], v17 offset:14336
    v_mfma_f32_16x16x32_bf16 v[72:75], a[104:107], a[180:183], v[72:75]
    ds_read_b64_tr_b16 a[96:97], v12 offset:20480
    v_mfma_f32_16x16x32_bf16 v[80:83], a[104:107], a[184:187], v[80:83]
    ds_read_b64_tr_b16 a[98:99], v12 offset:21504
    v_mfma_f32_16x16x32_bf16 v[88:91], a[104:107], a[188:191], v[88:91]
    ds_read_b64_tr_b16 a[100:101], v13 offset:20480
    v_mfma_f32_16x16x32_bf16 v[92:95], a[108:111], a[188:191], v[92:95]
    ds_read_b64_tr_b16 a[102:103], v13 offset:21504
    v_mfma_f32_16x16x32_bf16 v[84:87], a[108:111], a[184:187], v[84:87]
    s_add_u32 m0, s42, 5120
    s_add_u32 s35, s34, 81920
    v_mfma_f32_16x16x32_bf16 v[76:79], a[108:111], a[180:183], v[76:79]
    buffer_load_dwordx4 v3, s[20:23], s35 offen lds
    v_mfma_f32_16x16x32_bf16 v[68:71], a[108:111], a[176:179], v[68:71]
    ds_read_b64_tr_b16 a[104:105], v14 offset:20480
    v_mfma_f32_16x16x32_bf16 v[96:99], a[112:115], a[176:179], v[96:99]
    ds_read_b64_tr_b16 a[106:107], v14 offset:21504
    v_mfma_f32_16x16x32_bf16 v[104:107], a[112:115], a[180:183], v[104:107]
    ds_read_b64_tr_b16 a[108:109], v15 offset:20480
    v_mfma_f32_16x16x32_bf16 v[112:115], a[112:115], a[184:187], v[112:115]
    ds_read_b64_tr_b16 a[110:111], v15 offset:21504
    v_mfma_f32_16x16x32_bf16 v[120:123], a[112:115], a[188:191], v[120:123]
    ds_read_b64_tr_b16 a[112:113], v12 offset:24576
    v_mfma_f32_16x16x32_bf16 v[124:127], a[116:119], a[188:191], v[124:127]
    ds_read_b64_tr_b16 a[114:115], v12 offset:25600
    v_mfma_f32_16x16x32_bf16 v[116:119], a[116:119], a[184:187], v[116:119]
    s_add_u32 m0, s41, 20480
    v_mfma_f32_16x16x32_bf16 v[108:111], a[116:119], a[180:183], v[108:111]
    buffer_load_dwordx4 v4, s[8:11], s33 offen lds
    v_mfma_f32_16x16x32_bf16 v[100:103], a[116:119], a[176:179], v[100:103]
    ds_read_b64_tr_b16 a[116:117], v13 offset:24576
    s_waitcnt lgkmcnt(8)
    v_mfma_f32_16x16x32_bf16 v[128:131], a[120:123], a[176:179], v[128:131]
    ds_read_b64_tr_b16 a[118:119], v13 offset:25600
    v_mfma_f32_16x16x32_bf16 v[136:139], a[120:123], a[180:183], v[136:139]
    v_mfma_f32_16x16x32_bf16 v[144:147], a[120:123], a[184:187], v[144:147]
    v_mfma_f32_16x16x32_bf16 v[152:155], a[120:123], a[188:191], v[152:155]
    ds_read_b64_tr_b16 a[120:121], v14 offset:24576
    v_mfma_f32_16x16x32_bf16 v[156:159], a[124:127], a[188:191], v[156:159]
    ds_read_b64_tr_b16 a[122:123], v14 offset:25600
    v_mfma_f32_16x16x32_bf16 v[148:151], a[124:127], a[184:187], v[148:151]
    s_add_u32 m0, s42, 6144
    s_add_u32 s35, s34, 98304
    v_mfma_f32_16x16x32_bf16 v[140:143], a[124:127], a[180:183], v[140:143]
    buffer_load_dwordx4 v2, s[20:23], s35 offen lds
    v_mfma_f32_16x16x32_bf16 v[132:135], a[124:127], a[176:179], v[132:135]
    ds_read_b64_tr_b16 a[124:125], v15 offset:24576
    v_mfma_f32_16x16x32_bf16 v[160:163], a[128:131], a[176:179], v[160:163]
    ds_read_b64_tr_b16 a[126:127], v15 offset:25600
    v_mfma_f32_16x16x32_bf16 v[168:171], a[128:131], a[180:183], v[168:171]
    v_mfma_f32_16x16x32_bf16 v[176:179], a[128:131], a[184:187], v[176:179]
    v_mfma_f32_16x16x32_bf16 v[184:187], a[128:131], a[188:191], v[184:187]
    ds_read_b64_tr_b16 a[128:129], v12 offset:28672
    v_mfma_f32_16x16x32_bf16 v[188:191], a[132:135], a[188:191], v[188:191]
    ds_read_b64_tr_b16 a[130:131], v12 offset:29696
    v_mfma_f32_16x16x32_bf16 v[180:183], a[132:135], a[184:187], v[180:183]
    s_add_u32 m0, s41, 24576
    v_mfma_f32_16x16x32_bf16 v[172:175], a[132:135], a[180:183], v[172:175]
    buffer_load_dwordx4 v5, s[12:15], s30 offen lds
    v_mfma_f32_16x16x32_bf16 v[164:167], a[132:135], a[176:179], v[164:167]
    ds_read_b64_tr_b16 a[132:133], v13 offset:28672
    v_mfma_f32_16x16x32_bf16 v[192:195], a[136:139], a[176:179], v[192:195]
    ds_read_b64_tr_b16 a[134:135], v13 offset:29696
    v_mfma_f32_16x16x32_bf16 v[200:203], a[136:139], a[180:183], v[200:203]
    v_mfma_f32_16x16x32_bf16 v[208:211], a[136:139], a[184:187], v[208:211]
    v_mfma_f32_16x16x32_bf16 v[216:219], a[136:139], a[188:191], v[216:219]
    ds_read_b64_tr_b16 a[136:137], v14 offset:28672
    s_waitcnt lgkmcnt(8)
    v_mfma_f32_16x16x32_bf16 v[220:223], a[140:143], a[188:191], v[220:223]
    ds_read_b64_tr_b16 a[138:139], v14 offset:29696
    v_mfma_f32_16x16x32_bf16 v[212:215], a[140:143], a[184:187], v[212:215]
    s_add_u32 m0, s42, 7168
    s_add_u32 s35, s34, 114688
    v_mfma_f32_16x16x32_bf16 v[204:207], a[140:143], a[180:183], v[204:207]
    buffer_load_dwordx4 v3, s[20:23], s35 offen lds
    s_add_u32 s34, s34, 128
    v_mfma_f32_16x16x32_bf16 v[196:199], a[140:143], a[176:179], v[196:199]
    ds_read_b64_tr_b16 a[140:141], v15 offset:28672
    v_mfma_f32_16x16x32_bf16 a[0:3], a[144:147], a[176:179], a[0:3]
    ds_read_b64_tr_b16 a[142:143], v15 offset:29696
    v_mfma_f32_16x16x32_bf16 a[8:11], a[144:147], a[180:183], a[8:11]
    v_mfma_f32_16x16x32_bf16 a[16:19], a[144:147], a[184:187], a[16:19]
    v_mfma_f32_16x16x32_bf16 a[24:27], a[144:147], a[188:191], a[24:27]
    ds_read_b64_tr_b16 a[144:145], v12 offset:32768
    v_mfma_f32_16x16x32_bf16 a[28:31], a[148:151], a[188:191], a[28:31]
    ds_read_b64_tr_b16 a[146:147], v12 offset:33792
    v_mfma_f32_16x16x32_bf16 a[20:23], a[148:151], a[184:187], a[20:23]
    s_add_u32 m0, s41, 28544
    v_mfma_f32_16x16x32_bf16 a[12:15], a[148:151], a[180:183], a[12:15]
    buffer_load_dwordx4 v5, s[12:15], s30 offen offset:128 lds
    v_mfma_f32_16x16x32_bf16 a[4:7], a[148:151], a[176:179], a[4:7]
    ds_read_b64_tr_b16 a[148:149], v13 offset:32768
    v_mfma_f32_16x16x32_bf16 a[32:35], a[152:155], a[176:179], a[32:35]
    ds_read_b64_tr_b16 a[150:151], v13 offset:33792
    v_mfma_f32_16x16x32_bf16 a[40:43], a[152:155], a[180:183], a[40:43]
    v_mfma_f32_16x16x32_bf16 a[48:51], a[152:155], a[184:187], a[48:51]
    v_mfma_f32_16x16x32_bf16 a[56:59], a[152:155], a[188:191], a[56:59]
    ds_read_b64_tr_b16 a[152:153], v14 offset:32768
    v_mfma_f32_16x16x32_bf16 a[60:63], a[156:159], a[188:191], a[60:63]
    ds_read_b64_tr_b16 a[154:155], v14 offset:33792
    v_mfma_f32_16x16x32_bf16 a[52:55], a[156:159], a[184:187], a[52:55]
    s_add_u32 m0, s41, 32768
    v_mfma_f32_16x16x32_bf16 a[44:47], a[156:159], a[180:183], a[44:47]
    buffer_load_dwordx4 v5, s[16:19], s30 offen lds
    v_mfma_f32_16x16x32_bf16 a[36:39], a[156:159], a[176:179], a[36:39]
    ds_read_b64_tr_b16 a[156:157], v15 offset:32768
    s_waitcnt lgkmcnt(8)
    v_mfma_f32_16x16x32_bf16 a[64:67], a[160:163], a[176:179], a[64:67]
    ds_read_b64_tr_b16 a[158:159], v15 offset:33792
    v_mfma_f32_16x16x32_bf16 a[72:75], a[160:163], a[180:183], a[72:75]
    v_mfma_f32_16x16x32_bf16 a[80:83], a[160:163], a[184:187], a[80:83]
    v_mfma_f32_16x16x32_bf16 a[88:91], a[160:163], a[188:191], a[88:91]
    ds_read_b64_tr_b16 a[160:161], v12 offset:36864
    v_mfma_f32_16x16x32_bf16 a[92:95], a[164:167], a[188:191], a[92:95]
    ds_read_b64_tr_b16 a[162:163], v12 offset:37888
    v_mfma_f32_16x16x32_bf16 a[84:87], a[164:167], a[184:187], a[84:87]
    s_add_u32 m0, s41, 36736
    v_mfma_f32_16x16x32_bf16 a[76:79], a[164:167], a[180:183], a[76:79]
    buffer_load_dwordx4 v5, s[16:19], s30 offen offset:128 lds
    s_add_u32 s33, s33, 196608
    s_add_u32 s30, s30, 229376
    v_mfma_f32_16x16x32_bf16 a[68:71], a[164:167], a[176:179], a[68:71]
    ds_read_b64_tr_b16 a[164:165], v13 offset:36864
    v_mfma_f32_16x16x32_bf16 v[224:227], a[168:171], a[176:179], v[224:227]
    ds_read_b64_tr_b16 a[166:167], v13 offset:37888
    v_mfma_f32_16x16x32_bf16 v[232:235], a[168:171], a[180:183], v[232:235]
    v_mfma_f32_16x16x32_bf16 v[240:243], a[168:171], a[184:187], v[240:243]
    v_mfma_f32_16x16x32_bf16 v[248:251], a[168:171], a[188:191], v[248:251]
    ds_read_b64_tr_b16 a[168:169], v14 offset:36864
    v_mfma_f32_16x16x32_bf16 v[252:255], a[172:175], a[188:191], v[252:255]
    ds_read_b64_tr_b16 a[170:171], v14 offset:37888
    v_mfma_f32_16x16x32_bf16 v[244:247], a[172:175], a[184:187], v[244:247]
    v_mfma_f32_16x16x32_bf16 v[236:239], a[172:175], a[180:183], v[236:239]
    v_mfma_f32_16x16x32_bf16 v[228:231], a[172:175], a[176:179], v[228:231]
    ds_read_b64_tr_b16 a[172:173], v15 offset:36864
    ds_read_b64_tr_b16 a[174:175], v15 offset:37888
    v_mfma_f32_16x16x32_bf16 v[32:35], a[96:99], a[192:195], v[32:35]
    v_mfma_f32_16x16x32_bf16 v[40:43], a[96:99], a[196:199], v[40:43]
    v_mfma_f32_16x16x32_bf16 v[48:51], a[96:99], a[200:203], v[48:51]
    v_mfma_f32_16x16x32_bf16 v[56:59], a[96:99], a[204:207], v[56:59]
    s_waitcnt lgkmcnt(8)
    v_mfma_f32_16x16x32_bf16 v[60:63], a[100:103], a[204:207], v[60:63]
    s_cmp_lg_u32 s74, 0
    s_cbranch_scc1 L_cs1_3
L_csr1_3:
    s_waitcnt vmcnt(3)
    s_barrier
    v_mfma_f32_16x16x32_bf16 v[52:55], a[100:103], a[200:203], v[52:55]
    ds_read_b128 a[176:179], v16 offset:0
    v_mfma_f32_16x16x32_bf16 v[44:47], a[100:103], a[196:199], v[44:47]
    ds_read_b128 a[180:183], v16 offset:2048
    v_mfma_f32_16x16x32_bf16 v[36:39], a[100:103], a[192:195], v[36:39]
    ds_read_b128 a[184:187], v16 offset:4096
    v_mfma_f32_16x16x32_bf16 v[64:67], a[104:107], a[192:195], v[64:67]
    ds_read_b128 a[188:191], v16 offset:6144
    v_mfma_f32_16x16x32_bf16 v[72:75], a[104:107], a[196:199], v[72:75]
    ds_read_b64_tr_b16 a[96:97], v8 offset:0
    v_mfma_f32_16x16x32_bf16 v[80:83], a[104:107], a[200:203], v[80:83]
    s_cmp_eq_u32 s29, 1
    s_cselect_b32 s50, 0, 0x1000
    buffer_load_dword v24, off, s[24:27], s50 sc1
    ds_read_b64_tr_b16 a[98:99], v8 offset:1024
    v_mfma_f32_16x16x32_bf16 v[88:91], a[104:107], a[204:207], v[88:91]
    ds_read_b64_tr_b16 a[100:101], v9 offset:0
    v_mfma_f32_16x16x32_bf16 v[92:95], a[108:111], a[204:207], v[92:95]
    ds_read_b64_tr_b16 a[102:103], v9 offset:1024
    v_mfma_f32_16x16x32_bf16 v[84:87], a[108:111], a[200:203], v[84:87]
    s_add_u32 m0, s42, 8192
    s_add_u32 s35, s34, 0
    v_mfma_f32_16x16x32_bf16 v[76:79], a[108:111], a[196:199], v[76:79]
    buffer_load_dwordx4 v2, s[20:23], s35 offen lds
    v_mfma_f32_16x16x32_bf16 v[68:71], a[108:111], a[192:195], v[68:71]
    ds_read_b64_tr_b16 a[104:105], v10 offset:0
    v_mfma_f32_16x16x32_bf16 v[96:99], a[112:115], a[192:195], v[96:99]
    ds_read_b64_tr_b16 a[106:107], v10 offset:1024
    v_mfma_f32_16x16x32_bf16 v[104:107], a[112:115], a[196:199], v[104:107]
    s_add_u32 m0, s41, 40960
    v_mfma_f32_16x16x32_bf16 v[112:115], a[112:115], a[200:203], v[112:115]
    buffer_load_dwordx4 v4, s[8:11], s33 offen lds
    v_mfma_f32_16x16x32_bf16 v[120:123], a[112:115], a[204:207], v[120:123]
    ds_read_b64_tr_b16 a[108:109], v11 offset:0
    v_mfma_f32_16x16x32_bf16 v[124:127], a[116:119], a[204:207], v[124:127]
    ds_read_b64_tr_b16 a[110:111], v11 offset:1024
    v_mfma_f32_16x16x32_bf16 v[116:119], a[116:119], a[200:203], v[116:119]
    ds_read_b64_tr_b16 a[112:113], v8 offset:4096
    v_mfma_f32_16x16x32_bf16 v[108:111], a[116:119], a[196:199], v[108:111]
    ds_read_b64_tr_b16 a[114:115], v8 offset:5120
    v_mfma_f32_16x16x32_bf16 v[100:103], a[116:119], a[192:195], v[100:103]
    ds_read_b64_tr_b16 a[116:117], v9 offset:4096
    s_waitcnt lgkmcnt(8)
    v_mfma_f32_16x16x32_bf16 v[128:131], a[120:123], a[192:195], v[128:131]
    ds_read_b64_tr_b16 a[118:119], v9 offset:5120
    v_mfma_f32_16x16x32_bf16 v[136:139], a[120:123], a[196:199], v[136:139]
    s_add_u32 m0, s42, 9216
    s_add_u32 s35, s34, 16384
    v_mfma_f32_16x16x32_bf16 v[144:147], a[120:123], a[200:203], v[144:147]
    buffer_load_dwordx4 v3, s[20:23], s35 offen lds
    v_mfma_f32_16x16x32_bf16 v[152:155], a[120:123], a[204:207], v[152:155]
    ds_read_b64_tr_b16 a[120:121], v10 offset:4096
    v_mfma_f32_16x16x32_bf16 v[156:159], a[124:127], a[204:207], v[156:159]
    ds_read_b64_tr_b16 a[122:123], v10 offset:5120
    v_mfma_f32_16x16x32_bf16 v[148:151], a[124:127], a[200:203], v[148:151]
    v_mfma_f32_16x16x32_bf16 v[140:143], a[124:127], a[196:199], v[140:143]
    v_and_b32 v23, 15, v1
    v_lshrrev_b32 v21, 4, v1
    v_mfma_f32_16x16x32_bf16 v[132:135], a[124:127], a[192:195], v[132:135]
    ds_read_b64_tr_b16 a[124:125], v11 offset:4096
    v_mfma_f32_16x16x32_bf16 v[160:163], a[128:131], a[192:195], v[160:163]
    ds_read_b64_tr_b16 a[126:127], v11 offset:5120
    v_mfma_f32_16x16x32_bf16 v[168:171], a[128:131], a[196:199], v[168:171]
    s_add_u32 m0, s41, 45056
    v_mfma_f32_16x16x32_bf16 v[176:179], a[128:131], a[200:203], v[176:179]
    v_lshlrev_b32 v23, 2, v23
    v_lshrrev_b32 v22, 5, v1
    buffer_load_dwordx4 v5, s[12:15], s30 offen lds
    v_mfma_f32_16x16x32_bf16 v[184:187], a[128:131], a[204:207], v[184:187]
    ds_read_b64_tr_b16 a[128:129], v8 offset:8192
    v_mfma_f32_16x16x32_bf16 v[188:191], a[132:135], a[204:207], v[188:191]
    ds_read_b64_tr_b16 a[130:131], v8 offset:9216
    v_mfma_f32_16x16x32_bf16 v[180:183], a[132:135], a[200:203], v[180:183]
    s_add_u32 m0, s42, 10240
    s_add_u32 s35, s34, 32768
    v_mfma_f32_16x16x32_bf16 v[172:175], a[132:135], a[196:199], v[172:175]
    v_mul_u32_u24 v20, 1280, v21
    v_lshl_add_u32 v22, v22, 6, v23
    buffer_load_dwordx4 v2, s[20:23], s35 offen lds
    v_mfma_f32_16x16x32_bf16 v[164:167], a[132:135], a[192:195], v[164:167]
    ds_read_b64_tr_b16 a[132:133], v9 offset:8192
    v_mfma_f32_16x16x32_bf16 v[192:195], a[136:139], a[192:195], v[192:195]
    ds_read_b64_tr_b16 a[134:135], v9 offset:9216
    v_mfma_f32_16x16x32_bf16 v[200:203], a[136:139], a[196:199], v[200:203]
    v_mfma_f32_16x16x32_bf16 v[208:211], a[136:139], a[200:203], v[208:211]
    v_add_u32 v20, v20, v23
    s_mul_i32 s48, s56, 10240
    v_mfma_f32_16x16x32_bf16 v[216:219], a[136:139], a[204:207], v[216:219]
    ds_read_b64_tr_b16 a[136:137], v10 offset:8192
    s_waitcnt lgkmcnt(8)
    v_mfma_f32_16x16x32_bf16 v[220:223], a[140:143], a[204:207], v[220:223]
    ds_read_b64_tr_b16 a[138:139], v10 offset:9216
    v_mfma_f32_16x16x32_bf16 v[212:215], a[140:143], a[200:203], v[212:215]
    s_add_u32 m0, s41, 49024
    v_mfma_f32_16x16x32_bf16 v[204:207], a[140:143], a[196:199], v[204:207]
    v_add_u32 v21, 5120, v20
    s_mul_i32 s49, s28, 320
    buffer_load_dwordx4 v5, s[12:15], s30 offen offset:128 lds
    v_mfma_f32_16x16x32_bf16 v[196:199], a[140:143], a[192:195], v[196:199]
    ds_read_b64_tr_b16 a[140:141], v11 offset:8192
    v_mfma_f32_16x16x32_bf16 a[0:3], a[144:147], a[192:195], a[0:3]
    ds_read_b64_tr_b16 a[142:143], v11 offset:9216
    v_mfma_f32_16x16x32_bf16 a[8:11], a[144:147], a[196:199], a[8:11]
    v_mfma_f32_16x16x32_bf16 a[16:19], a[144:147], a[200:203], a[16:19]
    s_add_u32 s48, s48, s49
    s_add_u32 s48, s48, 0x10000
    v_mfma_f32_16x16x32_bf16 a[24:27], a[144:147], a[204:207], a[24:27]
    ds_read_b64_tr_b16 a[144:145], v8 offset:12288
    v_mfma_f32_16x16x32_bf16 a[28:31], a[148:151], a[204:207], a[28:31]
    ds_read_b64_tr_b16 a[146:147], v8 offset:13312
    v_mfma_f32_16x16x32_bf16 a[20:23], a[148:151], a[200:203], a[20:23]
    s_add_u32 m0, s42, 11264
    s_add_u32 s35, s34, 49152
    v_mfma_f32_16x16x32_bf16 a[12:15], a[148:151], a[196:199], a[12:15]
    s_lshl_b32 s49, s57, 2
    s_add_u32 s49, s49, s28
    buffer_load_dwordx4 v3, s[20:23], s35 offen lds
    v_mfma_f32_16x16x32_bf16 a[4:7], a[148:151], a[192:195], a[4:7]
    ds_read_b64_tr_b16 a[148:149], v9 offset:12288
    v_mfma_f32_16x16x32_bf16 a[32:35], a[152:155], a[192:195], a[32:35]
    ds_read_b64_tr_b16 a[150:151], v9 offset:13312
    v_mfma_f32_16x16x32_bf16 a[40:43], a[152:155], a[196:199], a[40:43]
    s_add_u32 m0, s41, 53248
    v_mfma_f32_16x16x32_bf16 a[48:51], a[152:155], a[200:203], a[48:51]
    s_lshl_b32 s49, s49, 9
    buffer_load_dwordx4 v5, s[16:19], s30 offen lds
    v_mfma_f32_16x16x32_bf16 a[56:59], a[152:155], a[204:207], a[56:59]
    ds_read_b64_tr_b16 a[152:153], v10 offset:12288
    v_mfma_f32_16x16x32_bf16 a[60:63], a[156:159], a[204:207], a[60:63]
    ds_read_b64_tr_b16 a[154:155], v10 offset:13312
    v_mfma_f32_16x16x32_bf16 a[52:55], a[156:159], a[200:203], a[52:55]
    v_mfma_f32_16x16x32_bf16 a[44:47], a[156:159], a[196:199], a[44:47]
    v_mfma_f32_16x16x32_bf16 a[36:39], a[156:159], a[192:195], a[36:39]
    ds_read_b64_tr_b16 a[156:157], v11 offset:12288
    s_waitcnt lgkmcnt(8)
    v_mfma_f32_16x16x32_bf16 a[64:67], a[160:163], a[192:195], a[64:67]
    ds_read_b64_tr_b16 a[158:159], v11 offset:13312
    v_mfma_f32_16x16x32_bf16 a[72:75], a[160:163], a[196:199], a[72:75]
    s_add_u32 m0, s42, 12288
    s_add_u32 s35, s34, 65536
    v_mfma_f32_16x16x32_bf16 a[80:83], a[160:163], a[200:203], a[80:83]
    buffer_load_dwordx4 v2, s[20:23], s35 offen lds
    v_mfma_f32_16x16x32_bf16 a[88:91], a[160:163], a[204:207], a[88:91]
    ds_read_b64_tr_b16 a[160:161], v8 offset:16384
    v_mfma_f32_16x16x32_bf16 a[92:95], a[164:167], a[204:207], a[92:95]
    ds_read_b64_tr_b16 a[162:163], v8 offset:17408
    v_mfma_f32_16x16x32_bf16 a[84:87], a[164:167], a[200:203], a[84:87]
    v_mfma_f32_16x16x32_bf16 a[76:79], a[164:167], a[196:199], a[76:79]
    v_mfma_f32_16x16x32_bf16 a[68:71], a[164:167], a[192:195], a[68:71]
    ds_read_b64_tr_b16 a[164:165], v9 offset:16384
    v_mfma_f32_16x16x32_bf16 v[224:227], a[168:171], a[192:195], v[224:227]
    ds_read_b64_tr_b16 a[166:167], v9 offset:17408
    v_mfma_f32_16x16x32_bf16 v[232:235], a[168:171], a[196:199], v[232:235]
    s_add_u32 m0, s41, 57216
    v_mfma_f32_16x16x32_bf16 v[240:243], a[168:171], a[200:203], v[240:243]
    buffer_load_dwordx4 v5, s[16:19], s30 offen offset:128 lds
    s_add_u32 s33, s33, 196608
    s_add_u32 s30, s30, 229376
    v_mfma_f32_16x16x32_bf16 v[248:251], a[168:171], a[204:207], v[248:251]
    ds_read_b64_tr_b16 a[168:169], v10 offset:16384
    v_mfma_f32_16x16x32_bf16 v[252:255], a[172:175], a[204:207], v[252:255]
    ds_read_b64_tr_b16 a[170:171], v10 offset:17408
    v_mfma_f32_16x16x32_bf16 v[244:247], a[172:175], a[200:203], v[244:247]
    v_mfma_f32_16x16x32_bf16 v[236:239], a[172:175], a[196:199], v[236:239]
    v_mfma_f32_16x16x32_bf16 v[228:231], a[172:175], a[192:195], v[228:231]
    ds_read_b64_tr_b16 a[172:173], v11 offset:16384
    ds_read_b64_tr_b16 a[174:175], v11 offset:17408
    s_cmp_eq_u32 s29, s75
    s_cbranch_scc1 L_cst1
L_cstr1:
    s_sub_u32 s77, s29, 1
    s_cmp_eq_u32 s77, s75
    s_cselect_b32 s74, 1, 0
    s_sub_u32 s29, s29, 1
    s_cmp_lg_u32 s29, 0
    s_cbranch_scc1 L_g1_loop1
L_g1_tail1:
    v_mfma_f32_16x16x32_bf16 v[32:35], a[96:99], a[176:179], v[32:35]
    s_waitcnt vmcnt(10)
    v_readfirstlane_b32 s77, v24
    s_cmp_lt_u32 s77, 256
    s_cbranch_scc1 L_slow1
L_slowr1:
    v_mfma_f32_16x16x32_bf16 v[40:43], a[96:99], a[180:183], v[40:43]
    buffer_load_dword v28, v23, s[4:7], s49 offen offset:256 sc1
    v_mfma_f32_16x16x32_bf16 v[48:51], a[96:99], a[184:187], v[48:51]
    v_mfma_f32_16x16x32_bf16 v[56:59], a[96:99], a[188:191], v[56:59]
    buffer_load_dword v29, v23, s[4:7], s49 offen offset:320 sc1
    v_mfma_f32_16x16x32_bf16 v[60:63], a[100:103], a[188:191], v[60:63]
    s_barrier
    ds_read_b64_tr_b16 a[96:97], v8 offset:20480
    v_mfma_f32_16x16x32_bf16 v[52:55], a[100:103], a[184:187], v[52:55]
    s_add_u32 m0, s42, 13312
    s_add_u32 s35, s34, 81920
    v_mfma_f32_16x16x32_bf16 v[44:47], a[100:103], a[180:183], v[44:47]
    buffer_load_dwordx4 v3, s[20:23], s35 offen lds
    v_mfma_f32_16x16x32_bf16 v[36:39], a[100:103], a[176:179], v[36:39]
    buffer_load_dword v30, v23, s[4:7], s49 offen offset:384 sc1
    v_mfma_f32_16x16x32_bf16 v[64:67], a[104:107], a[176:179], v[64:67]
    ds_read_b64_tr_b16 a[98:99], v8 offset:21504
    v_mfma_f32_16x16x32_bf16 v[72:75], a[104:107], a[180:183], v[72:75]
    s_add_u32 m0, s42, 14336
    s_add_u32 s35, s34, 98304
    v_mfma_f32_16x16x32_bf16 v[80:83], a[104:107], a[184:187], v[80:83]
    buffer_load_dwordx4 v2, s[20:23], s35 offen lds
    v_mfma_f32_16x16x32_bf16 v[88:91], a[104:107], a[188:191], v[88:91]
    buffer_load_dword v31, v23, s[4:7], s49 offen offset:448 sc1
    v_mfma_f32_16x16x32_bf16 v[92:95], a[108:111], a[188:191], v[92:95]
    ds_read_b64_tr_b16 a[100:101], v9 offset:20480
    v_mfma_f32_16x16x32_bf16 v[84:87], a[108:111], a[184:187], v[84:87]
    s_add_u32 m0, s42, 15360
    s_add_u32 s35, s34, 114688
    v_mfma_f32_16x16x32_bf16 v[76:79], a[108:111], a[180:183], v[76:79]
    buffer_load_dwordx4 v3, s[20:23], s35 offen lds
    v_mfma_f32_16x16x32_bf16 v[68:71], a[108:111], a[176:179], v[68:71]
    buffer_load_dword a228, v22, s[4:7], s49 offen offset:0 sc1
    v_mfma_f32_16x16x32_bf16 v[96:99], a[112:115], a[176:179], v[96:99]
    ds_read_b64_tr_b16 a[102:103], v9 offset:21504
    v_mfma_f32_16x16x32_bf16 v[104:107], a[112:115], a[180:183], v[104:107]
    s_add_u32 m0, s41, 61440
    v_mfma_f32_16x16x32_bf16 v[112:115], a[112:115], a[184:187], v[112:115]
    buffer_load_dwordx4 v4, s[8:11], s33 offen lds
    v_mfma_f32_16x16x32_bf16 v[120:123], a[112:115], a[188:191], v[120:123]
    buffer_load_dword a230, v22, s[4:7], s49 offen offset:128 sc1
    v_mfma_f32_16x16x32_bf16 v[124:127], a[116:119], a[188:191], v[124:127]
    ds_read_b64_tr_b16 a[104:105], v10 offset:20480
    v_mfma_f32_16x16x32_bf16 v[116:119], a[116:119], a[184:187], v[116:119]
    s_add_u32 m0, s41, 65536
    v_mfma_f32_16x16x32_bf16 v[108:111], a[116:119], a[180:183], v[108:111]
    buffer_load_dwordx4 v5, s[12:15], s30 offen lds
    v_mfma_f32_16x16x32_bf16 v[100:103], a[116:119], a[176:179], v[100:103]
    buffer_load_dword v22, v20, s[4:7], s48 offen offset:0 sc1
    v_mfma_f32_16x16x32_bf16 v[128:131], a[120:123], a[176:179], v[128:131]
    ds_read_b64_tr_b16 a[106:107], v10 offset:21504
    v_mfma_f32_16x16x32_bf16 v[136:139], a[120:123], a[180:183], v[136:139]
    s_add_u32 m0, s41, 69504
    v_mfma_f32_16x16x32_bf16 v[144:147], a[120:123], a[184:187], v[144:147]
    buffer_load_dwordx4 v5, s[12:15], s30 offen offset:128 lds
    v_mfma_f32_16x16x32_bf16 v[152:155], a[120:123], a[188:191], v[152:155]
    buffer_load_dword v23, v21, s[4:7], s48 offen offset:0 sc1
    v_mfma_f32_16x16x32_bf16 v[156:159], a[124:127], a[188:191], v[156:159]
    ds_read_b64_tr_b16 a[108:109], v11 offset:20480
    v_mfma_f32_16x16x32_bf16 v[148:151], a[124:127], a[184:187], v[148:151]
    s_add_u32 m0, s41, 73728
    v_mfma_f32_16x16x32_bf16 v[140:143], a[124:127], a[180:183], v[140:143]
    buffer_load_dwordx4 v5, s[16:19], s30 offen lds
    v_mfma_f32_16x16x32_bf16 v[132:135], a[124:127], a[176:179], v[132:135]
    buffer_load_dword v24, v20, s[4:7], s48 offen offset:64 sc1
    v_mfma_f32_16x16x32_bf16 v[160:163], a[128:131], a[176:179], v[160:163]
    ds_read_b64_tr_b16 a[110:111], v11 offset:21504
    v_mfma_f32_16x16x32_bf16 v[168:171], a[128:131], a[180:183], v[168:171]
    s_add_u32 m0, s41, 77696
    v_mfma_f32_16x16x32_bf16 v[176:179], a[128:131], a[184:187], v[176:179]
    buffer_load_dwordx4 v5, s[16:19], s30 offen offset:128 lds
    v_mfma_f32_16x16x32_bf16 v[184:187], a[128:131], a[188:191], v[184:187]
    buffer_load_dword v25, v21, s[4:7], s48 offen offset:64 sc1
    v_mfma_f32_16x16x32_bf16 v[188:191], a[132:135], a[188:191], v[188:191]
    ds_read_b128 a[192:195], v17 offset:0
    v_and_b32 v0, 31, v1
    v_mfma_f32_16x16x32_bf16 v[180:183], a[132:135], a[184:187], v[180:183]
    buffer_load_dword v26, v20, s[4:7], s48 offen offset:128 sc1
    ds_read_b128 a[196:199], v17 offset:2048
    v_lshlrev_b32 v0, 3, v0
    v_mfma_f32_16x16x32_bf16 v[172:175], a[132:135], a[180:183], v[172:175]
    ds_read_b128 a[200:203], v17 offset:4096
    v_add_u32 v0, 147456, v0
    v_mfma_f32_16x16x32_bf16 v[164:167], a[132:135], a[176:179], v[164:167]
    buffer_load_dword v27, v21, s[4:7], s48 offen offset:128 sc1
    ds_read_b128 a[204:207], v17 offset:6144
    v_lshlrev_b32 v2, 4, v1
    v_mfma_f32_16x16x32_bf16 v[192:195], a[136:139], a[176:179], v[192:195]
    s_waitcnt vmcnt(20)
    s_barrier
    v_lshlrev_b32 v3, 4, v1
    ds_read_b64_tr_b16 a[112:113], v12 offset:0
    v_mfma_f32_16x16x32_bf16 v[200:203], a[136:139], a[180:183], v[200:203]
    buffer_load_dword v18, v20, s[4:7], s48 offen offset:192 sc1
    s_lshl_b32 s58, s57, 3
    v_mfma_f32_16x16x32_bf16 v[208:211], a[136:139], a[184:187], v[208:211]
    s_lshl_b32 s59, s28, 1
    ds_read_b64_tr_b16 a[114:115], v12 offset:1024
    v_mfma_f32_16x16x32_bf16 v[216:219], a[136:139], a[188:191], v[216:219]
    buffer_load_dword v19, v21, s[4:7], s48 offen offset:192 sc1
    s_add_u32 s58, s58, s59
    s_waitcnt lgkmcnt(8)
    v_mfma_f32_16x16x32_bf16 v[220:223], a[140:143], a[188:191], v[220:223]
    s_and_b32 s60, s56, 15
    ds_read_b64_tr_b16 a[116:117], v13 offset:0
    v_mfma_f32_16x16x32_bf16 v[212:215], a[140:143], a[184:187], v[212:215]
    buffer_load_dword v20, v20, s[4:7], s48 offen offset:256 sc1
    s_lshl_b32 s60, s60, 7
    v_mfma_f32_16x16x32_bf16 v[204:207], a[140:143], a[180:183], v[204:207]
    s_add_u32 s60, s60, s58
    ds_read_b64_tr_b16 a[118:119], v13 offset:1024
    v_mfma_f32_16x16x32_bf16 v[196:199], a[140:143], a[176:179], v[196:199]
    buffer_load_dword v21, v21, s[4:7], s48 offen offset:256 sc1
    s_mov_b32 s62, 0x400000
    v_mfma_f32_16x16x32_bf16 a[0:3], a[144:147], a[176:179], a[0:3]
    s_mov_b32 s44, 0x3e8293ee
    ds_read_b64_tr_b16 a[120:121], v14 offset:0
    v_mfma_f32_16x16x32_bf16 a[8:11], a[144:147], a[180:183], a[8:11]
    s_cmp_ge_u32 s56, 16
    ds_read_b64_tr_b16 a[122:123], v14 offset:1024
    v_mfma_f32_16x16x32_bf16 a[16:19], a[144:147], a[184:187], a[16:19]
    s_cselect_b32 s61, 12, 11
    ds_read_b64_tr_b16 a[124:125], v15 offset:0
    v_mfma_f32_16x16x32_bf16 a[24:27], a[144:147], a[188:191], a[24:27]
    s_cselect_b32 s62, 0x800000, s62
    ds_read_b64_tr_b16 a[126:127], v15 offset:1024
    v_mfma_f32_16x16x32_bf16 a[28:31], a[148:151], a[188:191], a[28:31]
    s_cselect_b32 s44, 1.0, s44
    ds_read_b64_tr_b16 a[128:129], v8 offset:24576
    v_mfma_f32_16x16x32_bf16 a[20:23], a[148:151], a[184:187], a[20:23]
    s_add_u32 s64, s60, 0
    ds_read_b64_tr_b16 a[130:131], v8 offset:25600
    v_mfma_f32_16x16x32_bf16 a[12:15], a[148:151], a[180:183], a[12:15]
    s_lshl_b32 s64, s64, s61
    v_mfma_f32_16x16x32_bf16 a[4:7], a[148:151], a[176:179], a[4:7]
    s_add_u32 s64, s64, s62
    v_mfma_f32_16x16x32_bf16 a[32:35], a[152:155], a[176:179], a[32:35]
    s_add_u32 s65, s60, 1
    ds_read_b64_tr_b16 a[132:133], v9 offset:24576
    v_mfma_f32_16x16x32_bf16 a[40:43], a[152:155], a[180:183], a[40:43]
    s_lshl_b32 s65, s65, s61
    ds_read_b64_tr_b16 a[134:135], v9 offset:25600
    v_mfma_f32_16x16x32_bf16 a[48:51], a[152:155], a[184:187], a[48:51]
    s_add_u32 s65, s65, s62
    v_mfma_f32_16x16x32_bf16 a[56:59], a[152:155], a[188:191], a[56:59]
    s_add_u32 s66, s60, 64
    v_mfma_f32_16x16x32_bf16 a[60:63], a[156:159], a[188:191], a[60:63]
    s_lshl_b32 s66, s66, s61
    ds_read_b64_tr_b16 a[136:137], v8 offset:32768
    v_mfma_f32_16x16x32_bf16 a[52:55], a[156:159], a[184:187], a[52:55]
    s_add_u32 s66, s66, s62
    ds_read_b64_tr_b16 a[138:139], v8 offset:33792
    v_mfma_f32_16x16x32_bf16 a[44:47], a[156:159], a[180:183], a[44:47]
    s_add_u32 s67, s60, 65
    v_mfma_f32_16x16x32_bf16 a[36:39], a[156:159], a[176:179], a[36:39]
    s_lshl_b32 s67, s67, s61
    v_mfma_f32_16x16x32_bf16 a[64:67], a[160:163], a[176:179], a[64:67]
    s_add_u32 s67, s67, s62
    ds_read_b64_tr_b16 a[140:141], v9 offset:32768
    v_mfma_f32_16x16x32_bf16 a[72:75], a[160:163], a[180:183], a[72:75]
    s_lshr_b32 s60, s58, 2
    ds_read_b64_tr_b16 a[142:143], v9 offset:33792
    v_mfma_f32_16x16x32_bf16 a[80:83], a[160:163], a[184:187], a[80:83]
    s_mul_i32 s60, s60, 144
    v_mfma_f32_16x16x32_bf16 a[88:91], a[160:163], a[188:191], a[88:91]
    s_lshl_b32 s61, s56, 2
    v_mfma_f32_16x16x32_bf16 a[92:95], a[164:167], a[188:191], a[92:95]
    s_add_u32 s60, s60, s61
    ds_read_b64_tr_b16 a[144:145], v12 offset:4096
    v_mfma_f32_16x16x32_bf16 a[84:87], a[164:167], a[184:187], a[84:87]
    s_lshl_b32 s60, s60, 1
    ds_read_b64_tr_b16 a[146:147], v12 offset:5120
    v_mfma_f32_16x16x32_bf16 a[76:79], a[164:167], a[180:183], a[76:79]
    s_and_b32 s61, s28, 1
    v_mfma_f32_16x16x32_bf16 a[68:71], a[164:167], a[176:179], a[68:71]
    s_add_u32 s60, s60, s61
    v_mfma_f32_16x16x32_bf16 v[224:227], a[168:171], a[176:179], v[224:227]
    s_waitcnt vmcnt(17)
    ds_read_b128 a[240:243], v16 offset:8192
    s_lshl_b32 s60, s60, 12
    v_mfma_f32_16x16x32_bf16 v[232:235], a[168:171], a[180:183], v[232:235]
    ds_read_b128 a[244:247], v16 offset:10240
    s_add_u32 s70, s60, 0x1000000
    v_mfma_f32_16x16x32_bf16 v[240:243], a[168:171], a[184:187], v[240:243]
    ds_read_b128 a[248:251], v16 offset:12288
    s_mov_b32 s46, 0xbfb8aa3b
    v_mfma_f32_16x16x32_bf16 v[248:251], a[168:171], a[188:191], v[248:251]
    ds_read_b128 a[252:255], v16 offset:14336
    s_mul_i32 s77, s28, 640
    v_mfma_f32_16x16x32_bf16 v[252:255], a[172:175], a[188:191], v[252:255]
    s_add_u32 s77, s77, 147456
    ds_read_b64_tr_b16 a[148:149], v13 offset:4096
    v_mfma_f32_16x16x32_bf16 v[244:247], a[172:175], a[184:187], v[244:247]
    s_mov_b32 s72, 0xffff0000
    ds_read_b64_tr_b16 a[150:151], v13 offset:5120
    v_mfma_f32_16x16x32_bf16 v[236:239], a[172:175], a[180:183], v[236:239]
    s_mov_b32 s73, 0x07060302
    ds_read_b64_tr_b16 a[152:153], v12 offset:12288
    v_mfma_f32_16x16x32_bf16 v[228:231], a[172:175], a[176:179], v[228:231]
    ds_read_b64_tr_b16 a[154:155], v12 offset:13312
    s_waitcnt lgkmcnt(8)
    v_mfma_f32_16x16x32_bf16 v[32:35], a[96:99], a[192:195], v[32:35]
    ds_read_b128 a[176:179], v17 offset:8192
    s_waitcnt vmcnt(0)
    v_add_f32 v20, v20, v21
    v_add_f32 v22, v22, v23
    v_mfma_f32_16x16x32_bf16 v[40:43], a[96:99], a[196:199], v[40:43]
    ds_read_b128 a[180:183], v17 offset:10240
    v_add_f32 v26, v26, v27
    v_mov_b32 v21, v20
    v_mfma_f32_16x16x32_bf16 v[48:51], a[96:99], a[200:203], v[48:51]
    ds_read_b128 a[184:187], v17 offset:12288
    v_add_f32 v24, v24, v25
    v_add_f32 v18, v18, v19
    v_mfma_f32_16x16x32_bf16 v[56:59], a[96:99], a[204:207], v[56:59]
    ds_read_b128 a[188:191], v17 offset:14336
    v_accvgpr_mov_b32 a229, a228
    v_permlane32_swap_b32 v20, v21
    v_mfma_f32_16x16x32_bf16 v[60:63], a[100:103], a[204:207], v[60:63]
    v_permlane32_swap_b32 v22, v26
    v_permlane32_swap_b32 v24, v18
    ds_read_b64_tr_b16 a[156:157], v13 offset:12288
    v_mfma_f32_16x16x32_bf16 v[52:55], a[100:103], a[200:203], v[52:55]
    v_add_f32 v20, v20, v21
    v_add_f32 v22, v22, v26
    ds_read_b64_tr_b16 a[158:159], v13 offset:13312
    v_mfma_f32_16x16x32_bf16 v[44:47], a[100:103], a[196:199], v[44:47]
    v_add_f32 v24, v24, v18
    v_mov_b32 v21, v20
    v_mfma_f32_16x16x32_bf16 v[36:39], a[100:103], a[192:195], v[36:39]
    v_accvgpr_mov_b32 a231, a230
    v_lshl_add_u32 v16, v1, 3, s77
    v_mfma_f32_16x16x32_bf16 v[64:67], a[104:107], a[192:195], v[64:67]
    v_permlane16_swap_b32 v22, v24
    v_permlane16_swap_b32 v20, v21
    v_mfma_f32_16x16x32_bf16 v[72:75], a[104:107], a[196:199], v[72:75]
    v_add_f32 v22, v22, v24
    v_add_f32 v20, v20, v21
    v_mfma_f32_16x16x32_bf16 v[80:83], a[104:107], a[200:203], v[80:83]
    v_and_b32 v17, 15, v1
    v_and_b32 v24, s72, v22
    v_mfma_f32_16x16x32_bf16 v[88:91], a[104:107], a[204:207], v[88:91]
    v_and_b32 v25, s72, v20
    v_sub_f32 v23, v22, v24
    v_mfma_f32_16x16x32_bf16 v[92:95], a[108:111], a[204:207], v[92:95]
    v_lshl_add_u32 v17, v17, 3, s77
    v_sub_f32 v21, v20, v25
    v_mfma_f32_16x16x32_bf16 v[84:87], a[108:111], a[200:203], v[84:87]
    v_and_b32 v24, s72, v23
    v_and_b32 v25, s72, v21
    v_mfma_f32_16x16x32_bf16 v[76:79], a[108:111], a[196:199], v[76:79]
    v_perm_b32 v22, v23, v22, s73
    v_perm_b32 v20, v21, v20, s73
    v_mfma_f32_16x16x32_bf16 v[68:71], a[108:111], a[192:195], v[68:71]
    v_sub_f32 v23, v23, v24
    v_sub_f32 v21, v21, v25
    s_waitcnt lgkmcnt(8)
    v_mfma_f32_16x16x32_bf16 v[32:35], a[112:115], a[240:243], v[32:35]
    v_lshrrev_b32 v23, 16, v23
    v_lshrrev_b32 v21, 16, v21
    ds_write_b64 v16, v[22:23]
    ds_write_b64 v17, v[20:21] offset:512
    v_mfma_f32_16x16x32_bf16 v[40:43], a[112:115], a[244:247], v[40:43]
    v_mfma_f32_16x16x32_bf16 v[48:51], a[112:115], a[248:251], v[48:51]
    v_mfma_f32_16x16x32_bf16 v[56:59], a[112:115], a[252:255], v[56:59]
    v_mfma_f32_16x16x32_bf16 v[60:63], a[116:119], a[252:255], v[60:63]
    s_waitcnt lgkmcnt(0)
    s_barrier
    v_mfma_f32_16x16x32_bf16 v[52:55], a[116:119], a[248:251], v[52:55]
    v_rcp_f32 v16, v28
    ds_read_b64_tr_b16 a[160:161], v12 offset:20480
    v_mfma_f32_16x16x32_bf16 v[44:47], a[116:119], a[244:247], v[44:47]
    v_mul_f32 v20, s46, v28
    v_mul_f32 v28, s44, v28
    ds_read_b64_tr_b16 a[162:163], v12 offset:21504
    v_mfma_f32_16x16x32_bf16 v[36:39], a[116:119], a[240:243], v[36:39]
    v_rcp_f32 v18, v29
    ds_read_b64_tr_b16 a[164:165], v13 offset:20480
    v_mfma_f32_16x16x32_bf16 v[64:67], a[120:123], a[240:243], v[64:67]
    v_mul_f32 v22, s46, v29
    v_mul_f32 v29, s44, v29
    ds_read_b64_tr_b16 a[166:167], v13 offset:21504
    v_mfma_f32_16x16x32_bf16 v[72:75], a[120:123], a[244:247], v[72:75]
    v_rcp_f32 v4, v30
    ds_read_b64_tr_b16 a[168:169], v14 offset:20480
    v_mfma_f32_16x16x32_bf16 v[80:83], a[120:123], a[248:251], v[80:83]
    v_mul_f32 v24, s46, v30
    v_mul_f32 v30, s44, v30
    ds_read_b64_tr_b16 a[170:171], v14 offset:21504
    v_mfma_f32_16x16x32_bf16 v[88:91], a[120:123], a[252:255], v[88:91]
    v_rcp_f32 v6, v31
    ds_read_b64_tr_b16 a[172:173], v15 offset:20480
    v_mfma_f32_16x16x32_bf16 v[92:95], a[124:127], a[252:255], v[92:95]
    v_mul_f32 v26, s46, v31
    v_mul_f32 v31, s44, v31
    ds_read_b64_tr_b16 a[174:175], v15 offset:21504
    v_mfma_f32_16x16x32_bf16 v[84:87], a[124:127], a[248:251], v[84:87]
    ds_read2_b64 a[208:211], v0 offset0:0 offset1:32
    v_mfma_f32_16x16x32_bf16 v[76:79], a[124:127], a[244:247], v[76:79]
    ds_read2_b64 a[212:215], v0 offset0:64 offset1:192
    v_mfma_f32_16x16x32_bf16 v[68:71], a[124:127], a[240:243], v[68:71]
    ds_read2_b64 a[216:219], v0 offset0:96 offset1:224
    s_waitcnt lgkmcnt(8)
    v_mfma_f32_16x16x32_bf16 v[32:35], a[160:163], a[176:179], v[32:35]
    ds_read2st64_b64 a[220:223], v0 offset0:2 offset1:4
    v_mfma_f32_16x16x32_bf16 v[40:43], a[160:163], a[180:183], v[40:43]
    ds_read_b64 a[224:225], v0 offset:1280
    ds_read_b64 a[226:227], v0 offset:2304
    v_mfma_f32_16x16x32_bf16 v[48:51], a[160:163], a[184:187], v[48:51]
    ds_read_b64_tr_b16 a[96:97], v12 offset:24576
    v_mfma_f32_16x16x32_bf16 v[56:59], a[160:163], a[188:191], v[56:59]
    ds_read_b64_tr_b16 a[98:99], v12 offset:25600
    s_waitcnt lgkmcnt(8)
    v_mfma_f32_16x16x32_bf16 v[60:63], a[164:167], a[188:191], v[60:63]
    ds_read_b64_tr_b16 a[100:101], v13 offset:24576
    v_mfma_f32_16x16x32_bf16 v[52:55], a[164:167], a[184:187], v[52:55]
    ds_read_b64_tr_b16 a[102:103], v13 offset:25600
    v_mfma_f32_16x16x32_bf16 v[44:47], a[164:167], a[180:183], v[44:47]
    ds_read_b64_tr_b16 a[104:105], v12 offset:32768
    v_mfma_f32_16x16x32_bf16 v[36:39], a[164:167], a[176:179], v[36:39]
    ds_read_b64_tr_b16 a[106:107], v12 offset:33792
    v_mfma_f32_16x16x32_bf16 v[64:67], a[168:171], a[176:179], v[64:67]
    ds_read_b64_tr_b16 a[108:109], v13 offset:32768
    v_mfma_f32_16x16x32_bf16 v[72:75], a[168:171], a[180:183], v[72:75]
    ds_read_b64_tr_b16 a[110:111], v13 offset:33792
    v_mfma_f32_16x16x32_bf16 v[80:83], a[168:171], a[184:187], v[80:83]
    ds_read_b64_tr_b16 a[112:113], v10 offset:24576
    v_mfma_f32_16x16x32_bf16 v[88:91], a[168:171], a[188:191], v[88:91]
    ds_read_b64_tr_b16 a[114:115], v10 offset:25600
    v_mfma_f32_16x16x32_bf16 v[92:95], a[172:175], a[188:191], v[92:95]
    ds_read_b64_tr_b16 a[116:117], v11 offset:24576
    s_waitcnt lgkmcnt(8)
    v_mfma_f32_16x16x4_4b_bf16 v[32:47], a[208:209], a[228:229], v[32:47]
    v_mfma_f32_16x16x32_bf16 v[84:87], a[172:175], a[184:187], v[84:87]
    ds_read_b64_tr_b16 a[118:119], v11 offset:25600
    v_mfma_f32_16x16x32_bf16 v[76:79], a[172:175], a[180:183], v[76:79]
    ds_read_b64_tr_b16 a[120:121], v10 offset:32768
    v_mfma_f32_16x16x4_4b_bf16 v[48:63], a[208:209], a[230:231], v[48:63]
    v_mfma_f32_16x16x32_bf16 v[68:71], a[172:175], a[176:179], v[68:71]
    ds_read_b64_tr_b16 a[122:123], v10 offset:33792
    v_mfma_f32_16x16x32_bf16 v[96:99], a[128:131], a[192:195], v[96:99]
    ds_read_b64_tr_b16 a[124:125], v11 offset:32768
    v_mfma_f32_16x16x32_bf16 v[104:107], a[128:131], a[196:199], v[104:107]
    ds_read_b64_tr_b16 a[126:127], v11 offset:33792
    s_nop 0
    v_mul_f32 v32, v28, v32
    v_mfma_f32_16x16x32_bf16 v[112:115], a[128:131], a[200:203], v[112:115]
    ds_read_b64_tr_b16 a[160:161], v14 offset:4096
    v_mul_f32 v33, v28, v33
    v_mfma_f32_16x16x32_bf16 v[120:123], a[128:131], a[204:207], v[120:123]
    ds_read_b64_tr_b16 a[162:163], v14 offset:5120
    v_mul_f32 v34, v28, v34
    v_mul_f32 v35, v28, v35
    v_mfma_f32_16x16x32_bf16 v[124:127], a[132:135], a[204:207], v[124:127]
    ds_read_b64_tr_b16 a[164:165], v15 offset:4096
    v_mul_f32 v36, v28, v36
    v_mfma_f32_16x16x4_4b_bf16 v[64:79], a[210:211], a[228:229], v[64:79]
    v_mul_f32 v37, v28, v37
    v_mul_f32 v38, v28, v38
    v_mul_f32 v39, v28, v39
    v_cvt_pk_bf16_f32 v32, v32, v33
    v_mfma_f32_16x16x32_bf16 v[116:119], a[132:135], a[200:203], v[116:119]
    ds_read_b64_tr_b16 a[166:167], v15 offset:5120
    v_cvt_pk_bf16_f32 v33, v34, v35
    v_mfma_f32_16x16x32_bf16 v[108:111], a[132:135], a[196:199], v[108:111]
    ds_read_b64_tr_b16 a[168:169], v14 offset:12288
    v_cvt_pk_bf16_f32 v34, v36, v37
    v_cvt_pk_bf16_f32 v35, v38, v39
    v_mfma_f32_16x16x32_bf16 v[100:103], a[132:135], a[192:195], v[100:103]
    ds_read_b64_tr_b16 a[170:171], v14 offset:13312
    buffer_store_dwordx4 v[32:35], v2, s[4:7], s64 offen offset:0 sc1
    v_mul_f32 v40, v29, v40
    v_mfma_f32_16x16x32_bf16 a[0:3], a[136:139], a[192:195], a[0:3]
    ds_read_b64_tr_b16 a[172:173], v15 offset:12288
    v_mul_f32 v41, v29, v41
    v_mul_f32 v42, v29, v42
    v_mfma_f32_16x16x32_bf16 a[8:11], a[136:139], a[196:199], a[8:11]
    ds_read_b64_tr_b16 a[174:175], v15 offset:13312
    v_mul_f32 v43, v29, v43
    v_mul_f32 v44, v29, v44
    v_mfma_f32_16x16x32_bf16 a[16:19], a[136:139], a[200:203], a[16:19]
    ds_read_b64_tr_b16 a[128:129], v14 offset:24576
    v_mul_f32 v45, v29, v45
    v_mfma_f32_16x16x32_bf16 a[24:27], a[136:139], a[204:207], a[24:27]
    ds_read_b64_tr_b16 a[130:131], v14 offset:25600
    v_mul_f32 v46, v29, v46
    v_mul_f32 v47, v29, v47
    v_mfma_f32_16x16x4_4b_bf16 v[80:95], a[210:211], a[230:231], v[80:95]
    v_cvt_pk_bf16_f32 v40, v40, v41
    v_cvt_pk_bf16_f32 v41, v42, v43
    v_cvt_pk_bf16_f32 v42, v44, v45
    v_mfma_f32_16x16x32_bf16 a[28:31], a[140:143], a[204:207], a[28:31]
    ds_read_b64_tr_b16 a[132:133], v15 offset:24576
    v_cvt_pk_bf16_f32 v43, v46, v47
    buffer_store_dwordx4 v[40:43], v2, s[4:7], s64 offen offset:1024 sc1
    v_mul_f32 v48, v30, v48
    v_mfma_f32_16x16x32_bf16 a[20:23], a[140:143], a[200:203], a[20:23]
    ds_read_b64_tr_b16 a[134:135], v15 offset:25600
    v_mul_f32 v49, v30, v49
    v_mfma_f32_16x16x32_bf16 a[12:15], a[140:143], a[196:199], a[12:15]
    ds_read_b64_tr_b16 a[136:137], v14 offset:32768
    v_mul_f32 v50, v30, v50
    v_mul_f32 v51, v30, v51
    v_mfma_f32_16x16x32_bf16 a[4:7], a[140:143], a[192:195], a[4:7]
    ds_read_b64_tr_b16 a[138:139], v14 offset:33792
    v_mul_f32 v52, v30, v52
    v_mul_f32 v53, v30, v53
    v_mfma_f32_16x16x32_bf16 v[96:99], a[144:147], a[240:243], v[96:99]
    ds_read_b64_tr_b16 a[140:141], v15 offset:32768
    v_mul_f32 v54, v30, v54
    v_mfma_f32_16x16x32_bf16 v[104:107], a[144:147], a[244:247], v[104:107]
    ds_read_b64_tr_b16 a[142:143], v15 offset:33792
    v_mul_f32 v55, v30, v55
    v_cvt_pk_bf16_f32 v48, v48, v49
    v_mfma_f32_16x16x32_bf16 v[112:115], a[144:147], a[248:251], v[112:115]
    v_cvt_pk_bf16_f32 v49, v50, v51
    v_cvt_pk_bf16_f32 v50, v52, v53
    v_mfma_f32_16x16x32_bf16 v[120:123], a[144:147], a[252:255], v[120:123]
    v_cvt_pk_bf16_f32 v51, v54, v55
    v_mfma_f32_16x16x4_4b_bf16 a[0:15], a[214:215], a[228:229], a[0:15]
    buffer_store_dwordx4 v[48:51], v2, s[4:7], s65 offen offset:0 sc1
    v_mul_f32 v56, v31, v56
    v_mul_f32 v57, v31, v57
    v_mul_f32 v58, v31, v58
    v_mfma_f32_16x16x32_bf16 v[124:127], a[148:151], a[252:255], v[124:127]
    ds_read_b64_tr_b16 a[144:145], v8 offset:28672
    v_mul_f32 v59, v31, v59
    v_mul_f32 v60, v31, v60
    v_mfma_f32_16x16x32_bf16 v[116:119], a[148:151], a[248:251], v[116:119]
    ds_read_b64_tr_b16 a[146:147], v8 offset:29696
    v_mul_f32 v61, v31, v61
    v_mul_f32 v62, v31, v62
    v_mfma_f32_16x16x32_bf16 v[108:111], a[148:151], a[244:247], v[108:111]
    v_mul_f32 v63, v31, v63
    v_mfma_f32_16x16x32_bf16 v[100:103], a[148:151], a[240:243], v[100:103]
    v_cvt_pk_bf16_f32 v56, v56, v57
    v_cvt_pk_bf16_f32 v57, v58, v59
    v_mfma_f32_16x16x32_bf16 a[0:3], a[152:155], a[240:243], a[0:3]
    ds_read_b64_tr_b16 a[148:149], v9 offset:28672
    v_cvt_pk_bf16_f32 v58, v60, v61
    v_cvt_pk_bf16_f32 v59, v62, v63
    v_mfma_f32_16x16x32_bf16 a[8:11], a[152:155], a[244:247], a[8:11]
    ds_read_b64_tr_b16 a[150:151], v9 offset:29696
    buffer_store_dwordx4 v[56:59], v2, s[4:7], s65 offen offset:1024 sc1
    v_mul_f32 v64, v28, v64
    v_mfma_f32_16x16x32_bf16 a[16:19], a[152:155], a[248:251], a[16:19]
    v_mul_f32 v65, v28, v65
    v_mul_f32 v66, v28, v66
    v_mfma_f32_16x16x32_bf16 a[24:27], a[152:155], a[252:255], a[24:27]
    v_mul_f32 v67, v28, v67
    v_mfma_f32_16x16x4_4b_bf16 v[96:111], a[212:213], a[228:229], v[96:111]
    v_mul_f32 v68, v28, v68
    v_mul_f32 v69, v28, v69
    v_mul_f32 v70, v28, v70
    v_mul_f32 v71, v28, v71
    v_mfma_f32_16x16x32_bf16 a[28:31], a[156:159], a[252:255], a[28:31]
    ds_read_b64_tr_b16 a[152:153], v8 offset:36864
    v_cvt_pk_bf16_f32 v64, v64, v65
    v_mfma_f32_16x16x32_bf16 a[20:23], a[156:159], a[248:251], a[20:23]
    ds_read_b64_tr_b16 a[154:155], v8 offset:37888
    v_cvt_pk_bf16_f32 v65, v66, v67
    v_cvt_pk_bf16_f32 v66, v68, v69
    v_mfma_f32_16x16x32_bf16 a[12:15], a[156:159], a[244:247], a[12:15]
    v_cvt_pk_bf16_f32 v67, v70, v71
    v_mfma_f32_16x16x32_bf16 a[4:7], a[156:159], a[240:243], a[4:7]
    buffer_store_dwordx4 v[64:67], v2, s[4:7], s66 offen offset:0 sc1
    v_mul_f32 v72, v29, v72
    v_mul_f32 v73, v29, v73
    v_mfma_f32_16x16x32_bf16 v[96:99], a[96:99], a[176:179], v[96:99]
    ds_read_b64_tr_b16 a[156:157], v9 offset:36864
    v_mul_f32 v74, v29, v74
    v_mul_f32 v75, v29, v75
    v_mfma_f32_16x16x32_bf16 v[104:107], a[96:99], a[180:183], v[104:107]
    ds_read_b64_tr_b16 a[158:159], v9 offset:37888
    v_mul_f32 v76, v29, v76
    v_mfma_f32_16x16x32_bf16 v[112:115], a[96:99], a[184:187], v[112:115]
    v_mul_f32 v77, v29, v77
    v_mul_f32 v78, v29, v78
    v_mfma_f32_16x16x32_bf16 v[120:123], a[96:99], a[188:191], v[120:123]
    v_mul_f32 v79, v29, v79
    v_cvt_pk_bf16_f32 v72, v72, v73
    v_mfma_f32_16x16x4_4b_bf16 a[16:31], a[214:215], a[230:231], a[16:31]
    v_cvt_pk_bf16_f32 v73, v74, v75
    v_cvt_pk_bf16_f32 v74, v76, v77
    v_cvt_pk_bf16_f32 v75, v78, v79
    s_waitcnt lgkmcnt(8)
    v_mfma_f32_16x16x32_bf16 v[124:127], a[100:103], a[188:191], v[124:127]
    ds_read_b64_tr_b16 a[96:97], v12 offset:8192
    buffer_store_dwordx4 v[72:75], v2, s[4:7], s66 offen offset:1024 sc1
    v_mul_f32 v80, v30, v80
    v_mfma_f32_16x16x32_bf16 v[116:119], a[100:103], a[184:187], v[116:119]
    ds_read_b64_tr_b16 a[98:99], v12 offset:9216
    v_mul_f32 v81, v30, v81
    v_mul_f32 v82, v30, v82
    v_mfma_f32_16x16x32_bf16 v[108:111], a[100:103], a[180:183], v[108:111]
    v_mul_f32 v83, v30, v83
    v_mul_f32 v84, v30, v84
    v_mfma_f32_16x16x32_bf16 v[100:103], a[100:103], a[176:179], v[100:103]
    v_mul_f32 v85, v30, v85
    v_mfma_f32_16x16x32_bf16 a[0:3], a[104:107], a[176:179], a[0:3]
    ds_read_b64_tr_b16 a[100:101], v13 offset:8192
    v_mul_f32 v86, v30, v86
    v_mul_f32 v87, v30, v87
    v_mfma_f32_16x16x32_bf16 a[8:11], a[104:107], a[180:183], a[8:11]
    ds_read_b64_tr_b16 a[102:103], v13 offset:9216
    v_cvt_pk_bf16_f32 v80, v80, v81
    v_cvt_pk_bf16_f32 v81, v82, v83
    v_mfma_f32_16x16x32_bf16 a[16:19], a[104:107], a[184:187], a[16:19]
    v_cvt_pk_bf16_f32 v82, v84, v85
    v_mfma_f32_16x16x32_bf16 a[24:27], a[104:107], a[188:191], a[24:27]
    v_cvt_pk_bf16_f32 v83, v86, v87
    buffer_store_dwordx4 v[80:83], v2, s[4:7], s67 offen offset:0 sc1
    v_mul_f32 v88, v31, v88
    v_mfma_f32_16x16x4_4b_bf16 v[112:127], a[212:213], a[230:231], v[112:127]
    v_mul_f32 v89, v31, v89
    v_mul_f32 v90, v31, v90
    v_mul_f32 v91, v31, v91
    v_mfma_f32_16x16x32_bf16 a[28:31], a[108:111], a[188:191], a[28:31]
    ds_read_b64_tr_b16 a[104:105], v12 offset:16384
    v_mul_f32 v92, v31, v92
    v_mul_f32 v93, v31, v93
    v_mfma_f32_16x16x32_bf16 a[20:23], a[108:111], a[184:187], a[20:23]
    ds_read_b64_tr_b16 a[106:107], v12 offset:17408
    v_mul_f32 v94, v31, v94
    v_mfma_f32_16x16x32_bf16 a[12:15], a[108:111], a[180:183], a[12:15]
    v_mul_f32 v95, v31, v95
    v_cvt_pk_bf16_f32 v88, v88, v89
    v_mfma_f32_16x16x32_bf16 a[4:7], a[108:111], a[176:179], a[4:7]
    v_cvt_pk_bf16_f32 v89, v90, v91
    v_cvt_pk_bf16_f32 v90, v92, v93
    v_cvt_pk_bf16_f32 v91, v94, v95
    buffer_store_dwordx4 v[88:91], v2, s[4:7], s67 offen offset:1024 sc1
    v_pk_mul_f32 v[96:97], v[96:97], v[20:21] op_sel_hi:[1,0]
    v_pk_mul_f32 v[98:99], v[98:99], v[20:21] op_sel_hi:[1,0]
    v_pk_mul_f32 v[100:101], v[100:101], v[20:21] op_sel_hi:[1,0]
    v_pk_mul_f32 v[102:103], v[102:103], v[20:21] op_sel_hi:[1,0]
    v_pk_mul_f32 v[104:105], v[104:105], v[22:23] op_sel_hi:[1,0]
    v_pk_mul_f32 v[106:107], v[106:107], v[22:23] op_sel_hi:[1,0]
    v_pk_mul_f32 v[108:109], v[108:109], v[22:23] op_sel_hi:[1,0]
    v_pk_mul_f32 v[110:111], v[110:111], v[22:23] op_sel_hi:[1,0]
    v_accvgpr_read_b32 v32, a0
    v_accvgpr_read_b32 v33, a1
    v_mfma_f32_16x16x32_bf16 v[128:131], a[112:115], a[192:195], v[128:131]
    ds_read_b64_tr_b16 a[108:109], v13 offset:16384
    v_accvgpr_read_b32 v34, a2
    v_accvgpr_read_b32 v35, a3
    v_mfma_f32_16x16x32_bf16 v[136:139], a[112:115], a[196:199], v[136:139]
    ds_read_b64_tr_b16 a[110:111], v13 offset:17408
    v_accvgpr_read_b32 v36, a4
    v_accvgpr_read_b32 v37, a5
    v_mfma_f32_16x16x32_bf16 v[144:147], a[112:115], a[200:203], v[144:147]
    v_accvgpr_read_b32 v38, a6
    v_accvgpr_read_b32 v39, a7
    v_accvgpr_read_b32 v40, a8
    v_accvgpr_read_b32 v41, a9
    v_mfma_f32_16x16x32_bf16 v[152:155], a[112:115], a[204:207], v[152:155]
    v_accvgpr_read_b32 v42, a10
    v_accvgpr_read_b32 v43, a11
    v_mfma_f32_16x16x32_bf16 v[156:159], a[116:119], a[204:207], v[156:159]
    ds_read_b64_tr_b16 a[112:113], v12 offset:28672
    v_accvgpr_read_b32 v44, a12
    v_accvgpr_read_b32 v45, a13
    v_mfma_f32_16x16x32_bf16 v[148:151], a[116:119], a[200:203], v[148:151]
    ds_read_b64_tr_b16 a[114:115], v12 offset:29696
    v_accvgpr_read_b32 v46, a14
    v_accvgpr_read_b32 v47, a15
    v_exp_f32 v96, v96
    v_mfma_f32_16x16x32_bf16 v[140:143], a[116:119], a[196:199], v[140:143]
    v_exp_f32 v97, v97
    v_mfma_f32_16x16x32_bf16 v[132:135], a[116:119], a[192:195], v[132:135]
    v_exp_f32 v98, v98
    v_mfma_f32_16x16x32_bf16 a[32:35], a[120:123], a[192:195], a[32:35]
    ds_read_b64_tr_b16 a[116:117], v13 offset:28672
    v_exp_f32 v99, v99
    v_exp_f32 v100, v100
    v_mfma_f32_16x16x32_bf16 a[40:43], a[120:123], a[196:199], a[40:43]
    ds_read_b64_tr_b16 a[118:119], v13 offset:29696
    v_exp_f32 v101, v101
    v_mfma_f32_16x16x32_bf16 a[48:51], a[120:123], a[200:203], a[48:51]
    v_exp_f32 v102, v102
    v_mfma_f32_16x16x32_bf16 a[56:59], a[120:123], a[204:207], a[56:59]
    v_exp_f32 v103, v103
    v_exp_f32 v104, v104
    v_mfma_f32_16x16x32_bf16 a[60:63], a[124:127], a[204:207], a[60:63]
    ds_read_b64_tr_b16 a[120:121], v12 offset:36864
    v_exp_f32 v105, v105
    v_mfma_f32_16x16x32_bf16 a[52:55], a[124:127], a[200:203], a[52:55]
    ds_read_b64_tr_b16 a[122:123], v12 offset:37888
    v_exp_f32 v106, v106
    v_exp_f32 v107, v107
    v_mfma_f32_16x16x32_bf16 a[44:47], a[124:127], a[196:199], a[44:47]
    v_exp_f32 v108, v108
    v_mfma_f32_16x16x32_bf16 a[36:39], a[124:127], a[192:195], a[36:39]
    v_exp_f32 v109, v109
    v_mfma_f32_16x16x32_bf16 v[128:131], a[160:163], a[240:243], v[128:131]
    ds_read_b64_tr_b16 a[124:125], v13 offset:36864
    v_exp_f32 v110, v110
    v_exp_f32 v111, v111
    v_pk_fma_f32 v[96:97], v[96:97], v[16:17], v[16:17] op_sel_hi:[1,0,0]
    v_pk_fma_f32 v[98:99], v[98:99], v[16:17], v[16:17] op_sel_hi:[1,0,0]
    v_pk_fma_f32 v[100:101], v[100:101], v[16:17], v[16:17] op_sel_hi:[1,0,0]
    v_pk_fma_f32 v[102:103], v[102:103], v[16:17], v[16:17] op_sel_hi:[1,0,0]
    v_pk_fma_f32 v[104:105], v[104:105], v[18:19], v[18:19] op_sel_hi:[1,0,0]
    v_pk_fma_f32 v[106:107], v[106:107], v[18:19], v[18:19] op_sel_hi:[1,0,0]
    v_pk_fma_f32 v[108:109], v[108:109], v[18:19], v[18:19] op_sel_hi:[1,0,0]
    v_pk_fma_f32 v[110:111], v[110:111], v[18:19], v[18:19] op_sel_hi:[1,0,0]
    v_rcp_f32 v96, v96
    v_rcp_f32 v97, v97
    v_mfma_f32_16x16x32_bf16 v[136:139], a[160:163], a[244:247], v[136:139]
    ds_read_b64_tr_b16 a[126:127], v13 offset:37888
    v_rcp_f32 v98, v98
    v_mfma_f32_16x16x32_bf16 v[144:147], a[160:163], a[248:251], v[144:147]
    v_rcp_f32 v99, v99
    v_mfma_f32_16x16x32_bf16 v[152:155], a[160:163], a[252:255], v[152:155]
    v_rcp_f32 v100, v100
    v_rcp_f32 v101, v101
    v_mfma_f32_16x16x4_4b_bf16 a[32:47], a[218:219], a[228:229], a[32:47]
    v_rcp_f32 v102, v102
    v_rcp_f32 v103, v103
    v_mfma_f32_16x16x32_bf16 v[156:159], a[164:167], a[252:255], v[156:159]
    ds_read_b64_tr_b16 a[160:161], v10 offset:28672
    v_rcp_f32 v104, v104
    v_rcp_f32 v105, v105
    v_mfma_f32_16x16x32_bf16 v[148:151], a[164:167], a[248:251], v[148:151]
    ds_read_b64_tr_b16 a[162:163], v10 offset:29696
    v_rcp_f32 v106, v106
    v_mfma_f32_16x16x32_bf16 v[140:143], a[164:167], a[244:247], v[140:143]
    v_rcp_f32 v107, v107
    v_mfma_f32_16x16x32_bf16 v[132:135], a[164:167], a[240:243], v[132:135]
    v_rcp_f32 v108, v108
    v_rcp_f32 v109, v109
    v_mfma_f32_16x16x32_bf16 a[32:35], a[168:171], a[240:243], a[32:35]
    ds_read_b64_tr_b16 a[164:165], v11 offset:28672
    v_rcp_f32 v110, v110
    v_rcp_f32 v111, v111
    v_pk_mul_f32 v[96:97], v[96:97], v[32:33]
    v_pk_mul_f32 v[98:99], v[98:99], v[34:35]
    v_pk_mul_f32 v[100:101], v[100:101], v[36:37]
    v_pk_mul_f32 v[102:103], v[102:103], v[38:39]
    v_pk_mul_f32 v[104:105], v[104:105], v[40:41]
    v_pk_mul_f32 v[106:107], v[106:107], v[42:43]
    v_pk_mul_f32 v[108:109], v[108:109], v[44:45]
    v_pk_mul_f32 v[110:111], v[110:111], v[46:47]
    v_cvt_pk_bf16_f32 v96, v96, v97
    v_mfma_f32_16x16x32_bf16 a[40:43], a[168:171], a[244:247], a[40:43]
    ds_read_b64_tr_b16 a[166:167], v11 offset:29696
    v_cvt_pk_bf16_f32 v97, v98, v99
    v_cvt_pk_bf16_f32 v98, v100, v101
    v_cvt_pk_bf16_f32 v99, v102, v103
    buffer_store_dwordx4 v[96:99], v3, s[4:7], s70 offen offset:0 sc1
    v_cvt_pk_bf16_f32 v104, v104, v105
    v_cvt_pk_bf16_f32 v105, v106, v107
    v_cvt_pk_bf16_f32 v106, v108, v109
    v_cvt_pk_bf16_f32 v107, v110, v111
    buffer_store_dwordx4 v[104:107], v3, s[4:7], s70 offen offset:1024 sc1
    v_pk_mul_f32 v[112:113], v[112:113], v[24:25] op_sel_hi:[1,0]
    v_pk_mul_f32 v[114:115], v[114:115], v[24:25] op_sel_hi:[1,0]
    v_pk_mul_f32 v[116:117], v[116:117], v[24:25] op_sel_hi:[1,0]
    v_pk_mul_f32 v[118:119], v[118:119], v[24:25] op_sel_hi:[1,0]
    v_pk_mul_f32 v[120:121], v[120:121], v[26:27] op_sel_hi:[1,0]
    v_pk_mul_f32 v[122:123], v[122:123], v[26:27] op_sel_hi:[1,0]
    v_pk_mul_f32 v[124:125], v[124:125], v[26:27] op_sel_hi:[1,0]
    v_pk_mul_f32 v[126:127], v[126:127], v[26:27] op_sel_hi:[1,0]
    v_accvgpr_read_b32 v48, a16
    v_accvgpr_read_b32 v49, a17
    v_mfma_f32_16x16x32_bf16 a[48:51], a[168:171], a[248:251], a[48:51]
    v_accvgpr_read_b32 v50, a18
    v_accvgpr_read_b32 v51, a19
    v_mfma_f32_16x16x32_bf16 a[56:59], a[168:171], a[252:255], a[56:59]
    v_accvgpr_read_b32 v52, a20
    v_accvgpr_read_b32 v53, a21
    v_mfma_f32_16x16x4_4b_bf16 v[128:143], a[216:217], a[228:229], v[128:143]
    v_accvgpr_read_b32 v54, a22
    v_accvgpr_read_b32 v55, a23
    v_accvgpr_read_b32 v56, a24
    v_accvgpr_read_b32 v57, a25
    v_accvgpr_read_b32 v58, a26
    v_accvgpr_read_b32 v59, a27
    v_mfma_f32_16x16x32_bf16 a[60:63], a[172:175], a[252:255], a[60:63]
    ds_read_b64_tr_b16 a[168:169], v10 offset:36864
    v_accvgpr_read_b32 v60, a28
    v_accvgpr_read_b32 v61, a29
    v_mfma_f32_16x16x32_bf16 a[52:55], a[172:175], a[248:251], a[52:55]
    ds_read_b64_tr_b16 a[170:171], v10 offset:37888
    v_accvgpr_read_b32 v62, a30
    v_accvgpr_read_b32 v63, a31
    v_exp_f32 v112, v112
    v_mfma_f32_16x16x32_bf16 a[44:47], a[172:175], a[244:247], a[44:47]
    v_exp_f32 v113, v113
    v_mfma_f32_16x16x32_bf16 a[36:39], a[172:175], a[240:243], a[36:39]
    v_exp_f32 v114, v114
    v_mfma_f32_16x16x32_bf16 v[128:131], a[128:131], a[176:179], v[128:131]
    ds_read_b64_tr_b16 a[172:173], v11 offset:36864
    v_exp_f32 v115, v115
    v_exp_f32 v116, v116
    v_mfma_f32_16x16x32_bf16 v[136:139], a[128:131], a[180:183], v[136:139]
    ds_read_b64_tr_b16 a[174:175], v11 offset:37888
    v_exp_f32 v117, v117
    v_mfma_f32_16x16x32_bf16 v[144:147], a[128:131], a[184:187], v[144:147]
    v_exp_f32 v118, v118
    v_mfma_f32_16x16x32_bf16 v[152:155], a[128:131], a[188:191], v[152:155]
    v_exp_f32 v119, v119
    v_exp_f32 v120, v120
    v_mfma_f32_16x16x4_4b_bf16 a[48:63], a[218:219], a[230:231], a[48:63]
    v_exp_f32 v121, v121
    v_exp_f32 v122, v122
    v_exp_f32 v123, v123
    v_mfma_f32_16x16x32_bf16 v[156:159], a[132:135], a[188:191], v[156:159]
    ds_read_b64_tr_b16 a[128:129], v14 offset:8192
    v_exp_f32 v124, v124
    v_mfma_f32_16x16x32_bf16 v[148:151], a[132:135], a[184:187], v[148:151]
    ds_read_b64_tr_b16 a[130:131], v14 offset:9216
    v_exp_f32 v125, v125
    v_mfma_f32_16x16x32_bf16 v[140:143], a[132:135], a[180:183], v[140:143]
    v_exp_f32 v126, v126
    v_exp_f32 v127, v127
    v_pk_fma_f32 v[112:113], v[112:113], v[4:5], v[4:5] op_sel_hi:[1,0,0]
    v_pk_fma_f32 v[114:115], v[114:115], v[4:5], v[4:5] op_sel_hi:[1,0,0]
    v_pk_fma_f32 v[116:117], v[116:117], v[4:5], v[4:5] op_sel_hi:[1,0,0]
    v_pk_fma_f32 v[118:119], v[118:119], v[4:5], v[4:5] op_sel_hi:[1,0,0]
    v_pk_fma_f32 v[120:121], v[120:121], v[6:7], v[6:7] op_sel_hi:[1,0,0]
    v_pk_fma_f32 v[122:123], v[122:123], v[6:7], v[6:7] op_sel_hi:[1,0,0]
    v_pk_fma_f32 v[124:125], v[124:125], v[6:7], v[6:7] op_sel_hi:[1,0,0]
    v_pk_fma_f32 v[126:127], v[126:127], v[6:7], v[6:7] op_sel_hi:[1,0,0]
    v_rcp_f32 v112, v112
    v_rcp_f32 v113, v113
    v_mfma_f32_16x16x32_bf16 v[132:135], a[132:135], a[176:179], v[132:135]
    v_rcp_f32 v114, v114
    v_mfma_f32_16x16x32_bf16 a[32:35], a[136:139], a[176:179], a[32:35]
    ds_read_b64_tr_b16 a[132:133], v15 offset:8192
    v_rcp_f32 v115, v115
    v_mfma_f32_16x16x32_bf16 a[40:43], a[136:139], a[180:183], a[40:43]
    ds_read_b64_tr_b16 a[134:135], v15 offset:9216
    v_rcp_f32 v116, v116
    v_rcp_f32 v117, v117
    v_mfma_f32_16x16x32_bf16 a[48:51], a[136:139], a[184:187], a[48:51]
    v_rcp_f32 v118, v118
    v_mfma_f32_16x16x32_bf16 a[56:59], a[136:139], a[188:191], a[56:59]
    v_rcp_f32 v119, v119
    v_mfma_f32_16x16x4_4b_bf16 v[144:159], a[216:217], a[230:231], v[144:159]
    v_rcp_f32 v120, v120
    v_rcp_f32 v121, v121
    v_rcp_f32 v122, v122
    v_mfma_f32_16x16x32_bf16 a[60:63], a[140:143], a[188:191], a[60:63]
    ds_read_b64_tr_b16 a[136:137], v14 offset:16384
    v_rcp_f32 v123, v123
    v_mfma_f32_16x16x32_bf16 a[52:55], a[140:143], a[184:187], a[52:55]
    ds_read_b64_tr_b16 a[138:139], v14 offset:17408
    v_rcp_f32 v124, v124
    v_rcp_f32 v125, v125
    v_mfma_f32_16x16x32_bf16 a[44:47], a[140:143], a[180:183], a[44:47]
    v_rcp_f32 v126, v126
    v_rcp_f32 v127, v127
    v_pk_mul_f32 v[112:113], v[112:113], v[48:49]
    v_pk_mul_f32 v[114:115], v[114:115], v[50:51]
    v_pk_mul_f32 v[116:117], v[116:117], v[52:53]
    v_pk_mul_f32 v[118:119], v[118:119], v[54:55]
    v_pk_mul_f32 v[120:121], v[120:121], v[56:57]
    v_pk_mul_f32 v[122:123], v[122:123], v[58:59]
    v_pk_mul_f32 v[124:125], v[124:125], v[60:61]
    v_pk_mul_f32 v[126:127], v[126:127], v[62:63]
    v_cvt_pk_bf16_f32 v112, v112, v113
    v_mfma_f32_16x16x32_bf16 a[36:39], a[140:143], a[176:179], a[36:39]
    v_cvt_pk_bf16_f32 v113, v114, v115
    v_cvt_pk_bf16_f32 v114, v116, v117
    v_cvt_pk_bf16_f32 v115, v118, v119
    buffer_store_dwordx4 v[112:115], v3, s[4:7], s70 offen offset:2048 sc1
    v_cvt_pk_bf16_f32 v120, v120, v121
    v_cvt_pk_bf16_f32 v121, v122, v123
    v_cvt_pk_bf16_f32 v122, v124, v125
    v_cvt_pk_bf16_f32 v123, v126, v127
    buffer_store_dwordx4 v[120:123], v3, s[4:7], s70 offen offset:3072 sc1
    s_add_u32 s70, s70, 8192
    v_pk_mul_f32 v[128:129], v[128:129], v[20:21] op_sel_hi:[1,0]
    v_pk_mul_f32 v[130:131], v[130:131], v[20:21] op_sel_hi:[1,0]
    v_pk_mul_f32 v[132:133], v[132:133], v[20:21] op_sel_hi:[1,0]
    v_pk_mul_f32 v[134:135], v[134:135], v[20:21] op_sel_hi:[1,0]
    v_pk_mul_f32 v[136:137], v[136:137], v[22:23] op_sel_hi:[1,0]
    v_pk_mul_f32 v[138:139], v[138:139], v[22:23] op_sel_hi:[1,0]
    v_pk_mul_f32 v[140:141], v[140:141], v[22:23] op_sel_hi:[1,0]
    v_pk_mul_f32 v[142:143], v[142:143], v[22:23] op_sel_hi:[1,0]
    v_accvgpr_read_b32 v32, a32
    v_accvgpr_read_b32 v33, a33
    s_waitcnt lgkmcnt(8)
    v_mfma_f32_16x16x32_bf16 v[160:163], a[144:147], a[192:195], v[160:163]
    ds_read_b64_tr_b16 a[140:141], v15 offset:16384
    v_accvgpr_read_b32 v34, a34
    v_accvgpr_read_b32 v35, a35
    v_mfma_f32_16x16x32_bf16 v[168:171], a[144:147], a[196:199], v[168:171]
    ds_read_b64_tr_b16 a[142:143], v15 offset:17408
    v_accvgpr_read_b32 v36, a36
    v_accvgpr_read_b32 v37, a37
    v_mfma_f32_16x16x32_bf16 v[176:179], a[144:147], a[200:203], v[176:179]
    v_accvgpr_read_b32 v38, a38
    v_accvgpr_read_b32 v39, a39
    v_accvgpr_read_b32 v40, a40
    v_accvgpr_read_b32 v41, a41
    v_mfma_f32_16x16x32_bf16 v[184:187], a[144:147], a[204:207], v[184:187]
    v_accvgpr_read_b32 v42, a42
    v_accvgpr_read_b32 v43, a43
    v_mfma_f32_16x16x32_bf16 v[188:191], a[148:151], a[204:207], v[188:191]
    ds_read_b64_tr_b16 a[144:145], v14 offset:28672
    v_accvgpr_read_b32 v44, a44
    v_accvgpr_read_b32 v45, a45
    v_mfma_f32_16x16x32_bf16 v[180:183], a[148:151], a[200:203], v[180:183]
    ds_read_b64_tr_b16 a[146:147], v14 offset:29696
    v_accvgpr_read_b32 v46, a46
    v_accvgpr_read_b32 v47, a47
    v_exp_f32 v128, v128
    v_mfma_f32_16x16x32_bf16 v[172:175], a[148:151], a[196:199], v[172:175]
    v_exp_f32 v129, v129
    v_mfma_f32_16x16x32_bf16 v[164:167], a[148:151], a[192:195], v[164:167]
    v_exp_f32 v130, v130
    v_mfma_f32_16x16x32_bf16 a[64:67], a[152:155], a[192:195], a[64:67]
    ds_read_b64_tr_b16 a[148:149], v15 offset:28672
    v_exp_f32 v131, v131
    v_exp_f32 v132, v132
    v_mfma_f32_16x16x32_bf16 a[72:75], a[152:155], a[196:199], a[72:75]
    ds_read_b64_tr_b16 a[150:151], v15 offset:29696
    v_exp_f32 v133, v133
    v_mfma_f32_16x16x32_bf16 a[80:83], a[152:155], a[200:203], a[80:83]
    v_exp_f32 v134, v134
    v_mfma_f32_16x16x32_bf16 a[88:91], a[152:155], a[204:207], a[88:91]
    v_exp_f32 v135, v135
    v_exp_f32 v136, v136
    v_mfma_f32_16x16x32_bf16 a[92:95], a[156:159], a[204:207], a[92:95]
    ds_read_b64_tr_b16 a[152:153], v14 offset:36864
    v_exp_f32 v137, v137
    v_mfma_f32_16x16x32_bf16 a[84:87], a[156:159], a[200:203], a[84:87]
    ds_read_b64_tr_b16 a[154:155], v14 offset:37888
    v_exp_f32 v138, v138
    v_exp_f32 v139, v139
    v_mfma_f32_16x16x32_bf16 a[76:79], a[156:159], a[196:199], a[76:79]
    v_exp_f32 v140, v140
    v_mfma_f32_16x16x32_bf16 a[68:71], a[156:159], a[192:195], a[68:71]
    v_exp_f32 v141, v141
    v_mfma_f32_16x16x32_bf16 v[160:163], a[96:99], a[240:243], v[160:163]
    ds_read_b64_tr_b16 a[156:157], v15 offset:36864
    v_exp_f32 v142, v142
    v_exp_f32 v143, v143
    v_pk_fma_f32 v[128:129], v[128:129], v[16:17], v[16:17] op_sel_hi:[1,0,0]
    v_pk_fma_f32 v[130:131], v[130:131], v[16:17], v[16:17] op_sel_hi:[1,0,0]
    v_pk_fma_f32 v[132:133], v[132:133], v[16:17], v[16:17] op_sel_hi:[1,0,0]
    v_pk_fma_f32 v[134:135], v[134:135], v[16:17], v[16:17] op_sel_hi:[1,0,0]
    v_pk_fma_f32 v[136:137], v[136:137], v[18:19], v[18:19] op_sel_hi:[1,0,0]
    v_pk_fma_f32 v[138:139], v[138:139], v[18:19], v[18:19] op_sel_hi:[1,0,0]
    v_pk_fma_f32 v[140:141], v[140:141], v[18:19], v[18:19] op_sel_hi:[1,0,0]
    v_pk_fma_f32 v[142:143], v[142:143], v[18:19], v[18:19] op_sel_hi:[1,0,0]
    v_rcp_f32 v128, v128
    v_rcp_f32 v129, v129
    v_mfma_f32_16x16x32_bf16 v[168:171], a[96:99], a[244:247], v[168:171]
    ds_read_b64_tr_b16 a[158:159], v15 offset:37888
    v_rcp_f32 v130, v130
    v_mfma_f32_16x16x32_bf16 v[176:179], a[96:99], a[248:251], v[176:179]
    v_rcp_f32 v131, v131
    v_mfma_f32_16x16x32_bf16 v[184:187], a[96:99], a[252:255], v[184:187]
    v_rcp_f32 v132, v132
    v_rcp_f32 v133, v133
    v_mfma_f32_16x16x4_4b_bf16 a[64:79], a[222:223], a[228:229], a[64:79]
    v_rcp_f32 v134, v134
    v_rcp_f32 v135, v135
    v_mfma_f32_16x16x32_bf16 v[188:191], a[100:103], a[252:255], v[188:191]
    v_rcp_f32 v136, v136
    v_rcp_f32 v137, v137
    v_mfma_f32_16x16x32_bf16 v[180:183], a[100:103], a[248:251], v[180:183]
    v_rcp_f32 v138, v138
    v_mfma_f32_16x16x32_bf16 v[172:175], a[100:103], a[244:247], v[172:175]
    v_rcp_f32 v139, v139
    v_mfma_f32_16x16x32_bf16 v[164:167], a[100:103], a[240:243], v[164:167]
    v_rcp_f32 v140, v140
    v_rcp_f32 v141, v141
    v_mfma_f32_16x16x32_bf16 a[64:67], a[104:107], a[240:243], a[64:67]
    v_rcp_f32 v142, v142
    v_rcp_f32 v143, v143
    v_pk_mul_f32 v[128:129], v[128:129], v[32:33]
    v_pk_mul_f32 v[130:131], v[130:131], v[34:35]
    v_pk_mul_f32 v[132:133], v[132:133], v[36:37]
    v_pk_mul_f32 v[134:135], v[134:135], v[38:39]
    v_pk_mul_f32 v[136:137], v[136:137], v[40:41]
    v_pk_mul_f32 v[138:139], v[138:139], v[42:43]
    v_pk_mul_f32 v[140:141], v[140:141], v[44:45]
    v_pk_mul_f32 v[142:143], v[142:143], v[46:47]
    v_cvt_pk_bf16_f32 v128, v128, v129
    v_mfma_f32_16x16x32_bf16 a[72:75], a[104:107], a[244:247], a[72:75]
    v_cvt_pk_bf16_f32 v129, v130, v131
    v_cvt_pk_bf16_f32 v130, v132, v133
    v_cvt_pk_bf16_f32 v131, v134, v135
    buffer_store_dwordx4 v[128:131], v3, s[4:7], s70 offen offset:0 sc1
    v_cvt_pk_bf16_f32 v136, v136, v137
    v_cvt_pk_bf16_f32 v137, v138, v139
    v_cvt_pk_bf16_f32 v138, v140, v141
    v_cvt_pk_bf16_f32 v139, v142, v143
    buffer_store_dwordx4 v[136:139], v3, s[4:7], s70 offen offset:1024 sc1
    v_pk_mul_f32 v[144:145], v[144:145], v[24:25] op_sel_hi:[1,0]
    v_pk_mul_f32 v[146:147], v[146:147], v[24:25] op_sel_hi:[1,0]
    v_pk_mul_f32 v[148:149], v[148:149], v[24:25] op_sel_hi:[1,0]
    v_pk_mul_f32 v[150:151], v[150:151], v[24:25] op_sel_hi:[1,0]
    v_pk_mul_f32 v[152:153], v[152:153], v[26:27] op_sel_hi:[1,0]
    v_pk_mul_f32 v[154:155], v[154:155], v[26:27] op_sel_hi:[1,0]
    v_pk_mul_f32 v[156:157], v[156:157], v[26:27] op_sel_hi:[1,0]
    v_pk_mul_f32 v[158:159], v[158:159], v[26:27] op_sel_hi:[1,0]
    v_accvgpr_read_b32 v48, a48
    v_accvgpr_read_b32 v49, a49
    v_mfma_f32_16x16x32_bf16 a[80:83], a[104:107], a[248:251], a[80:83]
    v_accvgpr_read_b32 v50, a50
    v_accvgpr_read_b32 v51, a51
    v_mfma_f32_16x16x32_bf16 a[88:91], a[104:107], a[252:255], a[88:91]
    v_accvgpr_read_b32 v52, a52
    v_accvgpr_read_b32 v53, a53
    v_mfma_f32_16x16x4_4b_bf16 v[160:175], a[220:221], a[228:229], v[160:175]
    v_accvgpr_read_b32 v54, a54
    v_accvgpr_read_b32 v55, a55
    v_accvgpr_read_b32 v56, a56
    v_accvgpr_read_b32 v57, a57
    v_accvgpr_read_b32 v58, a58
    v_accvgpr_read_b32 v59, a59
    v_mfma_f32_16x16x32_bf16 a[92:95], a[108:111], a[252:255], a[92:95]
    v_accvgpr_read_b32 v60, a60
    v_accvgpr_read_b32 v61, a61
    v_mfma_f32_16x16x32_bf16 a[84:87], a[108:111], a[248:251], a[84:87]
    v_accvgpr_read_b32 v62, a62
    v_accvgpr_read_b32 v63, a63
    v_exp_f32 v144, v144
    v_mfma_f32_16x16x32_bf16 a[76:79], a[108:111], a[244:247], a[76:79]
    v_exp_f32 v145, v145
    v_mfma_f32_16x16x32_bf16 a[68:71], a[108:111], a[240:243], a[68:71]
    v_exp_f32 v146, v146
    v_mfma_f32_16x16x32_bf16 v[160:163], a[112:115], a[176:179], v[160:163]
    v_exp_f32 v147, v147
    v_exp_f32 v148, v148
    v_mfma_f32_16x16x32_bf16 v[168:171], a[112:115], a[180:183], v[168:171]
    v_exp_f32 v149, v149
    v_mfma_f32_16x16x32_bf16 v[176:179], a[112:115], a[184:187], v[176:179]
    v_exp_f32 v150, v150
    v_mfma_f32_16x16x32_bf16 v[184:187], a[112:115], a[188:191], v[184:187]
    v_exp_f32 v151, v151
    v_exp_f32 v152, v152
    v_mfma_f32_16x16x4_4b_bf16 a[80:95], a[222:223], a[230:231], a[80:95]
    v_exp_f32 v153, v153
    v_exp_f32 v154, v154
    v_exp_f32 v155, v155
    v_mfma_f32_16x16x32_bf16 v[188:191], a[116:119], a[188:191], v[188:191]
    v_exp_f32 v156, v156
    v_mfma_f32_16x16x32_bf16 v[180:183], a[116:119], a[184:187], v[180:183]
    v_exp_f32 v157, v157
    v_mfma_f32_16x16x32_bf16 v[172:175], a[116:119], a[180:183], v[172:175]
    v_exp_f32 v158, v158
    v_exp_f32 v159, v159
    v_pk_fma_f32 v[144:145], v[144:145], v[4:5], v[4:5] op_sel_hi:[1,0,0]
    v_pk_fma_f32 v[146:147], v[146:147], v[4:5], v[4:5] op_sel_hi:[1,0,0]
    v_pk_fma_f32 v[148:149], v[148:149], v[4:5], v[4:5] op_sel_hi:[1,0,0]
    v_pk_fma_f32 v[150:151], v[150:151], v[4:5], v[4:5] op_sel_hi:[1,0,0]
    v_pk_fma_f32 v[152:153], v[152:153], v[6:7], v[6:7] op_sel_hi:[1,0,0]
    v_pk_fma_f32 v[154:155], v[154:155], v[6:7], v[6:7] op_sel_hi:[1,0,0]
    v_pk_fma_f32 v[156:157], v[156:157], v[6:7], v[6:7] op_sel_hi:[1,0,0]
    v_pk_fma_f32 v[158:159], v[158:159], v[6:7], v[6:7] op_sel_hi:[1,0,0]
    v_rcp_f32 v144, v144
    v_rcp_f32 v145, v145
    v_mfma_f32_16x16x32_bf16 v[164:167], a[116:119], a[176:179], v[164:167]
    v_rcp_f32 v146, v146
    v_mfma_f32_16x16x32_bf16 a[64:67], a[120:123], a[176:179], a[64:67]
    v_rcp_f32 v147, v147
    v_mfma_f32_16x16x32_bf16 a[72:75], a[120:123], a[180:183], a[72:75]
    v_rcp_f32 v148, v148
    v_rcp_f32 v149, v149
    v_mfma_f32_16x16x32_bf16 a[80:83], a[120:123], a[184:187], a[80:83]
    v_rcp_f32 v150, v150
    v_mfma_f32_16x16x32_bf16 a[88:91], a[120:123], a[188:191], a[88:91]
    v_rcp_f32 v151, v151
    v_mfma_f32_16x16x4_4b_bf16 v[176:191], a[220:221], a[230:231], v[176:191]
    v_rcp_f32 v152, v152
    v_rcp_f32 v153, v153
    v_rcp_f32 v154, v154
    v_mfma_f32_16x16x32_bf16 a[92:95], a[124:127], a[188:191], a[92:95]
    v_rcp_f32 v155, v155
    v_mfma_f32_16x16x32_bf16 a[84:87], a[124:127], a[184:187], a[84:87]
    v_rcp_f32 v156, v156
    v_rcp_f32 v157, v157
    v_mfma_f32_16x16x32_bf16 a[76:79], a[124:127], a[180:183], a[76:79]
    v_rcp_f32 v158, v158
    v_rcp_f32 v159, v159
    v_pk_mul_f32 v[144:145], v[144:145], v[48:49]
    v_pk_mul_f32 v[146:147], v[146:147], v[50:51]
    v_pk_mul_f32 v[148:149], v[148:149], v[52:53]
    v_pk_mul_f32 v[150:151], v[150:151], v[54:55]
    v_pk_mul_f32 v[152:153], v[152:153], v[56:57]
    v_pk_mul_f32 v[154:155], v[154:155], v[58:59]
    v_pk_mul_f32 v[156:157], v[156:157], v[60:61]
    v_pk_mul_f32 v[158:159], v[158:159], v[62:63]
    v_cvt_pk_bf16_f32 v144, v144, v145
    v_mfma_f32_16x16x32_bf16 a[68:71], a[124:127], a[176:179], a[68:71]
    v_cvt_pk_bf16_f32 v145, v146, v147
    v_cvt_pk_bf16_f32 v146, v148, v149
    v_cvt_pk_bf16_f32 v147, v150, v151
    buffer_store_dwordx4 v[144:147], v3, s[4:7], s70 offen offset:2048 sc1
    v_cvt_pk_bf16_f32 v152, v152, v153
    v_cvt_pk_bf16_f32 v153, v154, v155
    v_cvt_pk_bf16_f32 v154, v156, v157
    v_cvt_pk_bf16_f32 v155, v158, v159
    buffer_store_dwordx4 v[152:155], v3, s[4:7], s70 offen offset:3072 sc1
    s_add_u32 s70, s70, 8192
    v_pk_mul_f32 v[160:161], v[160:161], v[20:21] op_sel_hi:[1,0]
    v_pk_mul_f32 v[162:163], v[162:163], v[20:21] op_sel_hi:[1,0]
    v_pk_mul_f32 v[164:165], v[164:165], v[20:21] op_sel_hi:[1,0]
    v_pk_mul_f32 v[166:167], v[166:167], v[20:21] op_sel_hi:[1,0]
    v_pk_mul_f32 v[168:169], v[168:169], v[22:23] op_sel_hi:[1,0]
    v_pk_mul_f32 v[170:171], v[170:171], v[22:23] op_sel_hi:[1,0]
    v_pk_mul_f32 v[172:173], v[172:173], v[22:23] op_sel_hi:[1,0]
    v_pk_mul_f32 v[174:175], v[174:175], v[22:23] op_sel_hi:[1,0]
    v_accvgpr_read_b32 v32, a64
    v_accvgpr_read_b32 v33, a65
    v_mfma_f32_16x16x32_bf16 v[192:195], a[160:163], a[192:195], v[192:195]
    v_accvgpr_read_b32 v34, a66
    v_accvgpr_read_b32 v35, a67
    v_mfma_f32_16x16x32_bf16 v[200:203], a[160:163], a[196:199], v[200:203]
    v_accvgpr_read_b32 v36, a68
    v_accvgpr_read_b32 v37, a69
    v_mfma_f32_16x16x32_bf16 v[208:211], a[160:163], a[200:203], v[208:211]
    v_accvgpr_read_b32 v38, a70
    v_accvgpr_read_b32 v39, a71
    v_accvgpr_read_b32 v40, a72
    v_accvgpr_read_b32 v41, a73
    v_mfma_f32_16x16x32_bf16 v[216:219], a[160:163], a[204:207], v[216:219]
    v_accvgpr_read_b32 v42, a74
    v_accvgpr_read_b32 v43, a75
    v_mfma_f32_16x16x32_bf16 v[220:223], a[164:167], a[204:207], v[220:223]
    v_accvgpr_read_b32 v44, a76
    v_accvgpr_read_b32 v45, a77
    v_mfma_f32_16x16x32_bf16 v[212:215], a[164:167], a[200:203], v[212:215]
    v_accvgpr_read_b32 v46, a78
    v_accvgpr_read_b32 v47, a79
    v_exp_f32 v160, v160
    v_mfma_f32_16x16x32_bf16 v[204:207], a[164:167], a[196:199], v[204:207]
    v_exp_f32 v161, v161
    v_mfma_f32_16x16x32_bf16 v[196:199], a[164:167], a[192:195], v[196:199]
    v_exp_f32 v162, v162
    v_mfma_f32_16x16x32_bf16 v[224:227], a[168:171], a[192:195], v[224:227]
    v_exp_f32 v163, v163
    v_exp_f32 v164, v164
    v_mfma_f32_16x16x32_bf16 v[232:235], a[168:171], a[196:199], v[232:235]
    v_exp_f32 v165, v165
    v_mfma_f32_16x16x32_bf16 v[240:243], a[168:171], a[200:203], v[240:243]
    v_exp_f32 v166, v166
    v_mfma_f32_16x16x32_bf16 v[248:251], a[168:171], a[204:207], v[248:251]
    v_exp_f32 v167, v167
    v_exp_f32 v168, v168
    s_waitcnt lgkmcnt(8)
    v_mfma_f32_16x16x32_bf16 v[252:255], a[172:175], a[204:207], v[252:255]
    v_exp_f32 v169, v169
    v_mfma_f32_16x16x32_bf16 v[244:247], a[172:175], a[200:203], v[244:247]
    v_exp_f32 v170, v170
    v_exp_f32 v171, v171
    v_mfma_f32_16x16x32_bf16 v[236:239], a[172:175], a[196:199], v[236:239]
    v_exp_f32 v172, v172
    v_mfma_f32_16x16x32_bf16 v[228:231], a[172:175], a[192:195], v[228:231]
    v_exp_f32 v173, v173
    v_mfma_f32_16x16x32_bf16 v[192:195], a[128:131], a[240:243], v[192:195]
    v_exp_f32 v174, v174
    v_exp_f32 v175, v175
    v_pk_fma_f32 v[160:161], v[160:161], v[16:17], v[16:17] op_sel_hi:[1,0,0]
    v_pk_fma_f32 v[162:163], v[162:163], v[16:17], v[16:17] op_sel_hi:[1,0,0]
    v_pk_fma_f32 v[164:165], v[164:165], v[16:17], v[16:17] op_sel_hi:[1,0,0]
    v_pk_fma_f32 v[166:167], v[166:167], v[16:17], v[16:17] op_sel_hi:[1,0,0]
    v_pk_fma_f32 v[168:169], v[168:169], v[18:19], v[18:19] op_sel_hi:[1,0,0]
    v_pk_fma_f32 v[170:171], v[170:171], v[18:19], v[18:19] op_sel_hi:[1,0,0]
    v_pk_fma_f32 v[172:173], v[172:173], v[18:19], v[18:19] op_sel_hi:[1,0,0]
    v_pk_fma_f32 v[174:175], v[174:175], v[18:19], v[18:19] op_sel_hi:[1,0,0]
    v_rcp_f32 v160, v160
    v_rcp_f32 v161, v161
    v_mfma_f32_16x16x32_bf16 v[200:203], a[128:131], a[244:247], v[200:203]
    v_rcp_f32 v162, v162
    v_mfma_f32_16x16x32_bf16 v[208:211], a[128:131], a[248:251], v[208:211]
    v_rcp_f32 v163, v163
    v_mfma_f32_16x16x32_bf16 v[216:219], a[128:131], a[252:255], v[216:219]
    v_rcp_f32 v164, v164
    v_rcp_f32 v165, v165
    v_mfma_f32_16x16x4_4b_bf16 v[224:239], a[226:227], a[228:229], v[224:239]
    v_rcp_f32 v166, v166
    v_rcp_f32 v167, v167
    v_mfma_f32_16x16x32_bf16 v[220:223], a[132:135], a[252:255], v[220:223]
    v_rcp_f32 v168, v168
    v_rcp_f32 v169, v169
    v_mfma_f32_16x16x32_bf16 v[212:215], a[132:135], a[248:251], v[212:215]
    v_rcp_f32 v170, v170
    v_mfma_f32_16x16x32_bf16 v[204:207], a[132:135], a[244:247], v[204:207]
    v_rcp_f32 v171, v171
    v_mfma_f32_16x16x32_bf16 v[196:199], a[132:135], a[240:243], v[196:199]
    v_rcp_f32 v172, v172
    v_rcp_f32 v173, v173
    v_mfma_f32_16x16x32_bf16 v[224:227], a[136:139], a[240:243], v[224:227]
    v_rcp_f32 v174, v174
    v_rcp_f32 v175, v175
    v_pk_mul_f32 v[160:161], v[160:161], v[32:33]
    v_pk_mul_f32 v[162:163], v[162:163], v[34:35]
    v_pk_mul_f32 v[164:165], v[164:165], v[36:37]
    v_pk_mul_f32 v[166:167], v[166:167], v[38:39]
    v_pk_mul_f32 v[168:169], v[168:169], v[40:41]
    v_pk_mul_f32 v[170:171], v[170:171], v[42:43]
    v_pk_mul_f32 v[172:173], v[172:173], v[44:45]
    v_pk_mul_f32 v[174:175], v[174:175], v[46:47]
    v_cvt_pk_bf16_f32 v160, v160, v161
    v_mfma_f32_16x16x32_bf16 v[232:235], a[136:139], a[244:247], v[232:235]
    v_cvt_pk_bf16_f32 v161, v162, v163
    v_cvt_pk_bf16_f32 v162, v164, v165
    v_cvt_pk_bf16_f32 v163, v166, v167
    buffer_store_dwordx4 v[160:163], v3, s[4:7], s70 offen offset:0 sc1
    v_cvt_pk_bf16_f32 v168, v168, v169
    v_cvt_pk_bf16_f32 v169, v170, v171
    v_cvt_pk_bf16_f32 v170, v172, v173
    v_cvt_pk_bf16_f32 v171, v174, v175
    buffer_store_dwordx4 v[168:171], v3, s[4:7], s70 offen offset:1024 sc1
    v_pk_mul_f32 v[176:177], v[176:177], v[24:25] op_sel_hi:[1,0]
    v_pk_mul_f32 v[178:179], v[178:179], v[24:25] op_sel_hi:[1,0]
    v_pk_mul_f32 v[180:181], v[180:181], v[24:25] op_sel_hi:[1,0]
    v_pk_mul_f32 v[182:183], v[182:183], v[24:25] op_sel_hi:[1,0]
    v_pk_mul_f32 v[184:185], v[184:185], v[26:27] op_sel_hi:[1,0]
    v_pk_mul_f32 v[186:187], v[186:187], v[26:27] op_sel_hi:[1,0]
    v_pk_mul_f32 v[188:189], v[188:189], v[26:27] op_sel_hi:[1,0]
    v_pk_mul_f32 v[190:191], v[190:191], v[26:27] op_sel_hi:[1,0]
    v_accvgpr_read_b32 v48, a80
    v_accvgpr_read_b32 v49, a81
    v_mfma_f32_16x16x32_bf16 v[240:243], a[136:139], a[248:251], v[240:243]
    v_accvgpr_read_b32 v50, a82
    v_accvgpr_read_b32 v51, a83
    v_mfma_f32_16x16x32_bf16 v[248:251], a[136:139], a[252:255], v[248:251]
    v_accvgpr_read_b32 v52, a84
    v_accvgpr_read_b32 v53, a85
    v_mfma_f32_16x16x4_4b_bf16 v[192:207], a[224:225], a[228:229], v[192:207]
    v_accvgpr_read_b32 v54, a86
    v_accvgpr_read_b32 v55, a87
    v_accvgpr_read_b32 v56, a88
    v_accvgpr_read_b32 v57, a89
    v_accvgpr_read_b32 v58, a90
    v_accvgpr_read_b32 v59, a91
    v_mfma_f32_16x16x32_bf16 v[252:255], a[140:143], a[252:255], v[252:255]
    v_accvgpr_read_b32 v60, a92
    v_accvgpr_read_b32 v61, a93
    v_mfma_f32_16x16x32_bf16 v[244:247], a[140:143], a[248:251], v[244:247]
    v_accvgpr_read_b32 v62, a94
    v_accvgpr_read_b32 v63, a95
    v_exp_f32 v176, v176
    v_mfma_f32_16x16x32_bf16 v[236:239], a[140:143], a[244:247], v[236:239]
    v_exp_f32 v177, v177
    v_mfma_f32_16x16x32_bf16 v[228:231], a[140:143], a[240:243], v[228:231]
    v_exp_f32 v178, v178
    s_waitcnt lgkmcnt(6)
    v_mfma_f32_16x16x32_bf16 v[192:195], a[144:147], a[176:179], v[192:195]
    v_exp_f32 v179, v179
    v_exp_f32 v180, v180
    v_mfma_f32_16x16x32_bf16 v[200:203], a[144:147], a[180:183], v[200:203]
    v_exp_f32 v181, v181
    v_mfma_f32_16x16x32_bf16 v[208:211], a[144:147], a[184:187], v[208:211]
    v_exp_f32 v182, v182
    v_mfma_f32_16x16x32_bf16 v[216:219], a[144:147], a[188:191], v[216:219]
    v_exp_f32 v183, v183
    v_exp_f32 v184, v184
    v_mfma_f32_16x16x4_4b_bf16 v[240:255], a[226:227], a[230:231], v[240:255]
    v_exp_f32 v185, v185
    v_exp_f32 v186, v186
    v_exp_f32 v187, v187
    s_waitcnt lgkmcnt(4)
    v_mfma_f32_16x16x32_bf16 v[220:223], a[148:151], a[188:191], v[220:223]
    v_exp_f32 v188, v188
    v_mfma_f32_16x16x32_bf16 v[212:215], a[148:151], a[184:187], v[212:215]
    v_exp_f32 v189, v189
    v_mfma_f32_16x16x32_bf16 v[204:207], a[148:151], a[180:183], v[204:207]
    v_exp_f32 v190, v190
    v_exp_f32 v191, v191
    v_pk_fma_f32 v[176:177], v[176:177], v[4:5], v[4:5] op_sel_hi:[1,0,0]
    v_pk_fma_f32 v[178:179], v[178:179], v[4:5], v[4:5] op_sel_hi:[1,0,0]
    v_pk_fma_f32 v[180:181], v[180:181], v[4:5], v[4:5] op_sel_hi:[1,0,0]
    v_pk_fma_f32 v[182:183], v[182:183], v[4:5], v[4:5] op_sel_hi:[1,0,0]
    v_pk_fma_f32 v[184:185], v[184:185], v[6:7], v[6:7] op_sel_hi:[1,0,0]
    v_pk_fma_f32 v[186:187], v[186:187], v[6:7], v[6:7] op_sel_hi:[1,0,0]
    v_pk_fma_f32 v[188:189], v[188:189], v[6:7], v[6:7] op_sel_hi:[1,0,0]
    v_pk_fma_f32 v[190:191], v[190:191], v[6:7], v[6:7] op_sel_hi:[1,0,0]
    v_rcp_f32 v176, v176
    v_rcp_f32 v177, v177
    v_mfma_f32_16x16x32_bf16 v[196:199], a[148:151], a[176:179], v[196:199]
    v_rcp_f32 v178, v178
    s_waitcnt lgkmcnt(2)
    v_mfma_f32_16x16x32_bf16 v[224:227], a[152:155], a[176:179], v[224:227]
    v_rcp_f32 v179, v179
    v_mfma_f32_16x16x32_bf16 v[232:235], a[152:155], a[180:183], v[232:235]
    v_rcp_f32 v180, v180
    v_rcp_f32 v181, v181
    v_mfma_f32_16x16x32_bf16 v[240:243], a[152:155], a[184:187], v[240:243]
    v_rcp_f32 v182, v182
    v_mfma_f32_16x16x32_bf16 v[248:251], a[152:155], a[188:191], v[248:251]
    v_rcp_f32 v183, v183
    v_mfma_f32_16x16x4_4b_bf16 v[208:223], a[224:225], a[230:231], v[208:223]
    v_rcp_f32 v184, v184
    v_rcp_f32 v185, v185
    v_rcp_f32 v186, v186
    s_waitcnt lgkmcnt(0)
    v_mfma_f32_16x16x32_bf16 v[252:255], a[156:159], a[188:191], v[252:255]
    v_rcp_f32 v187, v187
    v_mfma_f32_16x16x32_bf16 v[244:247], a[156:159], a[184:187], v[244:247]
    v_rcp_f32 v188, v188
    v_rcp_f32 v189, v189
    v_mfma_f32_16x16x32_bf16 v[236:239], a[156:159], a[180:183], v[236:239]
    v_rcp_f32 v190, v190
    v_rcp_f32 v191, v191
    v_pk_mul_f32 v[176:177], v[176:177], v[48:49]
    v_pk_mul_f32 v[178:179], v[178:179], v[50:51]
    v_pk_mul_f32 v[180:181], v[180:181], v[52:53]
    v_pk_mul_f32 v[182:183], v[182:183], v[54:55]
    v_pk_mul_f32 v[184:185], v[184:185], v[56:57]
    v_pk_mul_f32 v[186:187], v[186:187], v[58:59]
    v_pk_mul_f32 v[188:189], v[188:189], v[60:61]
    v_pk_mul_f32 v[190:191], v[190:191], v[62:63]
    v_cvt_pk_bf16_f32 v176, v176, v177
    v_mfma_f32_16x16x32_bf16 v[228:231], a[156:159], a[176:179], v[228:231]
    v_cvt_pk_bf16_f32 v177, v178, v179
    v_cvt_pk_bf16_f32 v178, v180, v181
    v_cvt_pk_bf16_f32 v179, v182, v183
    buffer_store_dwordx4 v[176:179], v3, s[4:7], s70 offen offset:2048 sc1
    v_cvt_pk_bf16_f32 v184, v184, v185
    v_cvt_pk_bf16_f32 v185, v186, v187
    v_cvt_pk_bf16_f32 v186, v188, v189
    v_cvt_pk_bf16_f32 v187, v190, v191
    buffer_store_dwordx4 v[184:187], v3, s[4:7], s70 offen offset:3072 sc1
    s_add_u32 s70, s70, 8192
    v_pk_mul_f32 v[192:193], v[192:193], v[20:21] op_sel_hi:[1,0]
    v_pk_mul_f32 v[194:195], v[194:195], v[20:21] op_sel_hi:[1,0]
    v_pk_mul_f32 v[196:197], v[196:197], v[20:21] op_sel_hi:[1,0]
    v_pk_mul_f32 v[198:199], v[198:199], v[20:21] op_sel_hi:[1,0]
    v_pk_mul_f32 v[200:201], v[200:201], v[22:23] op_sel_hi:[1,0]
    v_pk_mul_f32 v[202:203], v[202:203], v[22:23] op_sel_hi:[1,0]
    v_pk_mul_f32 v[204:205], v[204:205], v[22:23] op_sel_hi:[1,0]
    v_pk_mul_f32 v[206:207], v[206:207], v[22:23] op_sel_hi:[1,0]
    v_exp_f32 v192, v192
    v_exp_f32 v193, v193
    v_exp_f32 v194, v194
    v_exp_f32 v195, v195
    v_exp_f32 v196, v196
    v_exp_f32 v197, v197
    v_exp_f32 v198, v198
    v_exp_f32 v199, v199
    v_exp_f32 v200, v200
    v_exp_f32 v201, v201
    v_exp_f32 v202, v202
    v_exp_f32 v203, v203
    v_exp_f32 v204, v204
    v_exp_f32 v205, v205
    v_exp_f32 v206, v206
    v_exp_f32 v207, v207
    v_pk_fma_f32 v[192:193], v[192:193], v[16:17], v[16:17] op_sel_hi:[1,0,0]
    v_pk_fma_f32 v[194:195], v[194:195], v[16:17], v[16:17] op_sel_hi:[1,0,0]
    v_pk_fma_f32 v[196:197], v[196:197], v[16:17], v[16:17] op_sel_hi:[1,0,0]
    v_pk_fma_f32 v[198:199], v[198:199], v[16:17], v[16:17] op_sel_hi:[1,0,0]
    v_pk_fma_f32 v[200:201], v[200:201], v[18:19], v[18:19] op_sel_hi:[1,0,0]
    v_pk_fma_f32 v[202:203], v[202:203], v[18:19], v[18:19] op_sel_hi:[1,0,0]
    v_pk_fma_f32 v[204:205], v[204:205], v[18:19], v[18:19] op_sel_hi:[1,0,0]
    v_pk_fma_f32 v[206:207], v[206:207], v[18:19], v[18:19] op_sel_hi:[1,0,0]
    v_rcp_f32 v192, v192
    v_rcp_f32 v193, v193
    v_rcp_f32 v194, v194
    v_rcp_f32 v195, v195
    v_rcp_f32 v196, v196
    v_rcp_f32 v197, v197
    v_rcp_f32 v198, v198
    v_rcp_f32 v199, v199
    v_rcp_f32 v200, v200
    v_rcp_f32 v201, v201
    v_rcp_f32 v202, v202
    v_rcp_f32 v203, v203
    v_rcp_f32 v204, v204
    v_rcp_f32 v205, v205
    v_rcp_f32 v206, v206
    v_rcp_f32 v207, v207
    v_pk_mul_f32 v[192:193], v[192:193], v[224:225]
    v_pk_mul_f32 v[194:195], v[194:195], v[226:227]
    v_pk_mul_f32 v[196:197], v[196:197], v[228:229]
    v_pk_mul_f32 v[198:199], v[198:199], v[230:231]
    v_pk_mul_f32 v[200:201], v[200:201], v[232:233]
    v_pk_mul_f32 v[202:203], v[202:203], v[234:235]
    v_pk_mul_f32 v[204:205], v[204:205], v[236:237]
    v_pk_mul_f32 v[206:207], v[206:207], v[238:239]
    v_cvt_pk_bf16_f32 v192, v192, v193
    v_cvt_pk_bf16_f32 v193, v194, v195
    v_cvt_pk_bf16_f32 v194, v196, v197
    v_cvt_pk_bf16_f32 v195, v198, v199
    buffer_store_dwordx4 v[192:195], v3, s[4:7], s70 offen offset:0 sc1
    v_cvt_pk_bf16_f32 v200, v200, v201
    v_cvt_pk_bf16_f32 v201, v202, v203
    v_cvt_pk_bf16_f32 v202, v204, v205
    v_cvt_pk_bf16_f32 v203, v206, v207
    buffer_store_dwordx4 v[200:203], v3, s[4:7], s70 offen offset:1024 sc1
    v_pk_mul_f32 v[208:209], v[208:209], v[24:25] op_sel_hi:[1,0]
    v_pk_mul_f32 v[210:211], v[210:211], v[24:25] op_sel_hi:[1,0]
    v_pk_mul_f32 v[212:213], v[212:213], v[24:25] op_sel_hi:[1,0]
    v_pk_mul_f32 v[214:215], v[214:215], v[24:25] op_sel_hi:[1,0]
    v_pk_mul_f32 v[216:217], v[216:217], v[26:27] op_sel_hi:[1,0]
    v_pk_mul_f32 v[218:219], v[218:219], v[26:27] op_sel_hi:[1,0]
    v_pk_mul_f32 v[220:221], v[220:221], v[26:27] op_sel_hi:[1,0]
    v_pk_mul_f32 v[222:223], v[222:223], v[26:27] op_sel_hi:[1,0]
    v_exp_f32 v208, v208
    v_exp_f32 v209, v209
    v_exp_f32 v210, v210
    v_exp_f32 v211, v211
    v_exp_f32 v212, v212
    v_exp_f32 v213, v213
    v_exp_f32 v214, v214
    v_exp_f32 v215, v215
    v_exp_f32 v216, v216
    v_exp_f32 v217, v217
    v_exp_f32 v218, v218
    v_exp_f32 v219, v219
    v_exp_f32 v220, v220
    v_exp_f32 v221, v221
    v_exp_f32 v222, v222
    v_exp_f32 v223, v223
    v_pk_fma_f32 v[208:209], v[208:209], v[4:5], v[4:5] op_sel_hi:[1,0,0]
    v_pk_fma_f32 v[210:211], v[210:211], v[4:5], v[4:5] op_sel_hi:[1,0,0]
    v_pk_fma_f32 v[212:213], v[212:213], v[4:5], v[4:5] op_sel_hi:[1,0,0]
    v_pk_fma_f32 v[214:215], v[214:215], v[4:5], v[4:5] op_sel_hi:[1,0,0]
    v_pk_fma_f32 v[216:217], v[216:217], v[6:7], v[6:7] op_sel_hi:[1,0,0]
    v_pk_fma_f32 v[218:219], v[218:219], v[6:7], v[6:7] op_sel_hi:[1,0,0]
    v_pk_fma_f32 v[220:221], v[220:221], v[6:7], v[6:7] op_sel_hi:[1,0,0]
    v_pk_fma_f32 v[222:223], v[222:223], v[6:7], v[6:7] op_sel_hi:[1,0,0]
    v_rcp_f32 v208, v208
    v_rcp_f32 v209, v209
    v_rcp_f32 v210, v210
    v_rcp_f32 v211, v211
    v_rcp_f32 v212, v212
    v_rcp_f32 v213, v213
    v_rcp_f32 v214, v214
    v_rcp_f32 v215, v215
    v_rcp_f32 v216, v216
    v_rcp_f32 v217, v217
    v_rcp_f32 v218, v218
    v_rcp_f32 v219, v219
    v_rcp_f32 v220, v220
    v_rcp_f32 v221, v221
    v_rcp_f32 v222, v222
    v_rcp_f32 v223, v223
    v_pk_mul_f32 v[208:209], v[208:209], v[240:241]
    v_pk_mul_f32 v[210:211], v[210:211], v[242:243]
    v_pk_mul_f32 v[212:213], v[212:213], v[244:245]
    v_pk_mul_f32 v[214:215], v[214:215], v[246:247]
    v_pk_mul_f32 v[216:217], v[216:217], v[248:249]
    v_pk_mul_f32 v[218:219], v[218:219], v[250:251]
    v_pk_mul_f32 v[220:221], v[220:221], v[252:253]
    v_pk_mul_f32 v[222:223], v[222:223], v[254:255]
    v_cvt_pk_bf16_f32 v208, v208, v209
    v_cvt_pk_bf16_f32 v209, v210, v211
    v_cvt_pk_bf16_f32 v210, v212, v213
    v_cvt_pk_bf16_f32 v211, v214, v215
    buffer_store_dwordx4 v[208:211], v3, s[4:7], s70 offen offset:2048 sc1
    v_cvt_pk_bf16_f32 v216, v216, v217
    v_cvt_pk_bf16_f32 v217, v218, v219
    v_cvt_pk_bf16_f32 v218, v220, v221
    v_cvt_pk_bf16_f32 v219, v222, v223
    buffer_store_dwordx4 v[216:219], v3, s[4:7], s70 offen offset:3072 sc1
    s_endpgm
L_cs1_0:
    s_waitcnt lgkmcnt(0)
    s_cmp_lg_u32 s28, 0
    s_cbranch_scc1 L_cs1_0_1
    v_mfma_f32_16x16x32_bf16 a[208:211], a[96:99], v[28:31], a[208:211]
    v_mfma_f32_16x16x32_bf16 a[212:215], a[100:103], v[28:31], a[212:215]
    v_mfma_f32_16x16x32_bf16 a[216:219], a[104:107], v[28:31], a[216:219]
    v_mfma_f32_16x16x32_bf16 a[220:223], a[108:111], v[28:31], a[220:223]
    v_mfma_f32_16x16x32_bf16 a[224:227], a[112:115], v[28:31], a[224:227]
    s_branch L_csr1_0
L_cs1_0_1:
    s_cmp_lg_u32 s28, 1
    s_cbranch_scc1 L_cs1_0_2
    v_mfma_f32_16x16x32_bf16 a[208:211], a[116:119], v[28:31], a[208:211]
    v_mfma_f32_16x16x32_bf16 a[212:215], a[120:123], v[28:31], a[212:215]
    v_mfma_f32_16x16x32_bf16 a[216:219], a[124:127], v[28:31], a[216:219]
    v_mfma_f32_16x16x32_bf16 a[220:223], a[128:131], v[28:31], a[220:223]
    v_mfma_f32_16x16x32_bf16 a[224:227], a[132:135], v[28:31], a[224:227]
    s_branch L_csr1_0
L_cs1_0_2:
    s_cmp_lg_u32 s28, 2
    s_cbranch_scc1 L_cs1_0_3
    v_mfma_f32_16x16x32_bf16 a[208:211], a[136:139], v[28:31], a[208:211]
    v_mfma_f32_16x16x32_bf16 a[212:215], a[140:143], v[28:31], a[212:215]
    v_mfma_f32_16x16x32_bf16 a[216:219], a[144:147], v[28:31], a[216:219]
    v_mfma_f32_16x16x32_bf16 a[220:223], a[148:151], v[28:31], a[220:223]
    v_mfma_f32_16x16x32_bf16 a[224:227], a[152:155], v[28:31], a[224:227]
    s_branch L_csr1_0
L_cs1_0_3:
    v_mfma_f32_16x16x32_bf16 a[208:211], a[156:159], v[28:31], a[208:211]
    v_mfma_f32_16x16x32_bf16 a[212:215], a[160:163], v[28:31], a[212:215]
    v_mfma_f32_16x16x32_bf16 a[216:219], a[164:167], v[28:31], a[216:219]
    v_mfma_f32_16x16x32_bf16 a[220:223], a[168:171], v[28:31], a[220:223]
    v_mfma_f32_16x16x32_bf16 a[224:227], a[172:175], v[28:31], a[224:227]
    s_branch L_csr1_0
L_cs1_1:
    s_waitcnt lgkmcnt(0)
    s_cmp_lg_u32 s28, 0
    s_cbranch_scc1 L_cs1_1_1
    v_mfma_f32_16x16x32_bf16 a[208:211], a[96:99], v[28:31], a[208:211]
    v_mfma_f32_16x16x32_bf16 a[212:215], a[100:103], v[28:31], a[212:215]
    v_mfma_f32_16x16x32_bf16 a[216:219], a[104:107], v[28:31], a[216:219]
    v_mfma_f32_16x16x32_bf16 a[220:223], a[108:111], v[28:31], a[220:223]
    v_mfma_f32_16x16x32_bf16 a[224:227], a[112:115], v[28:31], a[224:227]
    s_branch L_csr1_1
L_cs1_1_1:
    s_cmp_lg_u32 s28, 1
    s_cbranch_scc1 L_cs1_1_2
    v_mfma_f32_16x16x32_bf16 a[208:211], a[116:119], v[28:31], a[208:211]
    v_mfma_f32_16x16x32_bf16 a[212:215], a[120:123], v[28:31], a[212:215]
    v_mfma_f32_16x16x32_bf16 a[216:219], a[124:127], v[28:31], a[216:219]
    v_mfma_f32_16x16x32_bf16 a[220:223], a[128:131], v[28:31], a[220:223]
    v_mfma_f32_16x16x32_bf16 a[224:227], a[132:135], v[28:31], a[224:227]
    s_branch L_csr1_1
L_cs1_1_2:
    s_cmp_lg_u32 s28, 2
    s_cbranch_scc1 L_cs1_1_3
    v_mfma_f32_16x16x32_bf16 a[208:211], a[136:139], v[28:31], a[208:211]
    v_mfma_f32_16x16x32_bf16 a[212:215], a[140:143], v[28:31], a[212:215]
    v_mfma_f32_16x16x32_bf16 a[216:219], a[144:147], v[28:31], a[216:219]
    v_mfma_f32_16x16x32_bf16 a[220:223], a[148:151], v[28:31], a[220:223]
    v_mfma_f32_16x16x32_bf16 a[224:227], a[152:155], v[28:31], a[224:227]
    s_branch L_csr1_1
L_cs1_1_3:
    v_mfma_f32_16x16x32_bf16 a[208:211], a[156:159], v[28:31], a[208:211]
    v_mfma_f32_16x16x32_bf16 a[212:215], a[160:163], v[28:31], a[212:215]
    v_mfma_f32_16x16x32_bf16 a[216:219], a[164:167], v[28:31], a[216:219]
    v_mfma_f32_16x16x32_bf16 a[220:223], a[168:171], v[28:31], a[220:223]
    v_mfma_f32_16x16x32_bf16 a[224:227], a[172:175], v[28:31], a[224:227]
    s_branch L_csr1_1
L_cs1_2:
    s_waitcnt lgkmcnt(0)
    s_cmp_lg_u32 s28, 0
    s_cbranch_scc1 L_cs1_2_1
    v_mfma_f32_16x16x32_bf16 a[208:211], a[96:99], v[28:31], a[208:211]
    v_mfma_f32_16x16x32_bf16 a[212:215], a[100:103], v[28:31], a[212:215]
    v_mfma_f32_16x16x32_bf16 a[216:219], a[104:107], v[28:31], a[216:219]
    v_mfma_f32_16x16x32_bf16 a[220:223], a[108:111], v[28:31], a[220:223]
    v_mfma_f32_16x16x32_bf16 a[224:227], a[112:115], v[28:31], a[224:227]
    s_branch L_csr1_2
L_cs1_2_1:
    s_cmp_lg_u32 s28, 1
    s_cbranch_scc1 L_cs1_2_2
    v_mfma_f32_16x16x32_bf16 a[208:211], a[116:119], v[28:31], a[208:211]
    v_mfma_f32_16x16x32_bf16 a[212:215], a[120:123], v[28:31], a[212:215]
    v_mfma_f32_16x16x32_bf16 a[216:219], a[124:127], v[28:31], a[216:219]
    v_mfma_f32_16x16x32_bf16 a[220:223], a[128:131], v[28:31], a[220:223]
    v_mfma_f32_16x16x32_bf16 a[224:227], a[132:135], v[28:31], a[224:227]
    s_branch L_csr1_2
L_cs1_2_2:
    s_cmp_lg_u32 s28, 2
    s_cbranch_scc1 L_cs1_2_3
    v_mfma_f32_16x16x32_bf16 a[208:211], a[136:139], v[28:31], a[208:211]
    v_mfma_f32_16x16x32_bf16 a[212:215], a[140:143], v[28:31], a[212:215]
    v_mfma_f32_16x16x32_bf16 a[216:219], a[144:147], v[28:31], a[216:219]
    v_mfma_f32_16x16x32_bf16 a[220:223], a[148:151], v[28:31], a[220:223]
    v_mfma_f32_16x16x32_bf16 a[224:227], a[152:155], v[28:31], a[224:227]
    s_branch L_csr1_2
L_cs1_2_3:
    v_mfma_f32_16x16x32_bf16 a[208:211], a[156:159], v[28:31], a[208:211]
    v_mfma_f32_16x16x32_bf16 a[212:215], a[160:163], v[28:31], a[212:215]
    v_mfma_f32_16x16x32_bf16 a[216:219], a[164:167], v[28:31], a[216:219]
    v_mfma_f32_16x16x32_bf16 a[220:223], a[168:171], v[28:31], a[220:223]
    v_mfma_f32_16x16x32_bf16 a[224:227], a[172:175], v[28:31], a[224:227]
    s_branch L_csr1_2
L_cs1_3:
    s_waitcnt lgkmcnt(0)
    s_cmp_lg_u32 s28, 0
    s_cbranch_scc1 L_cs1_3_1
    v_mfma_f32_16x16x32_bf16 a[208:211], a[96:99], v[28:31], a[208:211]
    v_mfma_f32_16x16x32_bf16 a[212:215], a[100:103], v[28:31], a[212:215]
    v_mfma_f32_16x16x32_bf16 a[216:219], a[104:107], v[28:31], a[216:219]
    v_mfma_f32_16x16x32_bf16 a[220:223], a[108:111], v[28:31], a[220:223]
    v_mfma_f32_16x16x32_bf16 a[224:227], a[112:115], v[28:31], a[224:227]
    s_branch L_csr1_3
L_cs1_3_1:
    s_cmp_lg_u32 s28, 1
    s_cbranch_scc1 L_cs1_3_2
    v_mfma_f32_16x16x32_bf16 a[208:211], a[116:119], v[28:31], a[208:211]
    v_mfma_f32_16x16x32_bf16 a[212:215], a[120:123], v[28:31], a[212:215]
    v_mfma_f32_16x16x32_bf16 a[216:219], a[124:127], v[28:31], a[216:219]
    v_mfma_f32_16x16x32_bf16 a[220:223], a[128:131], v[28:31], a[220:223]
    v_mfma_f32_16x16x32_bf16 a[224:227], a[132:135], v[28:31], a[224:227]
    s_branch L_csr1_3
L_cs1_3_2:
    s_cmp_lg_u32 s28, 2
    s_cbranch_scc1 L_cs1_3_3
    v_mfma_f32_16x16x32_bf16 a[208:211], a[136:139], v[28:31], a[208:211]
    v_mfma_f32_16x16x32_bf16 a[212:215], a[140:143], v[28:31], a[212:215]
    v_mfma_f32_16x16x32_bf16 a[216:219], a[144:147], v[28:31], a[216:219]
    v_mfma_f32_16x16x32_bf16 a[220:223], a[148:151], v[28:31], a[220:223]
    v_mfma_f32_16x16x32_bf16 a[224:227], a[152:155], v[28:31], a[224:227]
    s_branch L_csr1_3
L_cs1_3_3:
    v_mfma_f32_16x16x32_bf16 a[208:211], a[156:159], v[28:31], a[208:211]
    v_mfma_f32_16x16x32_bf16 a[212:215], a[160:163], v[28:31], a[212:215]
    v_mfma_f32_16x16x32_bf16 a[216:219], a[164:167], v[28:31], a[216:219]
    v_mfma_f32_16x16x32_bf16 a[220:223], a[168:171], v[28:31], a[220:223]
    v_mfma_f32_16x16x32_bf16 a[224:227], a[172:175], v[28:31], a[224:227]
    s_branch L_csr1_3
L_cst1:
    v_and_b32 v18, 48, v1
    s_mov_b32 exec_lo, 0x10001
    s_mov_b32 exec_hi, 0x10001
    buffer_store_dwordx4 a[208:211], v18, s[4:7], s78 offen offset:0 sc1
    buffer_store_dwordx4 a[212:215], v18, s[4:7], s78 offen offset:64 sc1
    buffer_store_dwordx4 a[216:219], v18, s[4:7], s78 offen offset:128 sc1
    buffer_store_dwordx4 a[220:223], v18, s[4:7], s78 offen offset:192 sc1
    buffer_store_dwordx4 a[224:227], v18, s[4:7], s78 offen offset:256 sc1
    s_mov_b64 exec, -1
    s_nop 1
    v_accvgpr_write_b32 a208, 0
    v_accvgpr_write_b32 a209, 0
    v_accvgpr_write_b32 a210, 0
    v_accvgpr_write_b32 a211, 0
    v_accvgpr_write_b32 a212, 0
    v_accvgpr_write_b32 a213, 0
    v_accvgpr_write_b32 a214, 0
    v_accvgpr_write_b32 a215, 0
    v_accvgpr_write_b32 a216, 0
    v_accvgpr_write_b32 a217, 0
    v_accvgpr_write_b32 a218, 0
    v_accvgpr_write_b32 a219, 0
    v_accvgpr_write_b32 a220, 0
    v_accvgpr_write_b32 a221, 0
    v_accvgpr_write_b32 a222, 0
    v_accvgpr_write_b32 a223, 0
    v_accvgpr_write_b32 a224, 0
    v_accvgpr_write_b32 a225, 0
    v_accvgpr_write_b32 a226, 0
    v_accvgpr_write_b32 a227, 0
    s_branch L_cstr1
L_sig1:
    s_mov_b64 exec, 1
    buffer_atomic_add v7, off, s[24:27], 0 sc1
    s_mov_b64 exec, -1
    s_branch L_sigr1
L_slow1:
    s_mov_b32 s29, 0x40000
L_slowl1:
    buffer_load_dword v18, off, s[24:27], 0 sc1
    s_waitcnt vmcnt(0)
    v_readfirstlane_b32 s77, v18
    s_cmp_ge_u32 s77, 256
    s_cbranch_scc1 L_slowr1
    s_sleep 2
    s_sub_u32 s29, s29, 1
    s_cmp_lg_u32 s29, 0
    s_cbranch_scc1 L_slowl1
    s_branch L_slowr1
L_g1_T2:
    s_add_u32 m0, s41, 0
    s_nop 0
    buffer_load_dwordx4 v4, s[8:11], s33 offen lds
    s_add_u32 m0, s41, 4096
    s_nop 0
    buffer_load_dwordx4 v6, s[8:11], s33 offen lds
    s_add_u32 m0, s41, 8064
    s_nop 0
    buffer_load_dwordx4 v6, s[8:11], s33 offen offset:128 lds
    s_add_u32 m0, s41, 12032
    s_nop 0
    buffer_load_dwordx4 v6, s[8:11], s33 offen offset:256 lds
    s_add_u32 m0, s41, 16000
    s_nop 0
    buffer_load_dwordx4 v6, s[8:11], s33 offen offset:384 lds
    s_add_u32 s33, s33, 196608
    s_mov_b32 s6, 0x3700000
    s_mov_b32 s7, s23
    s_mov_b32 s26, 0x100
    s_mov_b32 s27, s23
    s_lshl_b32 s58, s2, 3
    s_lshl_b32 s59, s28, 1
    s_add_u32 s58, s58, s59
    s_lshr_b32 s79, s58, 6
    s_lshl_b32 s79, s79, 8
    s_lshl_b32 s59, s58, 2
    s_add_u32 s79, s79, s59
    s_lshl_b32 s58, s58, 11
    v_and_b32 v20, 31, v1
    v_lshrrev_b32 v21, 5, v1
    v_lshlrev_b32 v20, 4, v20
    v_lshl_add_u32 v20, v21, 11, v20
    s_lshl_b32 s59, s2, 9
    s_add_u32 s59, s59, 0x3500000
    v_lshlrev_b32 v21, 3, v1
    buffer_load_dwordx4 v[32:35], v20, s[20:23], s58 offen offset:0
    buffer_load_dwordx4 v[36:39], v20, s[20:23], s58 offen offset:512
    buffer_load_dwordx4 v[40:43], v20, s[20:23], s58 offen offset:1024
    buffer_load_dwordx4 v[44:47], v20, s[20:23], s58 offen offset:1536
    buffer_store_dword v72, v21, s[4:7], s59 offen
    s_add_u32 m0, s41, 20480
    s_nop 0
    buffer_load_dwordx4 v4, s[8:11], s33 offen lds
    v_lshrrev_b32 v18, 5, v1
    v_bfe_u32 v19, v1, 2, 3
    v_and_b32 v20, 3, v1
    v_mfma_f32_32x32x16_bf16 v[80:95], v[72:75], v[72:75], 0
    v_lshlrev_b32 v21, 11, v18
    v_lshl_add_u32 v21, v19, 7, v21
    v_lshl_add_u32 v21, v20, 3, v21
    v_mfma_f32_32x32x16_bf16 v[96:111], v[72:75], v[72:75], 0
    v_lshrrev_b32 v19, 1, v19
    v_xor_b32 v20, 0, v19
    v_lshl_add_u32 v8, v20, 5, v21
    v_mfma_f32_32x32x16_bf16 v[112:127], v[72:75], v[72:75], 0
    s_add_u32 m0, s41, 24576
    s_nop 0
    buffer_load_dwordx4 v6, s[8:11], s33 offen lds
    v_add_u32 v12, 40960, v8
    v_xor_b32 v20, 1, v19
    v_lshl_add_u32 v9, v20, 5, v21
    v_mfma_f32_32x32x16_bf16 v[128:143], v[72:75], v[72:75], 0
    v_add_u32 v13, 40960, v9
    v_xor_b32 v20, 2, v19
    v_lshl_add_u32 v10, v20, 5, v21
    v_mfma_f32_32x32x16_bf16 v[144:159], v[72:75], v[72:75], 0
    v_add_u32 v14, 40960, v10
    v_xor_b32 v20, 3, v19
    v_lshl_add_u32 v11, v20, 5, v21
    v_mfma_f32_32x32x16_bf16 v[160:175], v[72:75], v[72:75], 0
    s_add_u32 m0, s41, 28544
    s_nop 0
    buffer_load_dwordx4 v6, s[8:11], s33 offen offset:128 lds
    v_add_u32 v15, 40960, v11
    v_and_b32 v20, 15, v1
    v_lshrrev_b32 v21, 1, v20
    v_mfma_f32_32x32x16_bf16 v[176:191], v[72:75], v[72:75], 0
    v_lshrrev_b32 v18, 4, v1
    v_xor_b32 v21, v21, v18
    v_lshlrev_b32 v20, 7, v20
    v_mfma_f32_32x32x16_bf16 v[192:207], v[72:75], v[72:75], 0
    v_add_u32 v20, s42, v20
    v_lshl_add_u32 v16, v21, 4, v20
    v_xor_b32 v17, 64, v16
    s_add_u32 m0, s41, 32512
    s_nop 0
    buffer_load_dwordx4 v6, s[8:11], s33 offen offset:256 lds
    v_mfma_f32_32x32x16_bf16 v[208:223], v[72:75], v[72:75], 0
    v_mov_b32 v28, 0x3f803f80
    v_mov_b32 v29, 0x3f803f80
    v_mov_b32 v30, 0x3f803f80
    v_mfma_f32_32x32x16_bf16 v[224:239], v[72:75], v[72:75], 0
    v_mov_b32 v31, 0x3f803f80
    v_mov_b32 v7, 1
    v_mov_b32 v19, 1.0
    v_mfma_f32_32x32x16_bf16 v[240:255], v[72:75], v[72:75], 0
    s_sub_u32 s75, s57, s75
    s_sub_u32 s76, 6, s75
    s_sub_u32 s75, 7, s75
    s_add_u32 m0, s41, 36480
    s_nop 0
    buffer_load_dwordx4 v6, s[8:11], s33 offen offset:384 lds
    s_add_u32 s33, s33, 196608
    v_mfma_f32_32x32x16_bf16 a[0:15], v[72:75], v[72:75], 0
    s_cmp_ge_u32 s57, 8
    s_cselect_b32 s75, -1, s75
    s_cselect_b32 s76, 7, s76
    v_mfma_f32_32x32x16_bf16 a[16:31], v[72:75], v[72:75], 0
    s_cmp_lg_u32 s28, 0
    s_cselect_b32 s76, -1, s76
    s_cmp_eq_u32 s75, 7
    v_mfma_f32_32x32x16_bf16 a[32:47], v[72:75], v[72:75], 0
    s_cselect_b32 s74, 1, 0
    s_lshl_b32 s78, s56, 3
    s_add_u32 s78, s78, s57
    s_add_u32 m0, s42, 8192
    s_add_u32 s35, s34, 0
    buffer_load_dwordx4 v2, s[20:23], s35 offen lds
    v_mfma_f32_32x32x16_bf16 a[48:63], v[72:75], v[72:75], 0
    s_mul_i32 s78, s78, 1280
    s_mul_i32 s77, s28, 320
    s_add_u32 s78, s78, s77
    v_mfma_f32_32x32x16_bf16 a[64:79], v[72:75], v[72:75], 0
    s_add_u32 s78, s78, 0x10000
    s_mov_b32 s77, 0xffff0000
    s_mov_b32 s29, 7
    v_mfma_f32_32x32x16_bf16 a[80:95], v[72:75], v[72:75], 0
    v_mfma_f32_32x32x16_bf16 a[208:223], v[72:75], v[72:75], 0
    v_mfma_f32_16x16x32_bf16 a[224:227], v[72:75], v[72:75], 0
    s_add_u32 m0, s42, 9216
    s_add_u32 s35, s34, 16384
    buffer_load_dwordx4 v3, s[20:23], s35 offen lds
    s_add_u32 m0, s42, 10240
    s_add_u32 s35, s34, 32768
    buffer_load_dwordx4 v2, s[20:23], s35 offen lds
    s_add_u32 m0, s42, 11264
    s_add_u32 s35, s34, 49152
    buffer_load_dwordx4 v3, s[20:23], s35 offen lds
    s_waitcnt vmcnt(10)
    s_add_u32 m0, s42, 12288
    s_add_u32 s35, s34, 65536
    buffer_load_dwordx4 v2, s[20:23], s35 offen lds
    v_lshlrev_b32 v48, 16, v32
    v_and_b32 v49, s77, v32
    v_lshlrev_b32 v50, 16, v33
    v_and_b32 v51, s77, v33
    v_lshlrev_b32 v52, 16, v34
    v_and_b32 v53, s77, v34
    v_lshlrev_b32 v54, 16, v35
    v_and_b32 v55, s77, v35
    v_lshlrev_b32 v56, 16, v36
    v_and_b32 v57, s77, v36
    v_lshlrev_b32 v58, 16, v37
    v_and_b32 v59, s77, v37
    v_lshlrev_b32 v60, 16, v38
    v_and_b32 v61, s77, v38
    v_lshlrev_b32 v62, 16, v39
    v_and_b32 v63, s77, v39
    v_lshlrev_b32 v64, 16, v40
    v_and_b32 v65, s77, v40
    v_lshlrev_b32 v66, 16, v41
    s_add_u32 m0, s41, 40960
    s_nop 0
    buffer_load_dwordx4 v4, s[8:11], s33 offen lds
    v_and_b32 v67, s77, v41
    v_lshlrev_b32 v68, 16, v42
    v_and_b32 v69, s77, v42
    v_lshlrev_b32 v70, 16, v43
    v_and_b32 v71, s77, v43
    v_lshlrev_b32 v72, 16, v44
    v_and_b32 v73, s77, v44
    v_lshlrev_b32 v74, 16, v45
    v_and_b32 v75, s77, v45
    v_lshlrev_b32 v76, 16, v46
    v_and_b32 v77, s77, v46
    v_lshlrev_b32 v78, 16, v47
    v_and_b32 v79, s77, v47
    v_pk_add_f32 v[32:33], v[48:49], v[50:51]
    v_pk_add_f32 v[34:35], v[52:53], v[54:55]
    v_pk_add_f32 v[32:33], v[32:33], v[56:57]
    v_pk_add_f32 v[34:35], v[34:35], v[58:59]
    v_pk_add_f32 v[32:33], v[32:33], v[60:61]
    v_pk_add_f32 v[34:35], v[34:35], v[62:63]
    v_pk_add_f32 v[32:33], v[32:33], v[64:65]
    s_add_u32 m0, s41, 45056
    s_nop 0
    buffer_load_dwordx4 v6, s[8:11], s33 offen lds
    v_pk_add_f32 v[34:35], v[34:35], v[66:67]
    v_pk_add_f32 v[32:33], v[32:33], v[68:69]
    v_pk_add_f32 v[34:35], v[34:35], v[70:71]
    v_pk_add_f32 v[32:33], v[32:33], v[72:73]
    v_pk_add_f32 v[34:35], v[34:35], v[74:75]
    v_pk_add_f32 v[32:33], v[32:33], v[76:77]
    v_pk_add_f32 v[34:35], v[34:35], v[78:79]
    v_pk_add_f32 v[32:33], v[32:33], v[34:35]
    v_add_f32 v32, v32, v33
    s_nop 1
    v_add_f32_dpp v32, v32, v32 quad_perm:[1,0,3,2] row_mask:0xf bank_mask:0xf
    s_nop 1
    v_add_f32_dpp v32, v32, v32 quad_perm:[2,3,0,1] row_mask:0xf bank_mask:0xf
    s_nop 1
    v_add_f32_dpp v32, v32, v32 row_half_mirror row_mask:0xf bank_mask:0xf
    s_nop 1
    v_add_f32_dpp v32, v32, v32 row_mirror row_mask:0xf bank_mask:0xf
    v_mov_b32 v33, v32
    s_nop 1
    s_add_u32 m0, s41, 49024
    s_nop 0
    buffer_load_dwordx4 v6, s[8:11], s33 offen offset:128 lds
    v_permlane16_swap_b32 v32, v33
    s_nop 1
    v_add_f32 v32, v32, v33
    v_mul_f32 v32, 0xba800000, v32
    v_pk_add_f32 v[48:49], v[48:49], v[32:33] op_sel_hi:[1,0]
    v_pk_add_f32 v[50:51], v[50:51], v[32:33] op_sel_hi:[1,0]
    v_pk_add_f32 v[52:53], v[52:53], v[32:33] op_sel_hi:[1,0]
    v_pk_add_f32 v[54:55], v[54:55], v[32:33] op_sel_hi:[1,0]
    v_pk_add_f32 v[56:57], v[56:57], v[32:33] op_sel_hi:[1,0]
    v_pk_add_f32 v[58:59], v[58:59], v[32:33] op_sel_hi:[1,0]
    v_pk_add_f32 v[60:61], v[60:61], v[32:33] op_sel_hi:[1,0]
    v_pk_add_f32 v[62:63], v[62:63], v[32:33] op_sel_hi:[1,0]
    v_pk_add_f32 v[64:65], v[64:65], v[32:33] op_sel_hi:[1,0]
    v_pk_add_f32 v[66:67], v[66:67], v[32:33] op_sel_hi:[1,0]
    v_pk_add_f32 v[68:69], v[68:69], v[32:33] op_sel_hi:[1,0]
    v_pk_add_f32 v[70:71], v[70:71], v[32:33] op_sel_hi:[1,0]
    v_pk_add_f32 v[72:73], v[72:73], v[32:33] op_sel_hi:[1,0]
    v_pk_add_f32 v[74:75], v[74:75], v[32:33] op_sel_hi:[1,0]
    v_pk_add_f32 v[76:77], v[76:77], v[32:33] op_sel_hi:[1,0]
    v_pk_add_f32 v[78:79], v[78:79], v[32:33] op_sel_hi:[1,0]
    s_add_u32 m0, s41, 52992
    s_nop 0
    buffer_load_dwordx4 v6, s[8:11], s33 offen offset:256 lds
    v_pk_mul_f32 v[24:25], v[48:49], v[48:49]
    v_pk_mul_f32 v[26:27], v[50:51], v[50:51]
    v_pk_fma_f32 v[24:25], v[52:53], v[52:53], v[24:25]
    v_pk_fma_f32 v[26:27], v[54:55], v[54:55], v[26:27]
    v_pk_fma_f32 v[24:25], v[56:57], v[56:57], v[24:25]
    v_pk_fma_f32 v[26:27], v[58:59], v[58:59], v[26:27]
    v_pk_fma_f32 v[24:25], v[60:61], v[60:61], v[24:25]
    v_pk_fma_f32 v[26:27], v[62:63], v[62:63], v[26:27]
    v_pk_fma_f32 v[24:25], v[64:65], v[64:65], v[24:25]
    v_pk_fma_f32 v[26:27], v[66:67], v[66:67], v[26:27]
    v_pk_fma_f32 v[24:25], v[68:69], v[68:69], v[24:25]
    v_pk_fma_f32 v[26:27], v[70:71], v[70:71], v[26:27]
    v_pk_fma_f32 v[24:25], v[72:73], v[72:73], v[24:25]
    v_pk_fma_f32 v[26:27], v[74:75], v[74:75], v[26:27]
    v_pk_fma_f32 v[24:25], v[76:77], v[76:77], v[24:25]
    v_pk_fma_f32 v[26:27], v[78:79], v[78:79], v[26:27]
    v_mov_b32 v22, v32
    v_mfma_f32_32x32x16_bf16 v[32:47], v[80:83], v[80:83], 0
    v_mfma_f32_32x32x16_bf16 v[48:63], v[80:83], v[80:83], 0
    s_add_u32 m0, s41, 56960
    s_nop 0
    buffer_load_dwordx4 v6, s[8:11], s33 offen offset:384 lds
    s_add_u32 s33, s33, 196608
    v_mfma_f32_32x32x16_bf16 v[64:79], v[80:83], v[80:83], 0
    v_pk_add_f32 v[24:25], v[24:25], v[26:27]
    v_add_f32 v24, v24, v25
    s_nop 1
    v_add_f32_dpp v24, v24, v24 quad_perm:[1,0,3,2] row_mask:0xf bank_mask:0xf
    s_nop 1
    v_add_f32_dpp v24, v24, v24 quad_perm:[2,3,0,1] row_mask:0xf bank_mask:0xf
    s_nop 1
    v_add_f32_dpp v24, v24, v24 row_half_mirror row_mask:0xf bank_mask:0xf
    s_nop 1
    v_add_f32_dpp v24, v24, v24 row_mirror row_mask:0xf bank_mask:0xf
    v_mov_b32 v25, v24
    s_nop 1
    v_permlane16_swap_b32 v24, v25
    s_nop 1
    v_add_f32 v24, v24, v25
    v_mul_f32 v24, 0x3a800000, v24
    v_cvt_pk_bf16_f32 v23, v22, v24
    v_cvt_pk_bf16_f32 v20, v22, v22
    v_and_b32 v24, s77, v23
    v_add_f32 v24, 0x3727c5ac, v24
    v_cvt_pk_bf16_f32 v24, v24, v24
    v_and_b32 v24, s77, v24
    v_sqrt_f32 v24, v24
    v_lshrrev_b32 v18, 5, v1
    v_cvt_pk_bf16_f32 v24, v24, v24
    v_and_b32 v24, s77, v24
    v_rcp_f32 v21, v24
    v_lshlrev_b32 v18, 2, v18
    s_mov_b32 exec_lo, 1
    s_mov_b32 exec_hi, 1
    buffer_store_dword v20, v18, s[4:7], s79 offen offset:0 sc1
    buffer_store_dword v21, v18, s[4:7], s79 offen offset:256 sc1
    s_mov_b64 exec, -1
    s_barrier
    ds_read_b128 a[176:179], v16 offset:0
    ds_read_b128 a[180:183], v16 offset:2048
    ds_read_b128 a[184:187], v16 offset:4096
    ds_read_b128 a[188:191], v16 offset:6144
    ds_read_b64_tr_b16 a[96:97], v8 offset:0
    ds_read_b64_tr_b16 a[98:99], v8 offset:1024
    ds_read_b64_tr_b16 a[100:101], v9 offset:0
    ds_read_b64_tr_b16 a[102:103], v9 offset:1024
    ds_read_b64_tr_b16 a[104:105], v10 offset:0
    ds_read_b64_tr_b16 a[106:107], v10 offset:1024
    ds_read_b64_tr_b16 a[108:109], v11 offset:0
    ds_read_b64_tr_b16 a[110:111], v11 offset:1024
    ds_read_b64_tr_b16 a[112:113], v8 offset:4096
    ds_read_b64_tr_b16 a[114:115], v8 offset:5120
    ds_read_b64_tr_b16 a[116:117], v9 offset:4096
    ds_read_b64_tr_b16 a[118:119], v9 offset:5120
    ds_read_b64_tr_b16 a[120:121], v10 offset:4096
    ds_read_b64_tr_b16 a[122:123], v10 offset:5120
    ds_read_b64_tr_b16 a[124:125], v11 offset:4096
    ds_read_b64_tr_b16 a[126:127], v11 offset:5120
    ds_read_b64_tr_b16 a[128:129], v8 offset:8192
    ds_read_b64_tr_b16 a[130:131], v8 offset:9216
    ds_read_b64_tr_b16 a[132:133], v9 offset:8192
    ds_read_b64_tr_b16 a[134:135], v9 offset:9216
    ds_read_b64_tr_b16 a[136:137], v10 offset:8192
    ds_read_b64_tr_b16 a[138:139], v10 offset:9216
    ds_read_b64_tr_b16 a[140:141], v11 offset:8192
    ds_read_b64_tr_b16 a[142:143], v11 offset:9216
    ds_read_b64_tr_b16 a[144:145], v8 offset:12288
    ds_read_b64_tr_b16 a[146:147], v8 offset:13312
    ds_read_b64_tr_b16 a[148:149], v9 offset:12288
    ds_read_b64_tr_b16 a[150:151], v9 offset:13312
    ds_read_b64_tr_b16 a[152:153], v10 offset:12288
    ds_read_b64_tr_b16 a[154:155], v10 offset:13312
    ds_read_b64_tr_b16 a[156:157], v11 offset:12288
    ds_read_b64_tr_b16 a[158:159], v11 offset:13312
    ds_read_b64_tr_b16 a[160:161], v8 offset:16384
    ds_read_b64_tr_b16 a[162:163], v8 offset:17408
    ds_read_b64_tr_b16 a[164:165], v9 offset:16384
    ds_read_b64_tr_b16 a[166:167], v9 offset:17408
    ds_read_b64_tr_b16 a[168:169], v10 offset:16384
    ds_read_b64_tr_b16 a[170:171], v10 offset:17408
    ds_read_b64_tr_b16 a[172:173], v11 offset:16384
    ds_read_b64_tr_b16 a[174:175], v11 offset:17408
L_g1_loop2:
    s_waitcnt lgkmcnt(8)
    v_mfma_f32_16x16x32_bf16 v[32:35], a[96:99], a[176:179], v[32:35]
    v_mfma_f32_16x16x32_bf16 v[40:43], a[96:99], a[180:183], v[40:43]
    v_mfma_f32_16x16x32_bf16 v[48:51], a[96:99], a[184:187], v[48:51]
    v_mfma_f32_16x16x32_bf16 v[56:59], a[96:99], a[188:191], v[56:59]
    s_waitcnt lgkmcnt(8)
    v_mfma_f32_16x16x32_bf16 v[60:63], a[100:103], a[188:191], v[60:63]
    s_cmp_lg_u32 s74, 0
    s_cbranch_scc1 L_cs2_0
L_csr2_0:
    s_waitcnt vmcnt(11)
    s_barrier
    v_mfma_f32_16x16x32_bf16 v[52:55], a[100:103], a[184:187], v[52:55]
    ds_read_b128 a[192:195], v17 offset:0
    v_mfma_f32_16x16x32_bf16 v[44:47], a[100:103], a[180:183], v[44:47]
    ds_read_b128 a[196:199], v17 offset:2048
    v_mfma_f32_16x16x32_bf16 v[36:39], a[100:103], a[176:179], v[36:39]
    ds_read_b128 a[200:203], v17 offset:4096
    v_mfma_f32_16x16x32_bf16 v[64:67], a[104:107], a[176:179], v[64:67]
    ds_read_b128 a[204:207], v17 offset:6144
    v_mfma_f32_16x16x32_bf16 v[72:75], a[104:107], a[180:183], v[72:75]
    ds_read_b64_tr_b16 a[96:97], v8 offset:20480
    v_mfma_f32_16x16x32_bf16 v[80:83], a[104:107], a[184:187], v[80:83]
    ds_read_b64_tr_b16 a[98:99], v8 offset:21504
    v_mfma_f32_16x16x32_bf16 v[88:91], a[104:107], a[188:191], v[88:91]
    ds_read_b64_tr_b16 a[100:101], v9 offset:20480
    v_mfma_f32_16x16x32_bf16 v[92:95], a[108:111], a[188:191], v[92:95]
    ds_read_b64_tr_b16 a[102:103], v9 offset:21504
    v_mfma_f32_16x16x32_bf16 v[84:87], a[108:111], a[184:187], v[84:87]
    s_add_u32 m0, s42, 13312
    s_add_u32 s35, s34, 81920
    v_mfma_f32_16x16x32_bf16 v[76:79], a[108:111], a[180:183], v[76:79]
    buffer_load_dwordx4 v3, s[20:23], s35 offen lds
    v_mfma_f32_16x16x32_bf16 v[68:71], a[108:111], a[176:179], v[68:71]
    ds_read_b64_tr_b16 a[104:105], v10 offset:20480
    v_mfma_f32_16x16x32_bf16 v[96:99], a[176:179], a[112:115], v[96:99]
    ds_read_b64_tr_b16 a[106:107], v10 offset:21504
    v_mfma_f32_16x16x32_bf16 v[104:107], a[180:183], a[112:115], v[104:107]
    ds_read_b64_tr_b16 a[108:109], v11 offset:20480
    v_mfma_f32_16x16x32_bf16 v[112:115], a[184:187], a[112:115], v[112:115]
    ds_read_b64_tr_b16 a[110:111], v11 offset:21504
    v_mfma_f32_16x16x32_bf16 v[120:123], a[188:191], a[112:115], v[120:123]
    ds_read_b64_tr_b16 a[112:113], v8 offset:24576
    v_mfma_f32_16x16x32_bf16 v[124:127], a[188:191], a[116:119], v[124:127]
    ds_read_b64_tr_b16 a[114:115], v8 offset:25600
    v_mfma_f32_16x16x32_bf16 v[116:119], a[184:187], a[116:119], v[116:119]
    s_add_u32 m0, s41, 61440
    v_mfma_f32_16x16x32_bf16 v[108:111], a[180:183], a[116:119], v[108:111]
    buffer_load_dwordx4 v4, s[8:11], s33 offen lds
    v_mfma_f32_16x16x32_bf16 v[100:103], a[176:179], a[116:119], v[100:103]
    ds_read_b64_tr_b16 a[116:117], v9 offset:24576
    s_waitcnt lgkmcnt(8)
    v_mfma_f32_16x16x32_bf16 v[128:131], a[176:179], a[120:123], v[128:131]
    ds_read_b64_tr_b16 a[118:119], v9 offset:25600
    v_mfma_f32_16x16x32_bf16 v[136:139], a[180:183], a[120:123], v[136:139]
    v_mfma_f32_16x16x32_bf16 v[144:147], a[184:187], a[120:123], v[144:147]
    v_mfma_f32_16x16x32_bf16 v[152:155], a[188:191], a[120:123], v[152:155]
    ds_read_b64_tr_b16 a[120:121], v10 offset:24576
    v_mfma_f32_16x16x32_bf16 v[156:159], a[188:191], a[124:127], v[156:159]
    ds_read_b64_tr_b16 a[122:123], v10 offset:25600
    v_mfma_f32_16x16x32_bf16 v[148:151], a[184:187], a[124:127], v[148:151]
    s_add_u32 m0, s42, 14336
    s_add_u32 s35, s34, 98304
    v_mfma_f32_16x16x32_bf16 v[140:143], a[180:183], a[124:127], v[140:143]
    buffer_load_dwordx4 v2, s[20:23], s35 offen lds
    v_mfma_f32_16x16x32_bf16 v[132:135], a[176:179], a[124:127], v[132:135]
    ds_read_b64_tr_b16 a[124:125], v11 offset:24576
    v_mfma_f32_16x16x32_bf16 v[160:163], a[176:179], a[128:131], v[160:163]
    ds_read_b64_tr_b16 a[126:127], v11 offset:25600
    v_mfma_f32_16x16x32_bf16 v[168:171], a[180:183], a[128:131], v[168:171]
    v_mfma_f32_16x16x32_bf16 v[176:179], a[184:187], a[128:131], v[176:179]
    v_mfma_f32_16x16x32_bf16 v[184:187], a[188:191], a[128:131], v[184:187]
    ds_read_b64_tr_b16 a[128:129], v8 offset:28672
    v_mfma_f32_16x16x32_bf16 v[188:191], a[188:191], a[132:135], v[188:191]
    ds_read_b64_tr_b16 a[130:131], v8 offset:29696
    v_mfma_f32_16x16x32_bf16 v[180:183], a[184:187], a[132:135], v[180:183]
    s_add_u32 m0, s41, 65536
    v_mfma_f32_16x16x32_bf16 v[172:175], a[180:183], a[132:135], v[172:175]
    buffer_load_dwordx4 v6, s[8:11], s33 offen lds
    v_mfma_f32_16x16x32_bf16 v[164:167], a[176:179], a[132:135], v[164:167]
    ds_read_b64_tr_b16 a[132:133], v9 offset:28672
    v_mfma_f32_16x16x32_bf16 v[192:195], a[176:179], a[136:139], v[192:195]
    ds_read_b64_tr_b16 a[134:135], v9 offset:29696
    v_mfma_f32_16x16x32_bf16 v[200:203], a[180:183], a[136:139], v[200:203]
    v_mfma_f32_16x16x32_bf16 v[208:211], a[184:187], a[136:139], v[208:211]
    v_mfma_f32_16x16x32_bf16 v[216:219], a[188:191], a[136:139], v[216:219]
    ds_read_b64_tr_b16 a[136:137], v10 offset:28672
    s_waitcnt lgkmcnt(8)
    v_mfma_f32_16x16x32_bf16 v[220:223], a[188:191], a[140:143], v[220:223]
    ds_read_b64_tr_b16 a[138:139], v10 offset:29696
    v_mfma_f32_16x16x32_bf16 v[212:215], a[184:187], a[140:143], v[212:215]
    s_add_u32 m0, s42, 15360
    s_add_u32 s35, s34, 114688
    v_mfma_f32_16x16x32_bf16 v[204:207], a[180:183], a[140:143], v[204:207]
    buffer_load_dwordx4 v3, s[20:23], s35 offen lds
    s_add_u32 s34, s34, 128
    s_and_b32 s35, s34, 0x7ff
    s_cselect_b32 s35, 0, 0x800
    s_sub_u32 s34, s34, s35
    v_mfma_f32_16x16x32_bf16 v[196:199], a[176:179], a[140:143], v[196:199]
    ds_read_b64_tr_b16 a[140:141], v11 offset:28672
    v_mfma_f32_16x16x32_bf16 a[0:3], a[176:179], a[144:147], a[0:3]
    ds_read_b64_tr_b16 a[142:143], v11 offset:29696
    v_mfma_f32_16x16x32_bf16 a[8:11], a[180:183], a[144:147], a[8:11]
    v_mfma_f32_16x16x32_bf16 a[16:19], a[184:187], a[144:147], a[16:19]
    v_mfma_f32_16x16x32_bf16 a[24:27], a[188:191], a[144:147], a[24:27]
    ds_read_b64_tr_b16 a[144:145], v8 offset:32768
    v_mfma_f32_16x16x32_bf16 a[28:31], a[188:191], a[148:151], a[28:31]
    ds_read_b64_tr_b16 a[146:147], v8 offset:33792
    v_mfma_f32_16x16x32_bf16 a[20:23], a[184:187], a[148:151], a[20:23]
    s_add_u32 m0, s41, 69504
    v_mfma_f32_16x16x32_bf16 a[12:15], a[180:183], a[148:151], a[12:15]
    buffer_load_dwordx4 v6, s[8:11], s33 offen offset:128 lds
    v_mfma_f32_16x16x32_bf16 a[4:7], a[176:179], a[148:151], a[4:7]
    ds_read_b64_tr_b16 a[148:149], v9 offset:32768
    v_mfma_f32_16x16x32_bf16 a[32:35], a[176:179], a[152:155], a[32:35]
    ds_read_b64_tr_b16 a[150:151], v9 offset:33792
    v_mfma_f32_16x16x32_bf16 a[40:43], a[180:183], a[152:155], a[40:43]
    v_mfma_f32_16x16x32_bf16 a[48:51], a[184:187], a[152:155], a[48:51]
    v_mfma_f32_16x16x32_bf16 a[56:59], a[188:191], a[152:155], a[56:59]
    ds_read_b64_tr_b16 a[152:153], v10 offset:32768
    v_mfma_f32_16x16x32_bf16 a[60:63], a[188:191], a[156:159], a[60:63]
    ds_read_b64_tr_b16 a[154:155], v10 offset:33792
    v_mfma_f32_16x16x32_bf16 a[52:55], a[184:187], a[156:159], a[52:55]
    s_add_u32 m0, s41, 73472
    v_mfma_f32_16x16x32_bf16 a[44:47], a[180:183], a[156:159], a[44:47]
    buffer_load_dwordx4 v6, s[8:11], s33 offen offset:256 lds
    v_mfma_f32_16x16x32_bf16 a[36:39], a[176:179], a[156:159], a[36:39]
    ds_read_b64_tr_b16 a[156:157], v11 offset:32768
    s_waitcnt lgkmcnt(8)
    v_mfma_f32_16x16x32_bf16 a[64:67], a[176:179], a[160:163], a[64:67]
    ds_read_b64_tr_b16 a[158:159], v11 offset:33792
    v_mfma_f32_16x16x32_bf16 a[72:75], a[180:183], a[160:163], a[72:75]
    v_mfma_f32_16x16x32_bf16 a[80:83], a[184:187], a[160:163], a[80:83]
    v_mfma_f32_16x16x32_bf16 a[88:91], a[188:191], a[160:163], a[88:91]
    ds_read_b64_tr_b16 a[160:161], v8 offset:36864
    v_mfma_f32_16x16x32_bf16 a[92:95], a[188:191], a[164:167], a[92:95]
    ds_read_b64_tr_b16 a[162:163], v8 offset:37888
    v_mfma_f32_16x16x32_bf16 a[84:87], a[184:187], a[164:167], a[84:87]
    s_add_u32 m0, s41, 77440
    v_mfma_f32_16x16x32_bf16 a[76:79], a[180:183], a[164:167], a[76:79]
    buffer_load_dwordx4 v6, s[8:11], s33 offen offset:384 lds
    s_add_u32 s33, s33, 196608
    s_cmp_eq_u32 s33, 6291456
    s_cselect_b32 s33, 0, s33
    v_mfma_f32_16x16x32_bf16 a[68:71], a[176:179], a[164:167], a[68:71]
    ds_read_b64_tr_b16 a[164:165], v9 offset:36864
    v_mfma_f32_16x16x32_bf16 v[224:227], a[176:179], a[168:171], v[224:227]
    ds_read_b64_tr_b16 a[166:167], v9 offset:37888
    v_mfma_f32_16x16x32_bf16 v[232:235], a[180:183], a[168:171], v[232:235]
    v_mfma_f32_16x16x32_bf16 v[240:243], a[184:187], a[168:171], v[240:243]
    v_mfma_f32_16x16x32_bf16 v[248:251], a[188:191], a[168:171], v[248:251]
    ds_read_b64_tr_b16 a[168:169], v10 offset:36864
    v_mfma_f32_16x16x32_bf16 v[252:255], a[188:191], a[172:175], v[252:255]
    ds_read_b64_tr_b16 a[170:171], v10 offset:37888
    v_mfma_f32_16x16x32_bf16 v[244:247], a[184:187], a[172:175], v[244:247]
    v_mfma_f32_16x16x32_bf16 v[236:239], a[180:183], a[172:175], v[236:239]
    v_mfma_f32_16x16x32_bf16 v[228:231], a[176:179], a[172:175], v[228:231]
    ds_read_b64_tr_b16 a[172:173], v11 offset:36864
    ds_read_b64_tr_b16 a[174:175], v11 offset:37888
    v_mfma_f32_16x16x32_bf16 v[32:35], a[96:99], a[192:195], v[32:35]
    v_mfma_f32_16x16x32_bf16 v[40:43], a[96:99], a[196:199], v[40:43]
    v_mfma_f32_16x16x32_bf16 v[48:51], a[96:99], a[200:203], v[48:51]
    v_mfma_f32_16x16x32_bf16 v[56:59], a[96:99], a[204:207], v[56:59]
    s_waitcnt lgkmcnt(8)
    v_mfma_f32_16x16x32_bf16 v[60:63], a[100:103], a[204:207], v[60:63]
    s_cmp_lg_u32 s74, 0
    s_cbranch_scc1 L_cs2_1
L_csr2_1:
    s_waitcnt vmcnt(3)
    s_barrier
    v_mfma_f32_16x16x32_bf16 v[52:55], a[100:103], a[200:203], v[52:55]
    ds_read_b128 a[176:179], v16 offset:8192
    v_mfma_f32_16x16x32_bf16 v[44:47], a[100:103], a[196:199], v[44:47]
    ds_read_b128 a[180:183], v16 offset:10240
    v_mfma_f32_16x16x32_bf16 v[36:39], a[100:103], a[192:195], v[36:39]
    ds_read_b128 a[184:187], v16 offset:12288
    v_mfma_f32_16x16x32_bf16 v[64:67], a[104:107], a[192:195], v[64:67]
    ds_read_b128 a[188:191], v16 offset:14336
    v_mfma_f32_16x16x32_bf16 v[72:75], a[104:107], a[196:199], v[72:75]
    ds_read_b64_tr_b16 a[96:97], v12 offset:0
    v_mfma_f32_16x16x32_bf16 v[80:83], a[104:107], a[200:203], v[80:83]
    ds_read_b64_tr_b16 a[98:99], v12 offset:1024
    v_mfma_f32_16x16x32_bf16 v[88:91], a[104:107], a[204:207], v[88:91]
    ds_read_b64_tr_b16 a[100:101], v13 offset:0
    v_mfma_f32_16x16x32_bf16 v[92:95], a[108:111], a[204:207], v[92:95]
    ds_read_b64_tr_b16 a[102:103], v13 offset:1024
    v_mfma_f32_16x16x32_bf16 v[84:87], a[108:111], a[200:203], v[84:87]
    s_add_u32 m0, s42, 0
    s_add_u32 s35, s34, 0
    v_mfma_f32_16x16x32_bf16 v[76:79], a[108:111], a[196:199], v[76:79]
    buffer_load_dwordx4 v2, s[20:23], s35 offen lds
    v_mfma_f32_16x16x32_bf16 v[68:71], a[108:111], a[192:195], v[68:71]
    ds_read_b64_tr_b16 a[104:105], v14 offset:0
    v_mfma_f32_16x16x32_bf16 v[96:99], a[192:195], a[112:115], v[96:99]
    ds_read_b64_tr_b16 a[106:107], v14 offset:1024
    v_mfma_f32_16x16x32_bf16 v[104:107], a[196:199], a[112:115], v[104:107]
    s_add_u32 m0, s41, 0
    v_mfma_f32_16x16x32_bf16 v[112:115], a[200:203], a[112:115], v[112:115]
    buffer_load_dwordx4 v4, s[8:11], s33 offen lds
    v_mfma_f32_16x16x32_bf16 v[120:123], a[204:207], a[112:115], v[120:123]
    ds_read_b64_tr_b16 a[108:109], v15 offset:0
    v_mfma_f32_16x16x32_bf16 v[124:127], a[204:207], a[116:119], v[124:127]
    ds_read_b64_tr_b16 a[110:111], v15 offset:1024
    v_mfma_f32_16x16x32_bf16 v[116:119], a[200:203], a[116:119], v[116:119]
    ds_read_b64_tr_b16 a[112:113], v12 offset:4096
    v_mfma_f32_16x16x32_bf16 v[108:111], a[196:199], a[116:119], v[108:111]
    ds_read_b64_tr_b16 a[114:115], v12 offset:5120
    v_mfma_f32_16x16x32_bf16 v[100:103], a[192:195], a[116:119], v[100:103]
    ds_read_b64_tr_b16 a[116:117], v13 offset:4096
    s_waitcnt lgkmcnt(8)
    v_mfma_f32_16x16x32_bf16 v[128:131], a[192:195], a[120:123], v[128:131]
    ds_read_b64_tr_b16 a[118:119], v13 offset:5120
    v_mfma_f32_16x16x32_bf16 v[136:139], a[196:199], a[120:123], v[136:139]
    s_add_u32 m0, s42, 1024
    s_add_u32 s35, s34, 16384
    v_mfma_f32_16x16x32_bf16 v[144:147], a[200:203], a[120:123], v[144:147]
    buffer_load_dwordx4 v3, s[20:23], s35 offen lds
    v_mfma_f32_16x16x32_bf16 v[152:155], a[204:207], a[120:123], v[152:155]
    ds_read_b64_tr_b16 a[120:121], v14 offset:4096
    v_mfma_f32_16x16x32_bf16 v[156:159], a[204:207], a[124:127], v[156:159]
    ds_read_b64_tr_b16 a[122:123], v14 offset:5120
    v_mfma_f32_16x16x32_bf16 v[148:151], a[200:203], a[124:127], v[148:151]
    v_mfma_f32_16x16x32_bf16 v[140:143], a[196:199], a[124:127], v[140:143]
    v_mfma_f32_16x16x32_bf16 v[132:135], a[192:195], a[124:127], v[132:135]
    ds_read_b64_tr_b16 a[124:125], v15 offset:4096
    v_mfma_f32_16x16x32_bf16 v[160:163], a[192:195], a[128:131], v[160:163]
    ds_read_b64_tr_b16 a[126:127], v15 offset:5120
    v_mfma_f32_16x16x32_bf16 v[168:171], a[196:199], a[128:131], v[168:171]
    s_add_u32 m0, s41, 4096
    v_mfma_f32_16x16x32_bf16 v[176:179], a[200:203], a[128:131], v[176:179]
    buffer_load_dwordx4 v6, s[8:11], s33 offen lds
    v_mfma_f32_16x16x32_bf16 v[184:187], a[204:207], a[128:131], v[184:187]
    ds_read_b64_tr_b16 a[128:129], v12 offset:8192
    v_mfma_f32_16x16x32_bf16 v[188:191], a[204:207], a[132:135], v[188:191]
    ds_read_b64_tr_b16 a[130:131], v12 offset:9216
    v_mfma_f32_16x16x32_bf16 v[180:183], a[200:203], a[132:135], v[180:183]
    s_add_u32 m0, s42, 2048
    s_add_u32 s35, s34, 32768
    v_mfma_f32_16x16x32_bf16 v[172:175], a[196:199], a[132:135], v[172:175]
    buffer_load_dwordx4 v2, s[20:23], s35 offen lds
    v_mfma_f32_16x16x32_bf16 v[164:167], a[192:195], a[132:135], v[164:167]
    ds_read_b64_tr_b16 a[132:133], v13 offset:8192
    v_mfma_f32_16x16x32_bf16 v[192:195], a[192:195], a[136:139], v[192:195]
    ds_read_b64_tr_b16 a[134:135], v13 offset:9216
    v_mfma_f32_16x16x32_bf16 v[200:203], a[196:199], a[136:139], v[200:203]
    v_mfma_f32_16x16x32_bf16 v[208:211], a[200:203], a[136:139], v[208:211]
    v_mfma_f32_16x16x32_bf16 v[216:219], a[204:207], a[136:139], v[216:219]
    ds_read_b64_tr_b16 a[136:137], v14 offset:8192
    s_waitcnt lgkmcnt(8)
    v_mfma_f32_16x16x32_bf16 v[220:223], a[204:207], a[140:143], v[220:223]
    ds_read_b64_tr_b16 a[138:139], v14 offset:9216
    v_mfma_f32_16x16x32_bf16 v[212:215], a[200:203], a[140:143], v[212:215]
    s_add_u32 m0, s41, 8064
    v_mfma_f32_16x16x32_bf16 v[204:207], a[196:199], a[140:143], v[204:207]
    buffer_load_dwordx4 v6, s[8:11], s33 offen offset:128 lds
    v_mfma_f32_16x16x32_bf16 v[196:199], a[192:195], a[140:143], v[196:199]
    ds_read_b64_tr_b16 a[140:141], v15 offset:8192
    v_mfma_f32_16x16x32_bf16 a[0:3], a[192:195], a[144:147], a[0:3]
    ds_read_b64_tr_b16 a[142:143], v15 offset:9216
    v_mfma_f32_16x16x32_bf16 a[8:11], a[196:199], a[144:147], a[8:11]
    v_mfma_f32_16x16x32_bf16 a[16:19], a[200:203], a[144:147], a[16:19]
    v_mfma_f32_16x16x32_bf16 a[24:27], a[204:207], a[144:147], a[24:27]
    ds_read_b64_tr_b16 a[144:145], v12 offset:12288
    v_mfma_f32_16x16x32_bf16 a[28:31], a[204:207], a[148:151], a[28:31]
    ds_read_b64_tr_b16 a[146:147], v12 offset:13312
    v_mfma_f32_16x16x32_bf16 a[20:23], a[200:203], a[148:151], a[20:23]
    s_add_u32 m0, s42, 3072
    s_add_u32 s35, s34, 49152
    v_mfma_f32_16x16x32_bf16 a[12:15], a[196:199], a[148:151], a[12:15]
    buffer_load_dwordx4 v3, s[20:23], s35 offen lds
    v_mfma_f32_16x16x32_bf16 a[4:7], a[192:195], a[148:151], a[4:7]
    ds_read_b64_tr_b16 a[148:149], v13 offset:12288
    v_mfma_f32_16x16x32_bf16 a[32:35], a[192:195], a[152:155], a[32:35]
    ds_read_b64_tr_b16 a[150:151], v13 offset:13312
    v_mfma_f32_16x16x32_bf16 a[40:43], a[196:199], a[152:155], a[40:43]
    s_add_u32 m0, s41, 12032
    v_mfma_f32_16x16x32_bf16 a[48:51], a[200:203], a[152:155], a[48:51]
    buffer_load_dwordx4 v6, s[8:11], s33 offen offset:256 lds
    v_mfma_f32_16x16x32_bf16 a[56:59], a[204:207], a[152:155], a[56:59]
    ds_read_b64_tr_b16 a[152:153], v14 offset:12288
    v_mfma_f32_16x16x32_bf16 a[60:63], a[204:207], a[156:159], a[60:63]
    ds_read_b64_tr_b16 a[154:155], v14 offset:13312
    v_mfma_f32_16x16x32_bf16 a[52:55], a[200:203], a[156:159], a[52:55]
    v_mfma_f32_16x16x32_bf16 a[44:47], a[196:199], a[156:159], a[44:47]
    v_mfma_f32_16x16x32_bf16 a[36:39], a[192:195], a[156:159], a[36:39]
    ds_read_b64_tr_b16 a[156:157], v15 offset:12288
    s_waitcnt lgkmcnt(8)
    v_mfma_f32_16x16x32_bf16 a[64:67], a[192:195], a[160:163], a[64:67]
    ds_read_b64_tr_b16 a[158:159], v15 offset:13312
    v_mfma_f32_16x16x32_bf16 a[72:75], a[196:199], a[160:163], a[72:75]
    s_add_u32 m0, s42, 4096
    s_add_u32 s35, s34, 65536
    v_mfma_f32_16x16x32_bf16 a[80:83], a[200:203], a[160:163], a[80:83]
    buffer_load_dwordx4 v2, s[20:23], s35 offen lds
    v_mfma_f32_16x16x32_bf16 a[88:91], a[204:207], a[160:163], a[88:91]
    ds_read_b64_tr_b16 a[160:161], v12 offset:16384
    v_mfma_f32_16x16x32_bf16 a[92:95], a[204:207], a[164:167], a[92:95]
    ds_read_b64_tr_b16 a[162:163], v12 offset:17408
    v_mfma_f32_16x16x32_bf16 a[84:87], a[200:203], a[164:167], a[84:87]
    v_mfma_f32_16x16x32_bf16 a[76:79], a[196:199], a[164:167], a[76:79]
    v_mfma_f32_16x16x32_bf16 a[68:71], a[192:195], a[164:167], a[68:71]
    ds_read_b64_tr_b16 a[164:165], v13 offset:16384
    v_mfma_f32_16x16x32_bf16 v[224:227], a[192:195], a[168:171], v[224:227]
    ds_read_b64_tr_b16 a[166:167], v13 offset:17408
    v_mfma_f32_16x16x32_bf16 v[232:235], a[196:199], a[168:171], v[232:235]
    s_add_u32 m0, s41, 16000
    v_mfma_f32_16x16x32_bf16 v[240:243], a[200:203], a[168:171], v[240:243]
    buffer_load_dwordx4 v6, s[8:11], s33 offen offset:384 lds
    s_add_u32 s33, s33, 196608
    v_mfma_f32_16x16x32_bf16 v[248:251], a[204:207], a[168:171], v[248:251]
    ds_read_b64_tr_b16 a[168:169], v14 offset:16384
    v_mfma_f32_16x16x32_bf16 v[252:255], a[204:207], a[172:175], v[252:255]
    ds_read_b64_tr_b16 a[170:171], v14 offset:17408
    v_mfma_f32_16x16x32_bf16 v[244:247], a[200:203], a[172:175], v[244:247]
    v_mfma_f32_16x16x32_bf16 v[236:239], a[196:199], a[172:175], v[236:239]
    v_mfma_f32_16x16x32_bf16 v[228:231], a[192:195], a[172:175], v[228:231]
    ds_read_b64_tr_b16 a[172:173], v15 offset:16384
    ds_read_b64_tr_b16 a[174:175], v15 offset:17408
    v_mfma_f32_16x16x32_bf16 v[32:35], a[96:99], a[176:179], v[32:35]
    v_mfma_f32_16x16x32_bf16 v[40:43], a[96:99], a[180:183], v[40:43]
    v_mfma_f32_16x16x32_bf16 v[48:51], a[96:99], a[184:187], v[48:51]
    v_mfma_f32_16x16x32_bf16 v[56:59], a[96:99], a[188:191], v[56:59]
    s_waitcnt lgkmcnt(8)
    v_mfma_f32_16x16x32_bf16 v[60:63], a[100:103], a[188:191], v[60:63]
    s_cmp_lg_u32 s74, 0
    s_cbranch_scc1 L_cs2_2
L_csr2_2:
    s_waitcnt vmcnt(10)
    s_barrier
    s_cmp_eq_u32 s29, s76
    s_cbranch_scc1 L_sig2
L_sigr2:
    v_mfma_f32_16x16x32_bf16 v[52:55], a[100:103], a[184:187], v[52:55]
    ds_read_b128 a[192:195], v17 offset:8192
    v_mfma_f32_16x16x32_bf16 v[44:47], a[100:103], a[180:183], v[44:47]
    ds_read_b128 a[196:199], v17 offset:10240
    v_mfma_f32_16x16x32_bf16 v[36:39], a[100:103], a[176:179], v[36:39]
    ds_read_b128 a[200:203], v17 offset:12288
    v_mfma_f32_16x16x32_bf16 v[64:67], a[104:107], a[176:179], v[64:67]
    ds_read_b128 a[204:207], v17 offset:14336
    v_mfma_f32_16x16x32_bf16 v[72:75], a[104:107], a[180:183], v[72:75]
    ds_read_b64_tr_b16 a[96:97], v12 offset:20480
    v_mfma_f32_16x16x32_bf16 v[80:83], a[104:107], a[184:187], v[80:83]
    ds_read_b64_tr_b16 a[98:99], v12 offset:21504
    v_mfma_f32_16x16x32_bf16 v[88:91], a[104:107], a[188:191], v[88:91]
    ds_read_b64_tr_b16 a[100:101], v13 offset:20480
    v_mfma_f32_16x16x32_bf16 v[92:95], a[108:111], a[188:191], v[92:95]
    ds_read_b64_tr_b16 a[102:103], v13 offset:21504
    v_mfma_f32_16x16x32_bf16 v[84:87], a[108:111], a[184:187], v[84:87]
    s_add_u32 m0, s42, 5120
    s_add_u32 s35, s34, 81920
    v_mfma_f32_16x16x32_bf16 v[76:79], a[108:111], a[180:183], v[76:79]
    buffer_load_dwordx4 v3, s[20:23], s35 offen lds
    v_mfma_f32_16x16x32_bf16 v[68:71], a[108:111], a[176:179], v[68:71]
    ds_read_b64_tr_b16 a[104:105], v14 offset:20480
    v_mfma_f32_16x16x32_bf16 v[96:99], a[176:179], a[112:115], v[96:99]
    ds_read_b64_tr_b16 a[106:107], v14 offset:21504
    v_mfma_f32_16x16x32_bf16 v[104:107], a[180:183], a[112:115], v[104:107]
    ds_read_b64_tr_b16 a[108:109], v15 offset:20480
    v_mfma_f32_16x16x32_bf16 v[112:115], a[184:187], a[112:115], v[112:115]
    ds_read_b64_tr_b16 a[110:111], v15 offset:21504
    v_mfma_f32_16x16x32_bf16 v[120:123], a[188:191], a[112:115], v[120:123]
    ds_read_b64_tr_b16 a[112:113], v12 offset:24576
    v_mfma_f32_16x16x32_bf16 v[124:127], a[188:191], a[116:119], v[124:127]
    ds_read_b64_tr_b16 a[114:115], v12 offset:25600
    v_mfma_f32_16x16x32_bf16 v[116:119], a[184:187], a[116:119], v[116:119]
    s_add_u32 m0, s41, 20480
    v_mfma_f32_16x16x32_bf16 v[108:111], a[180:183], a[116:119], v[108:111]
    buffer_load_dwordx4 v4, s[8:11], s33 offen lds
    v_mfma_f32_16x16x32_bf16 v[100:103], a[176:179], a[116:119], v[100:103]
    ds_read_b64_tr_b16 a[116:117], v13 offset:24576
    s_waitcnt lgkmcnt(8)
    v_mfma_f32_16x16x32_bf16 v[128:131], a[176:179], a[120:123], v[128:131]
    ds_read_b64_tr_b16 a[118:119], v13 offset:25600
    v_mfma_f32_16x16x32_bf16 v[136:139], a[180:183], a[120:123], v[136:139]
    v_mfma_f32_16x16x32_bf16 v[144:147], a[184:187], a[120:123], v[144:147]
    v_mfma_f32_16x16x32_bf16 v[152:155], a[188:191], a[120:123], v[152:155]
    ds_read_b64_tr_b16 a[120:121], v14 offset:24576
    v_mfma_f32_16x16x32_bf16 v[156:159], a[188:191], a[124:127], v[156:159]
    ds_read_b64_tr_b16 a[122:123], v14 offset:25600
    v_mfma_f32_16x16x32_bf16 v[148:151], a[184:187], a[124:127], v[148:151]
    s_add_u32 m0, s42, 6144
    s_add_u32 s35, s34, 98304
    v_mfma_f32_16x16x32_bf16 v[140:143], a[180:183], a[124:127], v[140:143]
    buffer_load_dwordx4 v2, s[20:23], s35 offen lds
    v_mfma_f32_16x16x32_bf16 v[132:135], a[176:179], a[124:127], v[132:135]
    ds_read_b64_tr_b16 a[124:125], v15 offset:24576
    v_mfma_f32_16x16x32_bf16 v[160:163], a[176:179], a[128:131], v[160:163]
    ds_read_b64_tr_b16 a[126:127], v15 offset:25600
    v_mfma_f32_16x16x32_bf16 v[168:171], a[180:183], a[128:131], v[168:171]
    v_mfma_f32_16x16x32_bf16 v[176:179], a[184:187], a[128:131], v[176:179]
    v_mfma_f32_16x16x32_bf16 v[184:187], a[188:191], a[128:131], v[184:187]
    ds_read_b64_tr_b16 a[128:129], v12 offset:28672
    v_mfma_f32_16x16x32_bf16 v[188:191], a[188:191], a[132:135], v[188:191]
    ds_read_b64_tr_b16 a[130:131], v12 offset:29696
    v_mfma_f32_16x16x32_bf16 v[180:183], a[184:187], a[132:135], v[180:183]
    s_add_u32 m0, s41, 24576
    v_mfma_f32_16x16x32_bf16 v[172:175], a[180:183], a[132:135], v[172:175]
    buffer_load_dwordx4 v6, s[8:11], s33 offen lds
    v_mfma_f32_16x16x32_bf16 v[164:167], a[176:179], a[132:135], v[164:167]
    ds_read_b64_tr_b16 a[132:133], v13 offset:28672
    v_mfma_f32_16x16x32_bf16 v[192:195], a[176:179], a[136:139], v[192:195]
    ds_read_b64_tr_b16 a[134:135], v13 offset:29696
    v_mfma_f32_16x16x32_bf16 v[200:203], a[180:183], a[136:139], v[200:203]
    v_mfma_f32_16x16x32_bf16 v[208:211], a[184:187], a[136:139], v[208:211]
    v_mfma_f32_16x16x32_bf16 v[216:219], a[188:191], a[136:139], v[216:219]
    ds_read_b64_tr_b16 a[136:137], v14 offset:28672
    s_waitcnt lgkmcnt(8)
    v_mfma_f32_16x16x32_bf16 v[220:223], a[188:191], a[140:143], v[220:223]
    ds_read_b64_tr_b16 a[138:139], v14 offset:29696
    v_mfma_f32_16x16x32_bf16 v[212:215], a[184:187], a[140:143], v[212:215]
    s_add_u32 m0, s42, 7168
    s_add_u32 s35, s34, 114688
    v_mfma_f32_16x16x32_bf16 v[204:207], a[180:183], a[140:143], v[204:207]
    buffer_load_dwordx4 v3, s[20:23], s35 offen lds
    s_add_u32 s34, s34, 128
    v_mfma_f32_16x16x32_bf16 v[196:199], a[176:179], a[140:143], v[196:199]
    ds_read_b64_tr_b16 a[140:141], v15 offset:28672
    v_mfma_f32_16x16x32_bf16 a[0:3], a[176:179], a[144:147], a[0:3]
    ds_read_b64_tr_b16 a[142:143], v15 offset:29696
    v_mfma_f32_16x16x32_bf16 a[8:11], a[180:183], a[144:147], a[8:11]
    v_mfma_f32_16x16x32_bf16 a[16:19], a[184:187], a[144:147], a[16:19]
    v_mfma_f32_16x16x32_bf16 a[24:27], a[188:191], a[144:147], a[24:27]
    ds_read_b64_tr_b16 a[144:145], v12 offset:32768
    v_mfma_f32_16x16x32_bf16 a[28:31], a[188:191], a[148:151], a[28:31]
    ds_read_b64_tr_b16 a[146:147], v12 offset:33792
    v_mfma_f32_16x16x32_bf16 a[20:23], a[184:187], a[148:151], a[20:23]
    s_add_u32 m0, s41, 28544
    v_mfma_f32_16x16x32_bf16 a[12:15], a[180:183], a[148:151], a[12:15]
    buffer_load_dwordx4 v6, s[8:11], s33 offen offset:128 lds
    v_mfma_f32_16x16x32_bf16 a[4:7], a[176:179], a[148:151], a[4:7]
    ds_read_b64_tr_b16 a[148:149], v13 offset:32768
    v_mfma_f32_16x16x32_bf16 a[32:35], a[176:179], a[152:155], a[32:35]
    ds_read_b64_tr_b16 a[150:151], v13 offset:33792
    v_mfma_f32_16x16x32_bf16 a[40:43], a[180:183], a[152:155], a[40:43]
    v_mfma_f32_16x16x32_bf16 a[48:51], a[184:187], a[152:155], a[48:51]
    v_mfma_f32_16x16x32_bf16 a[56:59], a[188:191], a[152:155], a[56:59]
    ds_read_b64_tr_b16 a[152:153], v14 offset:32768
    v_mfma_f32_16x16x32_bf16 a[60:63], a[188:191], a[156:159], a[60:63]
    ds_read_b64_tr_b16 a[154:155], v14 offset:33792
    v_mfma_f32_16x16x32_bf16 a[52:55], a[184:187], a[156:159], a[52:55]
    s_add_u32 m0, s41, 32512
    v_mfma_f32_16x16x32_bf16 a[44:47], a[180:183], a[156:159], a[44:47]
    buffer_load_dwordx4 v6, s[8:11], s33 offen offset:256 lds
    v_mfma_f32_16x16x32_bf16 a[36:39], a[176:179], a[156:159], a[36:39]
    ds_read_b64_tr_b16 a[156:157], v15 offset:32768
    s_waitcnt lgkmcnt(8)
    v_mfma_f32_16x16x32_bf16 a[64:67], a[176:179], a[160:163], a[64:67]
    ds_read_b64_tr_b16 a[158:159], v15 offset:33792
    v_mfma_f32_16x16x32_bf16 a[72:75], a[180:183], a[160:163], a[72:75]
    v_mfma_f32_16x16x32_bf16 a[80:83], a[184:187], a[160:163], a[80:83]
    v_mfma_f32_16x16x32_bf16 a[88:91], a[188:191], a[160:163], a[88:91]
    ds_read_b64_tr_b16 a[160:161], v12 offset:36864
    v_mfma_f32_16x16x32_bf16 a[92:95], a[188:191], a[164:167], a[92:95]
    ds_read_b64_tr_b16 a[162:163], v12 offset:37888
    v_mfma_f32_16x16x32_bf16 a[84:87], a[184:187], a[164:167], a[84:87]
    s_add_u32 m0, s41, 36480
    v_mfma_f32_16x16x32_bf16 a[76:79], a[180:183], a[164:167], a[76:79]
    buffer_load_dwordx4 v6, s[8:11], s33 offen offset:384 lds
    s_add_u32 s33, s33, 196608
    v_mfma_f32_16x16x32_bf16 a[68:71], a[176:179], a[164:167], a[68:71]
    ds_read_b64_tr_b16 a[164:165], v13 offset:36864
    v_mfma_f32_16x16x32_bf16 v[224:227], a[176:179], a[168:171], v[224:227]
    ds_read_b64_tr_b16 a[166:167], v13 offset:37888
    v_mfma_f32_16x16x32_bf16 v[232:235], a[180:183], a[168:171], v[232:235]
    v_mfma_f32_16x16x32_bf16 v[240:243], a[184:187], a[168:171], v[240:243]
    v_mfma_f32_16x16x32_bf16 v[248:251], a[188:191], a[168:171], v[248:251]
    ds_read_b64_tr_b16 a[168:169], v14 offset:36864
    v_mfma_f32_16x16x32_bf16 v[252:255], a[188:191], a[172:175], v[252:255]
    ds_read_b64_tr_b16 a[170:171], v14 offset:37888
    v_mfma_f32_16x16x32_bf16 v[244:247], a[184:187], a[172:175], v[244:247]
    v_mfma_f32_16x16x32_bf16 v[236:239], a[180:183], a[172:175], v[236:239]
    v_mfma_f32_16x16x32_bf16 v[228:231], a[176:179], a[172:175], v[228:231]
    ds_read_b64_tr_b16 a[172:173], v15 offset:36864
    ds_read_b64_tr_b16 a[174:175], v15 offset:37888
    v_mfma_f32_16x16x32_bf16 v[32:35], a[96:99], a[192:195], v[32:35]
    v_mfma_f32_16x16x32_bf16 v[40:43], a[96:99], a[196:199], v[40:43]
    v_mfma_f32_16x16x32_bf16 v[48:51], a[96:99], a[200:203], v[48:51]
    v_mfma_f32_16x16x32_bf16 v[56:59], a[96:99], a[204:207], v[56:59]
    s_waitcnt lgkmcnt(8)
    v_mfma_f32_16x16x32_bf16 v[60:63], a[100:103], a[204:207], v[60:63]
    s_cmp_lg_u32 s74, 0
    s_cbranch_scc1 L_cs2_3
L_csr2_3:
    s_waitcnt vmcnt(3)
    s_barrier
    v_mfma_f32_16x16x32_bf16 v[52:55], a[100:103], a[200:203], v[52:55]
    ds_read_b128 a[176:179], v16 offset:0
    v_mfma_f32_16x16x32_bf16 v[44:47], a[100:103], a[196:199], v[44:47]
    ds_read_b128 a[180:183], v16 offset:2048
    v_mfma_f32_16x16x32_bf16 v[36:39], a[100:103], a[192:195], v[36:39]
    ds_read_b128 a[184:187], v16 offset:4096
    v_mfma_f32_16x16x32_bf16 v[64:67], a[104:107], a[192:195], v[64:67]
    ds_read_b128 a[188:191], v16 offset:6144
    v_mfma_f32_16x16x32_bf16 v[72:75], a[104:107], a[196:199], v[72:75]
    ds_read_b64_tr_b16 a[96:97], v8 offset:0
    v_mfma_f32_16x16x32_bf16 v[80:83], a[104:107], a[200:203], v[80:83]
    s_cmp_eq_u32 s29, 1
    s_cselect_b32 s50, 0, 0x1000
    buffer_load_dword v24, off, s[24:27], s50 sc1
    ds_read_b64_tr_b16 a[98:99], v8 offset:1024
    v_mfma_f32_16x16x32_bf16 v[88:91], a[104:107], a[204:207], v[88:91]
    ds_read_b64_tr_b16 a[100:101], v9 offset:0
    v_mfma_f32_16x16x32_bf16 v[92:95], a[108:111], a[204:207], v[92:95]
    ds_read_b64_tr_b16 a[102:103], v9 offset:1024
    v_mfma_f32_16x16x32_bf16 v[84:87], a[108:111], a[200:203], v[84:87]
    s_add_u32 m0, s42, 8192
    s_add_u32 s35, s34, 0
    v_mfma_f32_16x16x32_bf16 v[76:79], a[108:111], a[196:199], v[76:79]
    buffer_load_dwordx4 v2, s[20:23], s35 offen lds
    v_mfma_f32_16x16x32_bf16 v[68:71], a[108:111], a[192:195], v[68:71]
    ds_read_b64_tr_b16 a[104:105], v10 offset:0
    v_mfma_f32_16x16x32_bf16 v[96:99], a[192:195], a[112:115], v[96:99]
    ds_read_b64_tr_b16 a[106:107], v10 offset:1024
    v_mfma_f32_16x16x32_bf16 v[104:107], a[196:199], a[112:115], v[104:107]
    s_add_u32 m0, s41, 40960
    v_mfma_f32_16x16x32_bf16 v[112:115], a[200:203], a[112:115], v[112:115]
    buffer_load_dwordx4 v4, s[8:11], s33 offen lds
    v_mfma_f32_16x16x32_bf16 v[120:123], a[204:207], a[112:115], v[120:123]
    ds_read_b64_tr_b16 a[108:109], v11 offset:0
    v_mfma_f32_16x16x32_bf16 v[124:127], a[204:207], a[116:119], v[124:127]
    ds_read_b64_tr_b16 a[110:111], v11 offset:1024
    v_mfma_f32_16x16x32_bf16 v[116:119], a[200:203], a[116:119], v[116:119]
    ds_read_b64_tr_b16 a[112:113], v8 offset:4096
    v_mfma_f32_16x16x32_bf16 v[108:111], a[196:199], a[116:119], v[108:111]
    ds_read_b64_tr_b16 a[114:115], v8 offset:5120
    v_mfma_f32_16x16x32_bf16 v[100:103], a[192:195], a[116:119], v[100:103]
    ds_read_b64_tr_b16 a[116:117], v9 offset:4096
    s_waitcnt lgkmcnt(8)
    v_mfma_f32_16x16x32_bf16 v[128:131], a[192:195], a[120:123], v[128:131]
    ds_read_b64_tr_b16 a[118:119], v9 offset:5120
    v_mfma_f32_16x16x32_bf16 v[136:139], a[196:199], a[120:123], v[136:139]
    s_add_u32 m0, s42, 9216
    s_add_u32 s35, s34, 16384
    v_mfma_f32_16x16x32_bf16 v[144:147], a[200:203], a[120:123], v[144:147]
    buffer_load_dwordx4 v3, s[20:23], s35 offen lds
    v_mfma_f32_16x16x32_bf16 v[152:155], a[204:207], a[120:123], v[152:155]
    ds_read_b64_tr_b16 a[120:121], v10 offset:4096
    v_mfma_f32_16x16x32_bf16 v[156:159], a[204:207], a[124:127], v[156:159]
    ds_read_b64_tr_b16 a[122:123], v10 offset:5120
    v_mfma_f32_16x16x32_bf16 v[148:151], a[200:203], a[124:127], v[148:151]
    v_mfma_f32_16x16x32_bf16 v[140:143], a[196:199], a[124:127], v[140:143]
    v_and_b32 v23, 15, v1
    v_lshrrev_b32 v21, 4, v1
    v_mfma_f32_16x16x32_bf16 v[132:135], a[192:195], a[124:127], v[132:135]
    ds_read_b64_tr_b16 a[124:125], v11 offset:4096
    v_mfma_f32_16x16x32_bf16 v[160:163], a[192:195], a[128:131], v[160:163]
    ds_read_b64_tr_b16 a[126:127], v11 offset:5120
    v_mfma_f32_16x16x32_bf16 v[168:171], a[196:199], a[128:131], v[168:171]
    s_add_u32 m0, s41, 45056
    v_mfma_f32_16x16x32_bf16 v[176:179], a[200:203], a[128:131], v[176:179]
    v_lshlrev_b32 v23, 2, v23
    v_lshrrev_b32 v22, 5, v1
    buffer_load_dwordx4 v6, s[8:11], s33 offen lds
    v_mfma_f32_16x16x32_bf16 v[184:187], a[204:207], a[128:131], v[184:187]
    ds_read_b64_tr_b16 a[128:129], v8 offset:8192
    v_mfma_f32_16x16x32_bf16 v[188:191], a[204:207], a[132:135], v[188:191]
    ds_read_b64_tr_b16 a[130:131], v8 offset:9216
    v_mfma_f32_16x16x32_bf16 v[180:183], a[200:203], a[132:135], v[180:183]
    s_add_u32 m0, s42, 10240
    s_add_u32 s35, s34, 32768
    v_mfma_f32_16x16x32_bf16 v[172:175], a[196:199], a[132:135], v[172:175]
    v_mul_u32_u24 v20, 1280, v21
    v_lshl_add_u32 v22, v22, 6, v23
    buffer_load_dwordx4 v2, s[20:23], s35 offen lds
    v_mfma_f32_16x16x32_bf16 v[164:167], a[192:195], a[132:135], v[164:167]
    ds_read_b64_tr_b16 a[132:133], v9 offset:8192
    v_mfma_f32_16x16x32_bf16 v[192:195], a[192:195], a[136:139], v[192:195]
    ds_read_b64_tr_b16 a[134:135], v9 offset:9216
    v_mfma_f32_16x16x32_bf16 v[200:203], a[196:199], a[136:139], v[200:203]
    v_mfma_f32_16x16x32_bf16 v[208:211], a[200:203], a[136:139], v[208:211]
    v_add_u32 v20, v20, v23
    s_mul_i32 s48, s56, 10240
    v_mfma_f32_16x16x32_bf16 v[216:219], a[204:207], a[136:139], v[216:219]
    ds_read_b64_tr_b16 a[136:137], v10 offset:8192
    s_waitcnt lgkmcnt(8)
    v_mfma_f32_16x16x32_bf16 v[220:223], a[204:207], a[140:143], v[220:223]
    ds_read_b64_tr_b16 a[138:139], v10 offset:9216
    v_mfma_f32_16x16x32_bf16 v[212:215], a[200:203], a[140:143], v[212:215]
    s_add_u32 m0, s41, 49024
    v_mfma_f32_16x16x32_bf16 v[204:207], a[196:199], a[140:143], v[204:207]
    v_add_u32 v21, 5120, v20
    s_mul_i32 s49, s28, 320
    buffer_load_dwordx4 v6, s[8:11], s33 offen offset:128 lds
    v_mfma_f32_16x16x32_bf16 v[196:199], a[192:195], a[140:143], v[196:199]
    ds_read_b64_tr_b16 a[140:141], v11 offset:8192
    v_mfma_f32_16x16x32_bf16 a[0:3], a[192:195], a[144:147], a[0:3]
    ds_read_b64_tr_b16 a[142:143], v11 offset:9216
    v_mfma_f32_16x16x32_bf16 a[8:11], a[196:199], a[144:147], a[8:11]
    v_mfma_f32_16x16x32_bf16 a[16:19], a[200:203], a[144:147], a[16:19]
    s_add_u32 s48, s48, s49
    s_add_u32 s48, s48, 0x10000
    v_mfma_f32_16x16x32_bf16 a[24:27], a[204:207], a[144:147], a[24:27]
    ds_read_b64_tr_b16 a[144:145], v8 offset:12288
    v_mfma_f32_16x16x32_bf16 a[28:31], a[204:207], a[148:151], a[28:31]
    ds_read_b64_tr_b16 a[146:147], v8 offset:13312
    v_mfma_f32_16x16x32_bf16 a[20:23], a[200:203], a[148:151], a[20:23]
    s_add_u32 m0, s42, 11264
    s_add_u32 s35, s34, 49152
    v_mfma_f32_16x16x32_bf16 a[12:15], a[196:199], a[148:151], a[12:15]
    s_lshl_b32 s49, s57, 2
    s_add_u32 s49, s49, s28
    buffer_load_dwordx4 v3, s[20:23], s35 offen lds
    v_mfma_f32_16x16x32_bf16 a[4:7], a[192:195], a[148:151], a[4:7]
    ds_read_b64_tr_b16 a[148:149], v9 offset:12288
    v_mfma_f32_16x16x32_bf16 a[32:35], a[192:195], a[152:155], a[32:35]
    ds_read_b64_tr_b16 a[150:151], v9 offset:13312
    v_mfma_f32_16x16x32_bf16 a[40:43], a[196:199], a[152:155], a[40:43]
    s_add_u32 m0, s41, 52992
    v_mfma_f32_16x16x32_bf16 a[48:51], a[200:203], a[152:155], a[48:51]
    s_lshl_b32 s49, s49, 9
    buffer_load_dwordx4 v6, s[8:11], s33 offen offset:256 lds
    v_mfma_f32_16x16x32_bf16 a[56:59], a[204:207], a[152:155], a[56:59]
    ds_read_b64_tr_b16 a[152:153], v10 offset:12288
    v_mfma_f32_16x16x32_bf16 a[60:63], a[204:207], a[156:159], a[60:63]
    ds_read_b64_tr_b16 a[154:155], v10 offset:13312
    v_mfma_f32_16x16x32_bf16 a[52:55], a[200:203], a[156:159], a[52:55]
    v_mfma_f32_16x16x32_bf16 a[44:47], a[196:199], a[156:159], a[44:47]
    v_mfma_f32_16x16x32_bf16 a[36:39], a[192:195], a[156:159], a[36:39]
    ds_read_b64_tr_b16 a[156:157], v11 offset:12288
    s_waitcnt lgkmcnt(8)
    v_mfma_f32_16x16x32_bf16 a[64:67], a[192:195], a[160:163], a[64:67]
    ds_read_b64_tr_b16 a[158:159], v11 offset:13312
    v_mfma_f32_16x16x32_bf16 a[72:75], a[196:199], a[160:163], a[72:75]
    s_add_u32 m0, s42, 12288
    s_add_u32 s35, s34, 65536
    v_mfma_f32_16x16x32_bf16 a[80:83], a[200:203], a[160:163], a[80:83]
    buffer_load_dwordx4 v2, s[20:23], s35 offen lds
    v_mfma_f32_16x16x32_bf16 a[88:91], a[204:207], a[160:163], a[88:91]
    ds_read_b64_tr_b16 a[160:161], v8 offset:16384
    v_mfma_f32_16x16x32_bf16 a[92:95], a[204:207], a[164:167], a[92:95]
    ds_read_b64_tr_b16 a[162:163], v8 offset:17408
    v_mfma_f32_16x16x32_bf16 a[84:87], a[200:203], a[164:167], a[84:87]
    v_mfma_f32_16x16x32_bf16 a[76:79], a[196:199], a[164:167], a[76:79]
    v_mfma_f32_16x16x32_bf16 a[68:71], a[192:195], a[164:167], a[68:71]
    ds_read_b64_tr_b16 a[164:165], v9 offset:16384
    v_mfma_f32_16x16x32_bf16 v[224:227], a[192:195], a[168:171], v[224:227]
    ds_read_b64_tr_b16 a[166:167], v9 offset:17408
    v_mfma_f32_16x16x32_bf16 v[232:235], a[196:199], a[168:171], v[232:235]
    s_add_u32 m0, s41, 56960
    v_mfma_f32_16x16x32_bf16 v[240:243], a[200:203], a[168:171], v[240:243]
    buffer_load_dwordx4 v6, s[8:11], s33 offen offset:384 lds
    s_add_u32 s33, s33, 196608
    v_mfma_f32_16x16x32_bf16 v[248:251], a[204:207], a[168:171], v[248:251]
    ds_read_b64_tr_b16 a[168:169], v10 offset:16384
    v_mfma_f32_16x16x32_bf16 v[252:255], a[204:207], a[172:175], v[252:255]
    ds_read_b64_tr_b16 a[170:171], v10 offset:17408
    v_mfma_f32_16x16x32_bf16 v[244:247], a[200:203], a[172:175], v[244:247]
    v_mfma_f32_16x16x32_bf16 v[236:239], a[196:199], a[172:175], v[236:239]
    v_mfma_f32_16x16x32_bf16 v[228:231], a[192:195], a[172:175], v[228:231]
    ds_read_b64_tr_b16 a[172:173], v11 offset:16384
    ds_read_b64_tr_b16 a[174:175], v11 offset:17408
    s_cmp_eq_u32 s29, s75
    s_cbranch_scc1 L_cst2
L_cstr2:
    s_sub_u32 s77, s29, 1
    s_cmp_eq_u32 s77, s75
    s_cselect_b32 s74, 1, 0
    s_sub_u32 s29, s29, 1
    s_cmp_lg_u32 s29, 0
    s_cbranch_scc1 L_g1_loop2
L_g1_tail2:
    v_mfma_f32_16x16x32_bf16 v[32:35], a[96:99], a[176:179], v[32:35]
    s_waitcnt vmcnt(10)
    v_readfirstlane_b32 s77, v24
    s_cmp_lt_u32 s77, 256
    s_cbranch_scc1 L_slow2
L_slowr2:
    v_mfma_f32_16x16x32_bf16 v[40:43], a[96:99], a[180:183], v[40:43]
    buffer_load_dword v28, v23, s[4:7], s49 offen offset:256 sc1
    v_mfma_f32_16x16x32_bf16 v[48:51], a[96:99], a[184:187], v[48:51]
    v_mfma_f32_16x16x32_bf16 v[56:59], a[96:99], a[188:191], v[56:59]
    buffer_load_dword v29, v23, s[4:7], s49 offen offset:320 sc1
    v_mfma_f32_16x16x32_bf16 v[60:63], a[100:103], a[188:191], v[60:63]
    s_barrier
    ds_read_b64_tr_b16 a[96:97], v8 offset:20480
    v_mfma_f32_16x16x32_bf16 v[52:55], a[100:103], a[184:187], v[52:55]
    s_add_u32 m0, s42, 13312
    s_add_u32 s35, s34, 81920
    v_mfma_f32_16x16x32_bf16 v[44:47], a[100:103], a[180:183], v[44:47]
    buffer_load_dwordx4 v3, s[20:23], s35 offen lds
    v_mfma_f32_16x16x32_bf16 v[36:39], a[100:103], a[176:179], v[36:39]
    buffer_load_dword v30, v23, s[4:7], s49 offen offset:384 sc1
    v_mfma_f32_16x16x32_bf16 v[64:67], a[104:107], a[176:179], v[64:67]
    ds_read_b64_tr_b16 a[98:99], v8 offset:21504
    v_mfma_f32_16x16x32_bf16 v[72:75], a[104:107], a[180:183], v[72:75]
    s_add_u32 m0, s42, 14336
    s_add_u32 s35, s34, 98304
    v_mfma_f32_16x16x32_bf16 v[80:83], a[104:107], a[184:187], v[80:83]
    buffer_load_dwordx4 v2, s[20:23], s35 offen lds
    v_mfma_f32_16x16x32_bf16 v[88:91], a[104:107], a[188:191], v[88:91]
    buffer_load_dword v31, v23, s[4:7], s49 offen offset:448 sc1
    v_mfma_f32_16x16x32_bf16 v[92:95], a[108:111], a[188:191], v[92:95]
    ds_read_b64_tr_b16 a[100:101], v9 offset:20480
    v_mfma_f32_16x16x32_bf16 v[84:87], a[108:111], a[184:187], v[84:87]
    s_add_u32 m0, s42, 15360
    s_add_u32 s35, s34, 114688
    v_mfma_f32_16x16x32_bf16 v[76:79], a[108:111], a[180:183], v[76:79]
    buffer_load_dwordx4 v3, s[20:23], s35 offen lds
    v_mfma_f32_16x16x32_bf16 v[68:71], a[108:111], a[176:179], v[68:71]
    buffer_load_dword a228, v22, s[4:7], s49 offen offset:0 sc1
    v_mfma_f32_16x16x32_bf16 v[96:99], a[176:179], a[112:115], v[96:99]
    ds_read_b64_tr_b16 a[102:103], v9 offset:21504
    v_mfma_f32_16x16x32_bf16 v[104:107], a[180:183], a[112:115], v[104:107]
    s_add_u32 m0, s41, 61440
    v_mfma_f32_16x16x32_bf16 v[112:115], a[184:187], a[112:115], v[112:115]
    buffer_load_dwordx4 v4, s[8:11], s33 offen lds
    v_mfma_f32_16x16x32_bf16 v[120:123], a[188:191], a[112:115], v[120:123]
    buffer_load_dword a230, v22, s[4:7], s49 offen offset:128 sc1
    v_mfma_f32_16x16x32_bf16 v[124:127], a[188:191], a[116:119], v[124:127]
    ds_read_b64_tr_b16 a[104:105], v10 offset:20480
    v_mfma_f32_16x16x32_bf16 v[116:119], a[184:187], a[116:119], v[116:119]
    s_add_u32 m0, s41, 65536
    v_mfma_f32_16x16x32_bf16 v[108:111], a[180:183], a[116:119], v[108:111]
    buffer_load_dwordx4 v6, s[8:11], s33 offen lds
    v_mfma_f32_16x16x32_bf16 v[100:103], a[176:179], a[116:119], v[100:103]
    buffer_load_dword v22, v20, s[4:7], s48 offen offset:0 sc1
    v_mfma_f32_16x16x32_bf16 v[128:131], a[176:179], a[120:123], v[128:131]
    ds_read_b64_tr_b16 a[106:107], v10 offset:21504
    v_mfma_f32_16x16x32_bf16 v[136:139], a[180:183], a[120:123], v[136:139]
    s_add_u32 m0, s41, 69504
    v_mfma_f32_16x16x32_bf16 v[144:147], a[184:187], a[120:123], v[144:147]
    buffer_load_dwordx4 v6, s[8:11], s33 offen offset:128 lds
    v_mfma_f32_16x16x32_bf16 v[152:155], a[188:191], a[120:123], v[152:155]
    buffer_load_dword v23, v21, s[4:7], s48 offen offset:0 sc1
    v_mfma_f32_16x16x32_bf16 v[156:159], a[188:191], a[124:127], v[156:159]
    ds_read_b64_tr_b16 a[108:109], v11 offset:20480
    v_mfma_f32_16x16x32_bf16 v[148:151], a[184:187], a[124:127], v[148:151]
    s_add_u32 m0, s41, 73472
    v_mfma_f32_16x16x32_bf16 v[140:143], a[180:183], a[124:127], v[140:143]
    buffer_load_dwordx4 v6, s[8:11], s33 offen offset:256 lds
    v_mfma_f32_16x16x32_bf16 v[132:135], a[176:179], a[124:127], v[132:135]
    buffer_load_dword v24, v20, s[4:7], s48 offen offset:64 sc1
    v_mfma_f32_16x16x32_bf16 v[160:163], a[176:179], a[128:131], v[160:163]
    ds_read_b64_tr_b16 a[110:111], v11 offset:21504
    v_mfma_f32_16x16x32_bf16 v[168:171], a[180:183], a[128:131], v[168:171]
    s_add_u32 m0, s41, 77440
    v_mfma_f32_16x16x32_bf16 v[176:179], a[184:187], a[128:131], v[176:179]
    buffer_load_dwordx4 v6, s[8:11], s33 offen offset:384 lds
    v_mfma_f32_16x16x32_bf16 v[184:187], a[188:191], a[128:131], v[184:187]
    buffer_load_dword v25, v21, s[4:7], s48 offen offset:64 sc1
    v_mfma_f32_16x16x32_bf16 v[188:191], a[188:191], a[132:135], v[188:191]
    ds_read_b128 a[192:195], v17 offset:0
    v_and_b32 v0, 31, v1
    v_mfma_f32_16x16x32_bf16 v[180:183], a[184:187], a[132:135], v[180:183]
    buffer_load_dword v26, v20, s[4:7], s48 offen offset:128 sc1
    ds_read_b128 a[196:199], v17 offset:2048
    v_lshlrev_b32 v0, 3, v0
    v_mfma_f32_16x16x32_bf16 v[172:175], a[180:183], a[132:135], v[172:175]
    ds_read_b128 a[200:203], v17 offset:4096
    v_add_u32 v0, 147456, v0
    v_mfma_f32_16x16x32_bf16 v[164:167], a[176:179], a[132:135], v[164:167]
    buffer_load_dword v27, v21, s[4:7], s48 offen offset:128 sc1
    ds_read_b128 a[204:207], v17 offset:6144
    v_lshlrev_b32 v2, 4, v1
    v_mfma_f32_16x16x32_bf16 v[192:195], a[176:179], a[136:139], v[192:195]
    s_waitcnt vmcnt(20)
    s_barrier
    v_lshlrev_b32 v3, 4, v1
    ds_read_b64_tr_b16 a[112:113], v12 offset:0
    v_mfma_f32_16x16x32_bf16 v[200:203], a[180:183], a[136:139], v[200:203]
    buffer_load_dword v18, v20, s[4:7], s48 offen offset:192 sc1
    s_lshl_b32 s58, s57, 3
    v_mfma_f32_16x16x32_bf16 v[208:211], a[184:187], a[136:139], v[208:211]
    s_lshl_b32 s59, s28, 1
    ds_read_b64_tr_b16 a[114:115], v12 offset:1024
    v_mfma_f32_16x16x32_bf16 v[216:219], a[188:191], a[136:139], v[216:219]
    buffer_load_dword v19, v21, s[4:7], s48 offen offset:192 sc1
    s_add_u32 s58, s58, s59
    s_waitcnt lgkmcnt(8)
    v_mfma_f32_16x16x32_bf16 v[220:223], a[188:191], a[140:143], v[220:223]
    ds_read_b64_tr_b16 a[116:117], v13 offset:0
    v_mfma_f32_16x16x32_bf16 v[212:215], a[184:187], a[140:143], v[212:215]
    buffer_load_dword v20, v20, s[4:7], s48 offen offset:256 sc1
    s_and_b32 s60, s56, 15
    v_mfma_f32_16x16x32_bf16 v[204:207], a[180:183], a[140:143], v[204:207]
    s_lshl_b32 s60, s60, 7
    ds_read_b64_tr_b16 a[118:119], v13 offset:1024
    v_mfma_f32_16x16x32_bf16 v[196:199], a[176:179], a[140:143], v[196:199]
    buffer_load_dword v21, v21, s[4:7], s48 offen offset:256 sc1
    s_add_u32 s60, s60, s58
    v_mfma_f32_16x16x32_bf16 a[0:3], a[176:179], a[144:147], a[0:3]
    s_mov_b32 s62, 0x400000
    ds_read_b64_tr_b16 a[120:121], v14 offset:0
    v_mfma_f32_16x16x32_bf16 a[8:11], a[180:183], a[144:147], a[8:11]
    s_mov_b32 s44, 0x3e8293ee
    ds_read_b64_tr_b16 a[122:123], v14 offset:1024
    v_mfma_f32_16x16x32_bf16 a[16:19], a[184:187], a[144:147], a[16:19]
    s_cmp_ge_u32 s56, 16
    ds_read_b64_tr_b16 a[124:125], v15 offset:0
    v_mfma_f32_16x16x32_bf16 a[24:27], a[188:191], a[144:147], a[24:27]
    s_cselect_b32 s61, 12, 11
    ds_read_b64_tr_b16 a[126:127], v15 offset:1024
    v_mfma_f32_16x16x32_bf16 a[28:31], a[188:191], a[148:151], a[28:31]
    s_cselect_b32 s62, 0x800000, s62
    ds_read_b64_tr_b16 a[128:129], v8 offset:24576
    v_mfma_f32_16x16x32_bf16 a[20:23], a[184:187], a[148:151], a[20:23]
    ds_read_b64_tr_b16 a[130:131], v8 offset:25600
    v_mfma_f32_16x16x32_bf16 a[12:15], a[180:183], a[148:151], a[12:15]
    s_cselect_b32 s44, 1.0, s44
    v_mfma_f32_16x16x32_bf16 a[4:7], a[176:179], a[148:151], a[4:7]
    s_add_u32 s64, s60, 0
    v_mfma_f32_16x16x32_bf16 a[32:35], a[176:179], a[152:155], a[32:35]
    s_lshl_b32 s64, s64, s61
    ds_read_b64_tr_b16 a[132:133], v9 offset:24576
    v_mfma_f32_16x16x32_bf16 a[40:43], a[180:183], a[152:155], a[40:43]
    s_add_u32 s64, s64, s62
    ds_read_b64_tr_b16 a[134:135], v9 offset:25600
    v_mfma_f32_16x16x32_bf16 a[48:51], a[184:187], a[152:155], a[48:51]
    s_add_u32 s65, s60, 1
    v_mfma_f32_16x16x32_bf16 a[56:59], a[188:191], a[152:155], a[56:59]
    s_lshl_b32 s65, s65, s61
    v_mfma_f32_16x16x32_bf16 a[60:63], a[188:191], a[156:159], a[60:63]
    s_add_u32 s65, s65, s62
    ds_read_b64_tr_b16 a[136:137], v8 offset:32768
    v_mfma_f32_16x16x32_bf16 a[52:55], a[184:187], a[156:159], a[52:55]
    s_add_u32 s66, s60, 64
    ds_read_b64_tr_b16 a[138:139], v8 offset:33792
    v_mfma_f32_16x16x32_bf16 a[44:47], a[180:183], a[156:159], a[44:47]
    v_mfma_f32_16x16x32_bf16 a[36:39], a[176:179], a[156:159], a[36:39]
    s_lshl_b32 s66, s66, s61
    v_mfma_f32_16x16x32_bf16 a[64:67], a[176:179], a[160:163], a[64:67]
    s_add_u32 s66, s66, s62
    ds_read_b64_tr_b16 a[140:141], v9 offset:32768
    v_mfma_f32_16x16x32_bf16 a[72:75], a[180:183], a[160:163], a[72:75]
    s_add_u32 s67, s60, 65
    ds_read_b64_tr_b16 a[142:143], v9 offset:33792
    v_mfma_f32_16x16x32_bf16 a[80:83], a[184:187], a[160:163], a[80:83]
    s_lshl_b32 s67, s67, s61
    v_mfma_f32_16x16x32_bf16 a[88:91], a[188:191], a[160:163], a[88:91]
    s_add_u32 s67, s67, s62
    v_mfma_f32_16x16x32_bf16 a[92:95], a[188:191], a[164:167], a[92:95]
    s_sub_u32 s60, s56, 28
    ds_read_b64_tr_b16 a[144:145], v12 offset:4096
    v_mfma_f32_16x16x32_bf16 a[84:87], a[184:187], a[164:167], a[84:87]
    s_lshl_b32 s60, s60, 9
    ds_read_b64_tr_b16 a[146:147], v12 offset:5120
    v_mfma_f32_16x16x32_bf16 a[76:79], a[180:183], a[164:167], a[76:79]
    s_add_u32 s60, s60, s58
    v_mfma_f32_16x16x32_bf16 a[68:71], a[176:179], a[164:167], a[68:71]
    v_mfma_f32_16x16x32_bf16 v[224:227], a[176:179], a[168:171], v[224:227]
    s_waitcnt vmcnt(17)
    ds_read_b128 a[240:243], v16 offset:8192
    s_lshl_b32 s60, s60, 12
    v_mfma_f32_16x16x32_bf16 v[232:235], a[180:183], a[168:171], v[232:235]
    ds_read_b128 a[244:247], v16 offset:10240
    s_add_u32 s70, s60, 0x800000
    v_mfma_f32_16x16x32_bf16 v[240:243], a[184:187], a[168:171], v[240:243]
    ds_read_b128 a[248:251], v16 offset:12288
    s_mul_i32 s77, s28, 640
    v_mfma_f32_16x16x32_bf16 v[248:251], a[188:191], a[168:171], v[248:251]
    ds_read_b128 a[252:255], v16 offset:14336
    s_add_u32 s77, s77, 147456
    v_mfma_f32_16x16x32_bf16 v[252:255], a[188:191], a[172:175], v[252:255]
    s_mov_b32 s72, 0xffff0000
    ds_read_b64_tr_b16 a[148:149], v13 offset:4096
    v_mfma_f32_16x16x32_bf16 v[244:247], a[184:187], a[172:175], v[244:247]
    s_mov_b32 s73, 0x07060302
    ds_read_b64_tr_b16 a[150:151], v13 offset:5120
    v_mfma_f32_16x16x32_bf16 v[236:239], a[180:183], a[172:175], v[236:239]
    v_and_b32 v7, 48, v1
    ds_read_b64_tr_b16 a[152:153], v12 offset:12288
    v_mfma_f32_16x16x32_bf16 v[228:231], a[176:179], a[172:175], v[228:231]
    ds_read_b64_tr_b16 a[154:155], v12 offset:13312
    s_waitcnt lgkmcnt(8)
    v_mfma_f32_16x16x32_bf16 v[32:35], a[96:99], a[192:195], v[32:35]
    ds_read_b128 a[176:179], v17 offset:8192
    s_waitcnt vmcnt(0)
    v_add_f32 v20, v20, v21
    v_add_f32 v22, v22, v23
    v_mfma_f32_16x16x32_bf16 v[40:43], a[96:99], a[196:199], v[40:43]
    ds_read_b128 a[180:183], v17 offset:10240
    v_add_f32 v26, v26, v27
    v_mov_b32 v21, v20
    v_mfma_f32_16x16x32_bf16 v[48:51], a[96:99], a[200:203], v[48:51]
    ds_read_b128 a[184:187], v17 offset:12288
    v_add_f32 v24, v24, v25
    v_add_f32 v18, v18, v19
    v_mfma_f32_16x16x32_bf16 v[56:59], a[96:99], a[204:207], v[56:59]
    ds_read_b128 a[188:191], v17 offset:14336
    v_accvgpr_mov_b32 a229, a228
    v_permlane32_swap_b32 v20, v21
    v_mfma_f32_16x16x32_bf16 v[60:63], a[100:103], a[204:207], v[60:63]
    v_permlane32_swap_b32 v22, v26
    v_permlane32_swap_b32 v24, v18
    ds_read_b64_tr_b16 a[156:157], v13 offset:12288
    v_mfma_f32_16x16x32_bf16 v[52:55], a[100:103], a[200:203], v[52:55]
    v_add_f32 v20, v20, v21
    v_add_f32 v22, v22, v26
    ds_read_b64_tr_b16 a[158:159], v13 offset:13312
    v_mfma_f32_16x16x32_bf16 v[44:47], a[100:103], a[196:199], v[44:47]
    v_add_f32 v24, v24, v18
    v_mov_b32 v21, v20
    v_mfma_f32_16x16x32_bf16 v[36:39], a[100:103], a[192:195], v[36:39]
    v_accvgpr_mov_b32 a231, a230
    v_lshl_add_u32 v16, v1, 3, s77
    v_mfma_f32_16x16x32_bf16 v[64:67], a[104:107], a[192:195], v[64:67]
    v_permlane16_swap_b32 v22, v24
    v_permlane16_swap_b32 v20, v21
    v_mfma_f32_16x16x32_bf16 v[72:75], a[104:107], a[196:199], v[72:75]
    v_add_f32 v22, v22, v24
    v_add_f32 v20, v20, v21
    v_mfma_f32_16x16x32_bf16 v[80:83], a[104:107], a[200:203], v[80:83]
    v_and_b32 v17, 15, v1
    v_and_b32 v24, s72, v22
    v_mfma_f32_16x16x32_bf16 v[88:91], a[104:107], a[204:207], v[88:91]
    v_and_b32 v25, s72, v20
    v_sub_f32 v23, v22, v24
    v_mfma_f32_16x16x32_bf16 v[92:95], a[108:111], a[204:207], v[92:95]
    v_lshl_add_u32 v17, v17, 3, s77
    v_sub_f32 v21, v20, v25
    v_mfma_f32_16x16x32_bf16 v[84:87], a[108:111], a[200:203], v[84:87]
    v_and_b32 v24, s72, v23
    v_and_b32 v25, s72, v21
    v_mfma_f32_16x16x32_bf16 v[76:79], a[108:111], a[196:199], v[76:79]
    v_perm_b32 v22, v23, v22, s73
    v_perm_b32 v20, v21, v20, s73
    v_mfma_f32_16x16x32_bf16 v[68:71], a[108:111], a[192:195], v[68:71]
    v_sub_f32 v23, v23, v24
    v_sub_f32 v21, v21, v25
    s_waitcnt lgkmcnt(8)
    v_mfma_f32_16x16x32_bf16 v[32:35], a[112:115], a[240:243], v[32:35]
    v_lshrrev_b32 v23, 16, v23
    v_lshrrev_b32 v21, 16, v21
    ds_write_b64 v16, v[22:23]
    ds_write_b64 v17, v[20:21] offset:512
    v_mfma_f32_16x16x32_bf16 v[40:43], a[112:115], a[244:247], v[40:43]
    v_mfma_f32_16x16x32_bf16 v[48:51], a[112:115], a[248:251], v[48:51]
    v_mfma_f32_16x16x32_bf16 v[56:59], a[112:115], a[252:255], v[56:59]
    v_mfma_f32_16x16x32_bf16 v[60:63], a[116:119], a[252:255], v[60:63]
    s_waitcnt lgkmcnt(0)
    s_barrier
    v_mfma_f32_16x16x32_bf16 v[52:55], a[116:119], a[248:251], v[52:55]
    buffer_load_dwordx4 v[20:23], v7, s[4:7], s49 offen offset:256 sc1
    ds_read_b64_tr_b16 a[160:161], v12 offset:20480
    v_mfma_f32_16x16x32_bf16 v[44:47], a[116:119], a[244:247], v[44:47]
    v_mul_f32 v28, s44, v28
    ds_read_b64_tr_b16 a[162:163], v12 offset:21504
    v_mfma_f32_16x16x32_bf16 v[36:39], a[116:119], a[240:243], v[36:39]
    buffer_load_dwordx4 v[24:27], v7, s[4:7], s49 offen offset:320 sc1
    ds_read_b64_tr_b16 a[164:165], v13 offset:20480
    v_mfma_f32_16x16x32_bf16 v[64:67], a[120:123], a[240:243], v[64:67]
    v_mul_f32 v29, s44, v29
    ds_read_b64_tr_b16 a[166:167], v13 offset:21504
    v_mfma_f32_16x16x32_bf16 v[72:75], a[120:123], a[244:247], v[72:75]
    buffer_load_dwordx4 v[16:19], v7, s[4:7], s49 offen offset:384 sc1
    ds_read_b64_tr_b16 a[168:169], v14 offset:20480
    v_mfma_f32_16x16x32_bf16 v[80:83], a[120:123], a[248:251], v[80:83]
    v_mul_f32 v30, s44, v30
    ds_read_b64_tr_b16 a[170:171], v14 offset:21504
    v_mfma_f32_16x16x32_bf16 v[88:91], a[120:123], a[252:255], v[88:91]
    buffer_load_dwordx4 v[4:7], v7, s[4:7], s49 offen offset:448 sc1
    ds_read_b64_tr_b16 a[172:173], v15 offset:20480
    v_mfma_f32_16x16x32_bf16 v[92:95], a[124:127], a[252:255], v[92:95]
    v_mul_f32 v31, s44, v31
    ds_read_b64_tr_b16 a[174:175], v15 offset:21504
    v_mfma_f32_16x16x32_bf16 v[84:87], a[124:127], a[248:251], v[84:87]
    ds_read2_b64 a[208:211], v0 offset0:0 offset1:32
    v_mfma_f32_16x16x32_bf16 v[76:79], a[124:127], a[244:247], v[76:79]
    ds_read2_b64 a[212:215], v0 offset0:64 offset1:192
    v_mfma_f32_16x16x32_bf16 v[68:71], a[124:127], a[240:243], v[68:71]
    ds_read2_b64 a[216:219], v0 offset0:96 offset1:224
    s_waitcnt lgkmcnt(8)
    v_mfma_f32_16x16x32_bf16 v[32:35], a[160:163], a[176:179], v[32:35]
    ds_read2st64_b64 a[220:223], v0 offset0:2 offset1:4
    v_mfma_f32_16x16x32_bf16 v[40:43], a[160:163], a[180:183], v[40:43]
    ds_read_b64 a[224:225], v0 offset:1280
    ds_read_b64 a[226:227], v0 offset:2304
    v_mfma_f32_16x16x32_bf16 v[48:51], a[160:163], a[184:187], v[48:51]
    ds_read_b64_tr_b16 a[96:97], v12 offset:24576
    v_mfma_f32_16x16x32_bf16 v[56:59], a[160:163], a[188:191], v[56:59]
    ds_read_b64_tr_b16 a[98:99], v12 offset:25600
    s_waitcnt lgkmcnt(8)
    v_mfma_f32_16x16x32_bf16 v[60:63], a[164:167], a[188:191], v[60:63]
    ds_read_b64_tr_b16 a[100:101], v13 offset:24576
    v_mfma_f32_16x16x32_bf16 v[52:55], a[164:167], a[184:187], v[52:55]
    ds_read_b64_tr_b16 a[102:103], v13 offset:25600
    v_mfma_f32_16x16x32_bf16 v[44:47], a[164:167], a[180:183], v[44:47]
    ds_read_b64_tr_b16 a[104:105], v12 offset:32768
    v_mfma_f32_16x16x32_bf16 v[36:39], a[164:167], a[176:179], v[36:39]
    ds_read_b64_tr_b16 a[106:107], v12 offset:33792
    v_mfma_f32_16x16x32_bf16 v[64:67], a[168:171], a[176:179], v[64:67]
    ds_read_b64_tr_b16 a[108:109], v13 offset:32768
    v_mfma_f32_16x16x32_bf16 v[72:75], a[168:171], a[180:183], v[72:75]
    ds_read_b64_tr_b16 a[110:111], v13 offset:33792
    v_mfma_f32_16x16x32_bf16 v[80:83], a[168:171], a[184:187], v[80:83]
    ds_read_b64_tr_b16 a[112:113], v10 offset:24576
    v_mfma_f32_16x16x32_bf16 v[88:91], a[168:171], a[188:191], v[88:91]
    ds_read_b64_tr_b16 a[114:115], v10 offset:25600
    v_mfma_f32_16x16x32_bf16 v[92:95], a[172:175], a[188:191], v[92:95]
    ds_read_b64_tr_b16 a[116:117], v11 offset:24576
    s_waitcnt lgkmcnt(8)
    v_mfma_f32_16x16x4_4b_bf16 v[32:47], a[208:209], a[228:229], v[32:47]
    v_mfma_f32_16x16x32_bf16 v[84:87], a[172:175], a[184:187], v[84:87]
    ds_read_b64_tr_b16 a[118:119], v11 offset:25600
    v_mfma_f32_16x16x32_bf16 v[76:79], a[172:175], a[180:183], v[76:79]
    ds_read_b64_tr_b16 a[120:121], v10 offset:32768
    v_mfma_f32_16x16x4_4b_bf16 v[48:63], a[208:209], a[230:231], v[48:63]
    v_mfma_f32_16x16x32_bf16 v[68:71], a[172:175], a[176:179], v[68:71]
    ds_read_b64_tr_b16 a[122:123], v10 offset:33792
    v_mfma_f32_16x16x32_bf16 v[96:99], a[192:195], a[128:131], v[96:99]
    ds_read_b64_tr_b16 a[124:125], v11 offset:32768
    v_mfma_f32_16x16x32_bf16 v[104:107], a[196:199], a[128:131], v[104:107]
    ds_read_b64_tr_b16 a[126:127], v11 offset:33792
    s_nop 0
    v_mul_f32 v32, v28, v32
    v_mfma_f32_16x16x32_bf16 v[112:115], a[200:203], a[128:131], v[112:115]
    ds_read_b64_tr_b16 a[160:161], v14 offset:4096
    v_mul_f32 v33, v28, v33
    v_mfma_f32_16x16x32_bf16 v[120:123], a[204:207], a[128:131], v[120:123]
    ds_read_b64_tr_b16 a[162:163], v14 offset:5120
    v_mul_f32 v34, v28, v34
    v_mul_f32 v35, v28, v35
    v_mfma_f32_16x16x32_bf16 v[124:127], a[204:207], a[132:135], v[124:127]
    ds_read_b64_tr_b16 a[164:165], v15 offset:4096
    v_mul_f32 v36, v28, v36
    v_mfma_f32_16x16x4_4b_bf16 v[64:79], a[210:211], a[228:229], v[64:79]
    v_mul_f32 v37, v28, v37
    v_mul_f32 v38, v28, v38
    v_mul_f32 v39, v28, v39
    v_cvt_pk_bf16_f32 v32, v32, v33
    v_mfma_f32_16x16x32_bf16 v[116:119], a[200:203], a[132:135], v[116:119]
    ds_read_b64_tr_b16 a[166:167], v15 offset:5120
    v_cvt_pk_bf16_f32 v33, v34, v35
    v_mfma_f32_16x16x32_bf16 v[108:111], a[196:199], a[132:135], v[108:111]
    ds_read_b64_tr_b16 a[168:169], v14 offset:12288
    v_cvt_pk_bf16_f32 v34, v36, v37
    v_cvt_pk_bf16_f32 v35, v38, v39
    v_mfma_f32_16x16x32_bf16 v[100:103], a[192:195], a[132:135], v[100:103]
    ds_read_b64_tr_b16 a[170:171], v14 offset:13312
    buffer_store_dwordx4 v[32:35], v2, s[4:7], s64 offen offset:0 sc1
    v_mul_f32 v40, v29, v40
    v_mfma_f32_16x16x32_bf16 a[0:3], a[192:195], a[136:139], a[0:3]
    ds_read_b64_tr_b16 a[172:173], v15 offset:12288
    v_mul_f32 v41, v29, v41
    v_mul_f32 v42, v29, v42
    v_mfma_f32_16x16x32_bf16 a[8:11], a[196:199], a[136:139], a[8:11]
    ds_read_b64_tr_b16 a[174:175], v15 offset:13312
    v_mul_f32 v43, v29, v43
    v_mul_f32 v44, v29, v44
    v_mfma_f32_16x16x32_bf16 a[16:19], a[200:203], a[136:139], a[16:19]
    ds_read_b64_tr_b16 a[128:129], v14 offset:24576
    v_mul_f32 v45, v29, v45
    v_mfma_f32_16x16x32_bf16 a[24:27], a[204:207], a[136:139], a[24:27]
    ds_read_b64_tr_b16 a[130:131], v14 offset:25600
    v_mul_f32 v46, v29, v46
    v_mul_f32 v47, v29, v47
    v_mfma_f32_16x16x4_4b_bf16 v[80:95], a[210:211], a[230:231], v[80:95]
    v_cvt_pk_bf16_f32 v40, v40, v41
    v_cvt_pk_bf16_f32 v41, v42, v43
    v_cvt_pk_bf16_f32 v42, v44, v45
    v_mfma_f32_16x16x32_bf16 a[28:31], a[204:207], a[140:143], a[28:31]
    ds_read_b64_tr_b16 a[132:133], v15 offset:24576
    v_cvt_pk_bf16_f32 v43, v46, v47
    buffer_store_dwordx4 v[40:43], v2, s[4:7], s64 offen offset:1024 sc1
    v_mul_f32 v48, v30, v48
    v_mfma_f32_16x16x32_bf16 a[20:23], a[200:203], a[140:143], a[20:23]
    ds_read_b64_tr_b16 a[134:135], v15 offset:25600
    v_mul_f32 v49, v30, v49
    v_mfma_f32_16x16x32_bf16 a[12:15], a[196:199], a[140:143], a[12:15]
    ds_read_b64_tr_b16 a[136:137], v14 offset:32768
    v_mul_f32 v50, v30, v50
    v_mul_f32 v51, v30, v51
    v_mfma_f32_16x16x32_bf16 a[4:7], a[192:195], a[140:143], a[4:7]
    ds_read_b64_tr_b16 a[138:139], v14 offset:33792
    v_mul_f32 v52, v30, v52
    v_mul_f32 v53, v30, v53
    v_mfma_f32_16x16x32_bf16 v[96:99], a[240:243], a[144:147], v[96:99]
    ds_read_b64_tr_b16 a[140:141], v15 offset:32768
    v_mul_f32 v54, v30, v54
    v_mfma_f32_16x16x32_bf16 v[104:107], a[244:247], a[144:147], v[104:107]
    ds_read_b64_tr_b16 a[142:143], v15 offset:33792
    v_mul_f32 v55, v30, v55
    v_cvt_pk_bf16_f32 v48, v48, v49
    v_mfma_f32_16x16x32_bf16 v[112:115], a[248:251], a[144:147], v[112:115]
    v_cvt_pk_bf16_f32 v49, v50, v51
    v_cvt_pk_bf16_f32 v50, v52, v53
    v_mfma_f32_16x16x32_bf16 v[120:123], a[252:255], a[144:147], v[120:123]
    v_cvt_pk_bf16_f32 v51, v54, v55
    v_mfma_f32_16x16x4_4b_bf16 a[0:15], a[228:229], a[214:215], a[0:15]
    buffer_store_dwordx4 v[48:51], v2, s[4:7], s65 offen offset:0 sc1
    v_mul_f32 v56, v31, v56
    v_mul_f32 v57, v31, v57
    v_mul_f32 v58, v31, v58
    v_mfma_f32_16x16x32_bf16 v[124:127], a[252:255], a[148:151], v[124:127]
    ds_read_b64_tr_b16 a[144:145], v8 offset:28672
    v_mul_f32 v59, v31, v59
    v_mul_f32 v60, v31, v60
    v_mfma_f32_16x16x32_bf16 v[116:119], a[248:251], a[148:151], v[116:119]
    ds_read_b64_tr_b16 a[146:147], v8 offset:29696
    v_mul_f32 v61, v31, v61
    v_mul_f32 v62, v31, v62
    v_mfma_f32_16x16x32_bf16 v[108:111], a[244:247], a[148:151], v[108:111]
    v_mul_f32 v63, v31, v63
    v_mfma_f32_16x16x32_bf16 v[100:103], a[240:243], a[148:151], v[100:103]
    v_cvt_pk_bf16_f32 v56, v56, v57
    v_cvt_pk_bf16_f32 v57, v58, v59
    v_mfma_f32_16x16x32_bf16 a[0:3], a[240:243], a[152:155], a[0:3]
    ds_read_b64_tr_b16 a[148:149], v9 offset:28672
    v_cvt_pk_bf16_f32 v58, v60, v61
    v_cvt_pk_bf16_f32 v59, v62, v63
    v_mfma_f32_16x16x32_bf16 a[8:11], a[244:247], a[152:155], a[8:11]
    ds_read_b64_tr_b16 a[150:151], v9 offset:29696
    buffer_store_dwordx4 v[56:59], v2, s[4:7], s65 offen offset:1024 sc1
    v_mul_f32 v64, v28, v64
    v_mfma_f32_16x16x32_bf16 a[16:19], a[248:251], a[152:155], a[16:19]
    v_mul_f32 v65, v28, v65
    v_mul_f32 v66, v28, v66
    v_mfma_f32_16x16x32_bf16 a[24:27], a[252:255], a[152:155], a[24:27]
    v_mul_f32 v67, v28, v67
    v_mfma_f32_16x16x4_4b_bf16 v[96:111], a[228:229], a[212:213], v[96:111]
    v_mul_f32 v68, v28, v68
    v_mul_f32 v69, v28, v69
    v_mul_f32 v70, v28, v70
    v_mul_f32 v71, v28, v71
    v_mfma_f32_16x16x32_bf16 a[28:31], a[252:255], a[156:159], a[28:31]
    ds_read_b64_tr_b16 a[152:153], v8 offset:36864
    v_cvt_pk_bf16_f32 v64, v64, v65
    v_mfma_f32_16x16x32_bf16 a[20:23], a[248:251], a[156:159], a[20:23]
    ds_read_b64_tr_b16 a[154:155], v8 offset:37888
    v_cvt_pk_bf16_f32 v65, v66, v67
    v_cvt_pk_bf16_f32 v66, v68, v69
    v_mfma_f32_16x16x32_bf16 a[12:15], a[244:247], a[156:159], a[12:15]
    v_cvt_pk_bf16_f32 v67, v70, v71
    v_mfma_f32_16x16x32_bf16 a[4:7], a[240:243], a[156:159], a[4:7]
    buffer_store_dwordx4 v[64:67], v2, s[4:7], s66 offen offset:0 sc1
    v_mul_f32 v72, v29, v72
    v_mul_f32 v73, v29, v73
    v_mfma_f32_16x16x32_bf16 v[96:99], a[176:179], a[96:99], v[96:99]
    ds_read_b64_tr_b16 a[156:157], v9 offset:36864
    v_mul_f32 v74, v29, v74
    v_mul_f32 v75, v29, v75
    v_mfma_f32_16x16x32_bf16 v[104:107], a[180:183], a[96:99], v[104:107]
    ds_read_b64_tr_b16 a[158:159], v9 offset:37888
    v_mul_f32 v76, v29, v76
    v_mfma_f32_16x16x32_bf16 v[112:115], a[184:187], a[96:99], v[112:115]
    v_mul_f32 v77, v29, v77
    v_mul_f32 v78, v29, v78
    v_mfma_f32_16x16x32_bf16 v[120:123], a[188:191], a[96:99], v[120:123]
    v_mul_f32 v79, v29, v79
    v_cvt_pk_bf16_f32 v72, v72, v73
    v_mfma_f32_16x16x4_4b_bf16 a[16:31], a[230:231], a[214:215], a[16:31]
    v_cvt_pk_bf16_f32 v73, v74, v75
    v_cvt_pk_bf16_f32 v74, v76, v77
    v_cvt_pk_bf16_f32 v75, v78, v79
    s_waitcnt lgkmcnt(8)
    v_mfma_f32_16x16x32_bf16 v[124:127], a[188:191], a[100:103], v[124:127]
    ds_read_b64_tr_b16 a[96:97], v12 offset:8192
    buffer_store_dwordx4 v[72:75], v2, s[4:7], s66 offen offset:1024 sc1
    v_mul_f32 v80, v30, v80
    v_mfma_f32_16x16x32_bf16 v[116:119], a[184:187], a[100:103], v[116:119]
    ds_read_b64_tr_b16 a[98:99], v12 offset:9216
    v_mul_f32 v81, v30, v81
    v_mul_f32 v82, v30, v82
    v_mfma_f32_16x16x32_bf16 v[108:111], a[180:183], a[100:103], v[108:111]
    v_mul_f32 v83, v30, v83
    v_mul_f32 v84, v30, v84
    v_mfma_f32_16x16x32_bf16 v[100:103], a[176:179], a[100:103], v[100:103]
    v_mul_f32 v85, v30, v85
    v_mfma_f32_16x16x32_bf16 a[0:3], a[176:179], a[104:107], a[0:3]
    ds_read_b64_tr_b16 a[100:101], v13 offset:8192
    v_mul_f32 v86, v30, v86
    v_mul_f32 v87, v30, v87
    v_mfma_f32_16x16x32_bf16 a[8:11], a[180:183], a[104:107], a[8:11]
    ds_read_b64_tr_b16 a[102:103], v13 offset:9216
    v_cvt_pk_bf16_f32 v80, v80, v81
    v_cvt_pk_bf16_f32 v81, v82, v83
    v_mfma_f32_16x16x32_bf16 a[16:19], a[184:187], a[104:107], a[16:19]
    v_cvt_pk_bf16_f32 v82, v84, v85
    v_mfma_f32_16x16x32_bf16 a[24:27], a[188:191], a[104:107], a[24:27]
    v_cvt_pk_bf16_f32 v83, v86, v87
    buffer_store_dwordx4 v[80:83], v2, s[4:7], s67 offen offset:0 sc1
    v_mul_f32 v88, v31, v88
    v_mfma_f32_16x16x4_4b_bf16 v[112:127], a[230:231], a[212:213], v[112:127]
    v_mul_f32 v89, v31, v89
    v_mul_f32 v90, v31, v90
    v_mul_f32 v91, v31, v91
    v_mfma_f32_16x16x32_bf16 a[28:31], a[188:191], a[108:111], a[28:31]
    ds_read_b64_tr_b16 a[104:105], v12 offset:16384
    v_mul_f32 v92, v31, v92
    v_mul_f32 v93, v31, v93
    v_mfma_f32_16x16x32_bf16 a[20:23], a[184:187], a[108:111], a[20:23]
    ds_read_b64_tr_b16 a[106:107], v12 offset:17408
    v_mul_f32 v94, v31, v94
    v_mfma_f32_16x16x32_bf16 a[12:15], a[180:183], a[108:111], a[12:15]
    v_mul_f32 v95, v31, v95
    v_cvt_pk_bf16_f32 v88, v88, v89
    v_mfma_f32_16x16x32_bf16 a[4:7], a[176:179], a[108:111], a[4:7]
    v_cvt_pk_bf16_f32 v89, v90, v91
    v_cvt_pk_bf16_f32 v90, v92, v93
    v_cvt_pk_bf16_f32 v91, v94, v95
    buffer_store_dwordx4 v[88:91], v2, s[4:7], s67 offen offset:1024 sc1
    s_waitcnt vmcnt(8)
    v_mfma_f32_16x16x32_bf16 v[128:131], a[192:195], a[112:115], v[128:131]
    ds_read_b64_tr_b16 a[108:109], v13 offset:16384
    s_add_u32 s71, s70, 0
    v_mul_f32 v96, v20, v96
    v_mfma_f32_16x16x32_bf16 v[136:139], a[196:199], a[112:115], v[136:139]
    ds_read_b64_tr_b16 a[110:111], v13 offset:17408
    v_mul_f32 v97, v21, v97
    v_mul_f32 v98, v22, v98
    v_mul_f32 v99, v23, v99
    v_mfma_f32_16x16x32_bf16 v[144:147], a[200:203], a[112:115], v[144:147]
    v_mul_f32 v104, v24, v104
    v_mul_f32 v105, v25, v105
    v_mfma_f32_16x16x32_bf16 v[152:155], a[204:207], a[112:115], v[152:155]
    v_mul_f32 v106, v26, v106
    v_mul_f32 v107, v27, v107
    v_cvt_pk_bf16_f32 v96, v96, v97
    v_mfma_f32_16x16x32_bf16 v[156:159], a[204:207], a[116:119], v[156:159]
    ds_read_b64_tr_b16 a[112:113], v12 offset:28672
    v_cvt_pk_bf16_f32 v97, v98, v99
    v_cvt_pk_bf16_f32 v98, v104, v105
    v_mfma_f32_16x16x32_bf16 v[148:151], a[200:203], a[116:119], v[148:151]
    ds_read_b64_tr_b16 a[114:115], v12 offset:29696
    v_cvt_pk_bf16_f32 v99, v106, v107
    buffer_store_dwordx4 v[96:99], v3, s[4:7], s71 offen offset:2048 sc1
    v_mul_f32 v100, v20, v100
    v_mfma_f32_16x16x32_bf16 v[140:143], a[196:199], a[116:119], v[140:143]
    v_mul_f32 v101, v21, v101
    v_mul_f32 v102, v22, v102
    v_mfma_f32_16x16x32_bf16 v[132:135], a[192:195], a[116:119], v[132:135]
    v_mul_f32 v103, v23, v103
    v_mul_f32 v108, v24, v108
    v_mul_f32 v109, v25, v109
    v_mfma_f32_16x16x32_bf16 a[32:35], a[192:195], a[120:123], a[32:35]
    ds_read_b64_tr_b16 a[116:117], v13 offset:28672
    v_mul_f32 v110, v26, v110
    v_mul_f32 v111, v27, v111
    v_mfma_f32_16x16x32_bf16 a[40:43], a[196:199], a[120:123], a[40:43]
    ds_read_b64_tr_b16 a[118:119], v13 offset:29696
    v_cvt_pk_bf16_f32 v100, v100, v101
    v_cvt_pk_bf16_f32 v101, v102, v103
    v_cvt_pk_bf16_f32 v102, v108, v109
    v_mfma_f32_16x16x32_bf16 a[48:51], a[200:203], a[120:123], a[48:51]
    v_cvt_pk_bf16_f32 v103, v110, v111
    buffer_store_dwordx4 v[100:103], v3, s[4:7], s71 offen offset:3072 sc1
    v_mfma_f32_16x16x32_bf16 a[56:59], a[204:207], a[120:123], a[56:59]
    s_add_u32 s71, s70, 4096
    v_mul_f32 v112, v16, v112
    v_mul_f32 v113, v17, v113
    v_mfma_f32_16x16x32_bf16 a[60:63], a[204:207], a[124:127], a[60:63]
    ds_read_b64_tr_b16 a[120:121], v12 offset:36864
    v_mul_f32 v114, v18, v114
    v_mul_f32 v115, v19, v115
    v_mfma_f32_16x16x32_bf16 a[52:55], a[200:203], a[124:127], a[52:55]
    ds_read_b64_tr_b16 a[122:123], v12 offset:37888
    v_mul_f32 v120, v4, v120
    v_mul_f32 v121, v5, v121
    v_mul_f32 v122, v6, v122
    v_mfma_f32_16x16x32_bf16 a[44:47], a[196:199], a[124:127], a[44:47]
    v_mul_f32 v123, v7, v123
    v_cvt_pk_bf16_f32 v112, v112, v113
    v_mfma_f32_16x16x32_bf16 a[36:39], a[192:195], a[124:127], a[36:39]
    v_cvt_pk_bf16_f32 v113, v114, v115
    v_cvt_pk_bf16_f32 v114, v120, v121
    v_cvt_pk_bf16_f32 v115, v122, v123
    v_mfma_f32_16x16x32_bf16 v[128:131], a[240:243], a[160:163], v[128:131]
    ds_read_b64_tr_b16 a[124:125], v13 offset:36864
    buffer_store_dwordx4 v[112:115], v3, s[4:7], s71 offen offset:2048 sc1
    v_mul_f32 v116, v16, v116
    v_mfma_f32_16x16x32_bf16 v[136:139], a[244:247], a[160:163], v[136:139]
    ds_read_b64_tr_b16 a[126:127], v13 offset:37888
    v_mul_f32 v117, v17, v117
    v_mul_f32 v118, v18, v118
    v_mul_f32 v119, v19, v119
    v_mfma_f32_16x16x32_bf16 v[144:147], a[248:251], a[160:163], v[144:147]
    v_mul_f32 v124, v4, v124
    v_mul_f32 v125, v5, v125
    v_mfma_f32_16x16x32_bf16 v[152:155], a[252:255], a[160:163], v[152:155]
    v_mul_f32 v126, v6, v126
    v_mul_f32 v127, v7, v127
    v_cvt_pk_bf16_f32 v116, v116, v117
    v_mfma_f32_16x16x4_4b_bf16 a[32:47], a[228:229], a[218:219], a[32:47]
    v_cvt_pk_bf16_f32 v117, v118, v119
    v_cvt_pk_bf16_f32 v118, v124, v125
    v_cvt_pk_bf16_f32 v119, v126, v127
    buffer_store_dwordx4 v[116:119], v3, s[4:7], s71 offen offset:3072 sc1
    s_add_u32 s71, s70, 1048576
    v_mfma_f32_16x16x32_bf16 v[156:159], a[252:255], a[164:167], v[156:159]
    ds_read_b64_tr_b16 a[160:161], v10 offset:28672
    v_accvgpr_read_b32 v32, a0
    v_accvgpr_read_b32 v33, a1
    v_mfma_f32_16x16x32_bf16 v[148:151], a[248:251], a[164:167], v[148:151]
    ds_read_b64_tr_b16 a[162:163], v10 offset:29696
    v_accvgpr_read_b32 v34, a2
    v_accvgpr_read_b32 v35, a3
    v_accvgpr_read_b32 v36, a8
    v_mfma_f32_16x16x32_bf16 v[140:143], a[244:247], a[164:167], v[140:143]
    v_accvgpr_read_b32 v37, a9
    v_accvgpr_read_b32 v38, a10
    v_mfma_f32_16x16x32_bf16 v[132:135], a[240:243], a[164:167], v[132:135]
    v_accvgpr_read_b32 v39, a11
    v_mul_f32 v32, v20, v32
    v_mul_f32 v33, v21, v33
    v_mfma_f32_16x16x32_bf16 a[32:35], a[240:243], a[168:171], a[32:35]
    ds_read_b64_tr_b16 a[164:165], v11 offset:28672
    v_mul_f32 v34, v22, v34
    v_mul_f32 v35, v23, v35
    v_mfma_f32_16x16x32_bf16 a[40:43], a[244:247], a[168:171], a[40:43]
    ds_read_b64_tr_b16 a[166:167], v11 offset:29696
    v_mul_f32 v36, v24, v36
    v_mul_f32 v37, v25, v37
    v_mul_f32 v38, v26, v38
    v_mfma_f32_16x16x32_bf16 a[48:51], a[248:251], a[168:171], a[48:51]
    v_mul_f32 v39, v27, v39
    v_cvt_pk_bf16_f32 v32, v32, v33
    v_cvt_pk_bf16_f32 v33, v34, v35
    v_mfma_f32_16x16x32_bf16 a[56:59], a[252:255], a[168:171], a[56:59]
    v_cvt_pk_bf16_f32 v34, v36, v37
    v_cvt_pk_bf16_f32 v35, v38, v39
    v_mfma_f32_16x16x4_4b_bf16 v[128:143], a[228:229], a[216:217], v[128:143]
    buffer_store_dwordx4 v[32:35], v3, s[4:7], s71 offen offset:2048 sc1
    v_accvgpr_read_b32 v40, a4
    v_accvgpr_read_b32 v41, a5
    v_accvgpr_read_b32 v42, a6
    v_accvgpr_read_b32 v43, a7
    v_mfma_f32_16x16x32_bf16 a[60:63], a[252:255], a[172:175], a[60:63]
    ds_read_b64_tr_b16 a[168:169], v10 offset:36864
    v_accvgpr_read_b32 v44, a12
    v_accvgpr_read_b32 v45, a13
    v_accvgpr_read_b32 v46, a14
    v_mfma_f32_16x16x32_bf16 a[52:55], a[248:251], a[172:175], a[52:55]
    ds_read_b64_tr_b16 a[170:171], v10 offset:37888
    v_accvgpr_read_b32 v47, a15
    v_mul_f32 v40, v20, v40
    v_mfma_f32_16x16x32_bf16 a[44:47], a[244:247], a[172:175], a[44:47]
    v_mul_f32 v41, v21, v41
    v_mul_f32 v42, v22, v42
    v_mul_f32 v43, v23, v43
    v_mfma_f32_16x16x32_bf16 a[36:39], a[240:243], a[172:175], a[36:39]
    v_mul_f32 v44, v24, v44
    v_mul_f32 v45, v25, v45
    v_mfma_f32_16x16x32_bf16 v[128:131], a[176:179], a[128:131], v[128:131]
    ds_read_b64_tr_b16 a[172:173], v11 offset:36864
    v_mul_f32 v46, v26, v46
    v_mul_f32 v47, v27, v47
    v_cvt_pk_bf16_f32 v40, v40, v41
    v_mfma_f32_16x16x32_bf16 v[136:139], a[180:183], a[128:131], v[136:139]
    ds_read_b64_tr_b16 a[174:175], v11 offset:37888
    v_cvt_pk_bf16_f32 v41, v42, v43
    v_cvt_pk_bf16_f32 v42, v44, v45
    v_mfma_f32_16x16x32_bf16 v[144:147], a[184:187], a[128:131], v[144:147]
    v_cvt_pk_bf16_f32 v43, v46, v47
    buffer_store_dwordx4 v[40:43], v3, s[4:7], s71 offen offset:3072 sc1
    s_add_u32 s71, s70, 1052672
    v_mfma_f32_16x16x32_bf16 v[152:155], a[188:191], a[128:131], v[152:155]
    v_accvgpr_read_b32 v48, a16
    v_accvgpr_read_b32 v49, a17
    v_mfma_f32_16x16x4_4b_bf16 a[48:63], a[230:231], a[218:219], a[48:63]
    v_accvgpr_read_b32 v50, a18
    v_accvgpr_read_b32 v51, a19
    v_accvgpr_read_b32 v52, a24
    v_accvgpr_read_b32 v53, a25
    v_accvgpr_read_b32 v54, a26
    v_mfma_f32_16x16x32_bf16 v[156:159], a[188:191], a[132:135], v[156:159]
    ds_read_b64_tr_b16 a[128:129], v14 offset:8192
    v_accvgpr_read_b32 v55, a27
    v_mul_f32 v48, v16, v48
    v_mul_f32 v49, v17, v49
    v_mfma_f32_16x16x32_bf16 v[148:151], a[184:187], a[132:135], v[148:151]
    ds_read_b64_tr_b16 a[130:131], v14 offset:9216
    v_mul_f32 v50, v18, v50
    v_mul_f32 v51, v19, v51
    v_mfma_f32_16x16x32_bf16 v[140:143], a[180:183], a[132:135], v[140:143]
    v_mul_f32 v52, v4, v52
    v_mul_f32 v53, v5, v53
    v_mul_f32 v54, v6, v54
    v_mfma_f32_16x16x32_bf16 v[132:135], a[176:179], a[132:135], v[132:135]
    v_mul_f32 v55, v7, v55
    v_cvt_pk_bf16_f32 v48, v48, v49
    v_mfma_f32_16x16x32_bf16 a[32:35], a[176:179], a[136:139], a[32:35]
    ds_read_b64_tr_b16 a[132:133], v15 offset:8192
    v_cvt_pk_bf16_f32 v49, v50, v51
    v_cvt_pk_bf16_f32 v50, v52, v53
    v_cvt_pk_bf16_f32 v51, v54, v55
    v_mfma_f32_16x16x32_bf16 a[40:43], a[180:183], a[136:139], a[40:43]
    ds_read_b64_tr_b16 a[134:135], v15 offset:9216
    buffer_store_dwordx4 v[48:51], v3, s[4:7], s71 offen offset:2048 sc1
    v_accvgpr_read_b32 v56, a20
    v_mfma_f32_16x16x32_bf16 a[48:51], a[184:187], a[136:139], a[48:51]
    v_accvgpr_read_b32 v57, a21
    v_accvgpr_read_b32 v58, a22
    v_accvgpr_read_b32 v59, a23
    v_mfma_f32_16x16x32_bf16 a[56:59], a[188:191], a[136:139], a[56:59]
    v_accvgpr_read_b32 v60, a28
    v_accvgpr_read_b32 v61, a29
    v_mfma_f32_16x16x4_4b_bf16 v[144:159], a[230:231], a[216:217], v[144:159]
    v_accvgpr_read_b32 v62, a30
    v_accvgpr_read_b32 v63, a31
    v_mul_f32 v56, v16, v56
    v_mul_f32 v57, v17, v57
    v_mul_f32 v58, v18, v58
    v_mfma_f32_16x16x32_bf16 a[60:63], a[188:191], a[140:143], a[60:63]
    ds_read_b64_tr_b16 a[136:137], v14 offset:16384
    v_mul_f32 v59, v19, v59
    v_mul_f32 v60, v4, v60
    v_mul_f32 v61, v5, v61
    v_mfma_f32_16x16x32_bf16 a[52:55], a[184:187], a[140:143], a[52:55]
    ds_read_b64_tr_b16 a[138:139], v14 offset:17408
    v_mul_f32 v62, v6, v62
    v_mul_f32 v63, v7, v63
    v_mfma_f32_16x16x32_bf16 a[44:47], a[180:183], a[140:143], a[44:47]
    v_cvt_pk_bf16_f32 v56, v56, v57
    v_cvt_pk_bf16_f32 v57, v58, v59
    v_cvt_pk_bf16_f32 v58, v60, v61
    v_mfma_f32_16x16x32_bf16 a[36:39], a[176:179], a[140:143], a[36:39]
    v_cvt_pk_bf16_f32 v59, v62, v63
    buffer_store_dwordx4 v[56:59], v3, s[4:7], s71 offen offset:3072 sc1
    s_add_u32 s71, s70, 262144
    s_waitcnt lgkmcnt(8)
    v_mfma_f32_16x16x32_bf16 v[160:163], a[192:195], a[144:147], v[160:163]
    ds_read_b64_tr_b16 a[140:141], v15 offset:16384
    v_mul_f32 v128, v20, v128
    v_mul_f32 v129, v21, v129
    v_mfma_f32_16x16x32_bf16 v[168:171], a[196:199], a[144:147], v[168:171]
    ds_read_b64_tr_b16 a[142:143], v15 offset:17408
    v_mul_f32 v130, v22, v130
    v_mul_f32 v131, v23, v131
    v_mul_f32 v136, v24, v136
    v_mfma_f32_16x16x32_bf16 v[176:179], a[200:203], a[144:147], v[176:179]
    v_mul_f32 v137, v25, v137
    v_mul_f32 v138, v26, v138
    v_mfma_f32_16x16x32_bf16 v[184:187], a[204:207], a[144:147], v[184:187]
    v_mul_f32 v139, v27, v139
    v_cvt_pk_bf16_f32 v128, v128, v129
    v_cvt_pk_bf16_f32 v129, v130, v131
    v_mfma_f32_16x16x32_bf16 v[188:191], a[204:207], a[148:151], v[188:191]
    ds_read_b64_tr_b16 a[144:145], v14 offset:28672
    v_cvt_pk_bf16_f32 v130, v136, v137
    v_cvt_pk_bf16_f32 v131, v138, v139
    v_mfma_f32_16x16x32_bf16 v[180:183], a[200:203], a[148:151], v[180:183]
    ds_read_b64_tr_b16 a[146:147], v14 offset:29696
    buffer_store_dwordx4 v[128:131], v3, s[4:7], s71 offen offset:2048 sc1
    v_mul_f32 v132, v20, v132
    v_mul_f32 v133, v21, v133
    v_mfma_f32_16x16x32_bf16 v[172:175], a[196:199], a[148:151], v[172:175]
    v_mul_f32 v134, v22, v134
    v_mul_f32 v135, v23, v135
    v_mfma_f32_16x16x32_bf16 v[164:167], a[192:195], a[148:151], v[164:167]
    v_mul_f32 v140, v24, v140
    v_mul_f32 v141, v25, v141
    v_mul_f32 v142, v26, v142
    v_mfma_f32_16x16x32_bf16 a[64:67], a[192:195], a[152:155], a[64:67]
    ds_read_b64_tr_b16 a[148:149], v15 offset:28672
    v_mul_f32 v143, v27, v143
    v_cvt_pk_bf16_f32 v132, v132, v133
    v_mfma_f32_16x16x32_bf16 a[72:75], a[196:199], a[152:155], a[72:75]
    ds_read_b64_tr_b16 a[150:151], v15 offset:29696
    v_cvt_pk_bf16_f32 v133, v134, v135
    v_cvt_pk_bf16_f32 v134, v140, v141
    v_cvt_pk_bf16_f32 v135, v142, v143
    v_mfma_f32_16x16x32_bf16 a[80:83], a[200:203], a[152:155], a[80:83]
    buffer_store_dwordx4 v[132:135], v3, s[4:7], s71 offen offset:3072 sc1
    s_add_u32 s71, s70, 266240
    v_mfma_f32_16x16x32_bf16 a[88:91], a[204:207], a[152:155], a[88:91]
    v_mul_f32 v144, v16, v144
    v_mul_f32 v145, v17, v145
    v_mul_f32 v146, v18, v146
    v_mfma_f32_16x16x32_bf16 a[92:95], a[204:207], a[156:159], a[92:95]
    ds_read_b64_tr_b16 a[152:153], v14 offset:36864
    v_mul_f32 v147, v19, v147
    v_mul_f32 v152, v4, v152
    v_mfma_f32_16x16x32_bf16 a[84:87], a[200:203], a[156:159], a[84:87]
    ds_read_b64_tr_b16 a[154:155], v14 offset:37888
    v_mul_f32 v153, v5, v153
    v_mul_f32 v154, v6, v154
    v_mul_f32 v155, v7, v155
    v_mfma_f32_16x16x32_bf16 a[76:79], a[196:199], a[156:159], a[76:79]
    v_cvt_pk_bf16_f32 v144, v144, v145
    v_cvt_pk_bf16_f32 v145, v146, v147
    v_mfma_f32_16x16x32_bf16 a[68:71], a[192:195], a[156:159], a[68:71]
    v_cvt_pk_bf16_f32 v146, v152, v153
    v_cvt_pk_bf16_f32 v147, v154, v155
    buffer_store_dwordx4 v[144:147], v3, s[4:7], s71 offen offset:2048 sc1
    v_mfma_f32_16x16x32_bf16 v[160:163], a[240:243], a[96:99], v[160:163]
    ds_read_b64_tr_b16 a[156:157], v15 offset:36864
    v_mul_f32 v148, v16, v148
    v_mul_f32 v149, v17, v149
    v_mfma_f32_16x16x32_bf16 v[168:171], a[244:247], a[96:99], v[168:171]
    ds_read_b64_tr_b16 a[158:159], v15 offset:37888
    v_mul_f32 v150, v18, v150
    v_mul_f32 v151, v19, v151
    v_mul_f32 v156, v4, v156
    v_mfma_f32_16x16x32_bf16 v[176:179], a[248:251], a[96:99], v[176:179]
    v_mul_f32 v157, v5, v157
    v_mul_f32 v158, v6, v158
    v_mfma_f32_16x16x32_bf16 v[184:187], a[252:255], a[96:99], v[184:187]
    v_mul_f32 v159, v7, v159
    v_cvt_pk_bf16_f32 v148, v148, v149
    v_cvt_pk_bf16_f32 v149, v150, v151
    v_mfma_f32_16x16x4_4b_bf16 a[64:79], a[228:229], a[222:223], a[64:79]
    v_cvt_pk_bf16_f32 v150, v156, v157
    v_cvt_pk_bf16_f32 v151, v158, v159
    buffer_store_dwordx4 v[148:151], v3, s[4:7], s71 offen offset:3072 sc1
    s_add_u32 s71, s70, 1310720
    v_accvgpr_read_b32 v32, a32
    v_mfma_f32_16x16x32_bf16 v[188:191], a[252:255], a[100:103], v[188:191]
    v_accvgpr_read_b32 v33, a33
    v_accvgpr_read_b32 v34, a34
    v_mfma_f32_16x16x32_bf16 v[180:183], a[248:251], a[100:103], v[180:183]
    v_accvgpr_read_b32 v35, a35
    v_accvgpr_read_b32 v36, a40
    v_accvgpr_read_b32 v37, a41
    v_mfma_f32_16x16x32_bf16 v[172:175], a[244:247], a[100:103], v[172:175]
    v_accvgpr_read_b32 v38, a42
    v_accvgpr_read_b32 v39, a43
    v_mfma_f32_16x16x32_bf16 v[164:167], a[240:243], a[100:103], v[164:167]
    v_mul_f32 v32, v20, v32
    v_mul_f32 v33, v21, v33
    v_mul_f32 v34, v22, v34
    v_mfma_f32_16x16x32_bf16 a[64:67], a[240:243], a[104:107], a[64:67]
    v_mul_f32 v35, v23, v35
    v_mul_f32 v36, v24, v36
    v_mfma_f32_16x16x32_bf16 a[72:75], a[244:247], a[104:107], a[72:75]
    v_mul_f32 v37, v25, v37
    v_mul_f32 v38, v26, v38
    v_mul_f32 v39, v27, v39
    v_mfma_f32_16x16x32_bf16 a[80:83], a[248:251], a[104:107], a[80:83]
    v_cvt_pk_bf16_f32 v32, v32, v33
    v_cvt_pk_bf16_f32 v33, v34, v35
    v_mfma_f32_16x16x32_bf16 a[88:91], a[252:255], a[104:107], a[88:91]
    v_cvt_pk_bf16_f32 v34, v36, v37
    v_cvt_pk_bf16_f32 v35, v38, v39
    buffer_store_dwordx4 v[32:35], v3, s[4:7], s71 offen offset:2048 sc1
    v_mfma_f32_16x16x4_4b_bf16 v[160:175], a[228:229], a[220:221], v[160:175]
    v_accvgpr_read_b32 v40, a36
    v_accvgpr_read_b32 v41, a37
    v_accvgpr_read_b32 v42, a38
    v_accvgpr_read_b32 v43, a39
    v_accvgpr_read_b32 v44, a44
    v_mfma_f32_16x16x32_bf16 a[92:95], a[252:255], a[108:111], a[92:95]
    v_accvgpr_read_b32 v45, a45
    v_accvgpr_read_b32 v46, a46
    v_mfma_f32_16x16x32_bf16 a[84:87], a[248:251], a[108:111], a[84:87]
    v_accvgpr_read_b32 v47, a47
    v_mul_f32 v40, v20, v40
    v_mul_f32 v41, v21, v41
    v_mfma_f32_16x16x32_bf16 a[76:79], a[244:247], a[108:111], a[76:79]
    v_mul_f32 v42, v22, v42
    v_mul_f32 v43, v23, v43
    v_mfma_f32_16x16x32_bf16 a[68:71], a[240:243], a[108:111], a[68:71]
    v_mul_f32 v44, v24, v44
    v_mul_f32 v45, v25, v45
    v_mul_f32 v46, v26, v46
    v_mfma_f32_16x16x32_bf16 v[160:163], a[176:179], a[112:115], v[160:163]
    v_mul_f32 v47, v27, v47
    v_cvt_pk_bf16_f32 v40, v40, v41
    v_mfma_f32_16x16x32_bf16 v[168:171], a[180:183], a[112:115], v[168:171]
    v_cvt_pk_bf16_f32 v41, v42, v43
    v_cvt_pk_bf16_f32 v42, v44, v45
    v_cvt_pk_bf16_f32 v43, v46, v47
    v_mfma_f32_16x16x32_bf16 v[176:179], a[184:187], a[112:115], v[176:179]
    buffer_store_dwordx4 v[40:43], v3, s[4:7], s71 offen offset:3072 sc1
    s_add_u32 s71, s70, 1314816
    v_mfma_f32_16x16x32_bf16 v[184:187], a[188:191], a[112:115], v[184:187]
    v_accvgpr_read_b32 v48, a48
    v_accvgpr_read_b32 v49, a49
    v_accvgpr_read_b32 v50, a50
    v_mfma_f32_16x16x4_4b_bf16 a[80:95], a[230:231], a[222:223], a[80:95]
    v_accvgpr_read_b32 v51, a51
    v_accvgpr_read_b32 v52, a56
    v_accvgpr_read_b32 v53, a57
    v_accvgpr_read_b32 v54, a58
    v_accvgpr_read_b32 v55, a59
    v_mfma_f32_16x16x32_bf16 v[188:191], a[188:191], a[116:119], v[188:191]
    v_mul_f32 v48, v16, v48
    v_mul_f32 v49, v17, v49
    v_mfma_f32_16x16x32_bf16 v[180:183], a[184:187], a[116:119], v[180:183]
    v_mul_f32 v50, v18, v50
    v_mul_f32 v51, v19, v51
    v_mul_f32 v52, v4, v52
    v_mfma_f32_16x16x32_bf16 v[172:175], a[180:183], a[116:119], v[172:175]
    v_mul_f32 v53, v5, v53
    v_mul_f32 v54, v6, v54
    v_mfma_f32_16x16x32_bf16 v[164:167], a[176:179], a[116:119], v[164:167]
    v_mul_f32 v55, v7, v55
    v_cvt_pk_bf16_f32 v48, v48, v49
    v_cvt_pk_bf16_f32 v49, v50, v51
    v_mfma_f32_16x16x32_bf16 a[64:67], a[176:179], a[120:123], a[64:67]
    v_cvt_pk_bf16_f32 v50, v52, v53
    v_cvt_pk_bf16_f32 v51, v54, v55
    v_mfma_f32_16x16x32_bf16 a[72:75], a[180:183], a[120:123], a[72:75]
    buffer_store_dwordx4 v[48:51], v3, s[4:7], s71 offen offset:2048 sc1
    v_accvgpr_read_b32 v56, a52
    v_accvgpr_read_b32 v57, a53
    v_mfma_f32_16x16x32_bf16 a[80:83], a[184:187], a[120:123], a[80:83]
    v_accvgpr_read_b32 v58, a54
    v_accvgpr_read_b32 v59, a55
    v_mfma_f32_16x16x32_bf16 a[88:91], a[188:191], a[120:123], a[88:91]
    v_accvgpr_read_b32 v60, a60
    v_accvgpr_read_b32 v61, a61
    v_accvgpr_read_b32 v62, a62
    v_mfma_f32_16x16x4_4b_bf16 v[176:191], a[230:231], a[220:221], v[176:191]
    v_accvgpr_read_b32 v63, a63
    v_mul_f32 v56, v16, v56
    v_mul_f32 v57, v17, v57
    v_mul_f32 v58, v18, v58
    v_mul_f32 v59, v19, v59
    v_mfma_f32_16x16x32_bf16 a[92:95], a[188:191], a[124:127], a[92:95]
    v_mul_f32 v60, v4, v60
    v_mul_f32 v61, v5, v61
    v_mfma_f32_16x16x32_bf16 a[84:87], a[184:187], a[124:127], a[84:87]
    v_mul_f32 v62, v6, v62
    v_mul_f32 v63, v7, v63
    v_cvt_pk_bf16_f32 v56, v56, v57
    v_mfma_f32_16x16x32_bf16 a[76:79], a[180:183], a[124:127], a[76:79]
    v_cvt_pk_bf16_f32 v57, v58, v59
    v_cvt_pk_bf16_f32 v58, v60, v61
    v_mfma_f32_16x16x32_bf16 a[68:71], a[176:179], a[124:127], a[68:71]
    v_cvt_pk_bf16_f32 v59, v62, v63
    buffer_store_dwordx4 v[56:59], v3, s[4:7], s71 offen offset:3072 sc1
    s_add_u32 s71, s70, 524288
    v_mfma_f32_16x16x32_bf16 v[192:195], a[192:195], a[160:163], v[192:195]
    v_mul_f32 v160, v20, v160
    v_mul_f32 v161, v21, v161
    v_mfma_f32_16x16x32_bf16 v[200:203], a[196:199], a[160:163], v[200:203]
    v_mul_f32 v162, v22, v162
    v_mul_f32 v163, v23, v163
    v_mul_f32 v168, v24, v168
    v_mfma_f32_16x16x32_bf16 v[208:211], a[200:203], a[160:163], v[208:211]
    v_mul_f32 v169, v25, v169
    v_mul_f32 v170, v26, v170
    v_mfma_f32_16x16x32_bf16 v[216:219], a[204:207], a[160:163], v[216:219]
    v_mul_f32 v171, v27, v171
    v_cvt_pk_bf16_f32 v160, v160, v161
    v_cvt_pk_bf16_f32 v161, v162, v163
    v_mfma_f32_16x16x32_bf16 v[220:223], a[204:207], a[164:167], v[220:223]
    v_cvt_pk_bf16_f32 v162, v168, v169
    v_cvt_pk_bf16_f32 v163, v170, v171
    v_mfma_f32_16x16x32_bf16 v[212:215], a[200:203], a[164:167], v[212:215]
    buffer_store_dwordx4 v[160:163], v3, s[4:7], s71 offen offset:2048 sc1
    v_mul_f32 v164, v20, v164
    v_mul_f32 v165, v21, v165
    v_mfma_f32_16x16x32_bf16 v[204:207], a[196:199], a[164:167], v[204:207]
    v_mul_f32 v166, v22, v166
    v_mul_f32 v167, v23, v167
    v_mfma_f32_16x16x32_bf16 v[196:199], a[192:195], a[164:167], v[196:199]
    v_mul_f32 v172, v24, v172
    v_mul_f32 v173, v25, v173
    v_mul_f32 v174, v26, v174
    v_mfma_f32_16x16x32_bf16 v[224:227], a[192:195], a[168:171], v[224:227]
    v_mul_f32 v175, v27, v175
    v_cvt_pk_bf16_f32 v164, v164, v165
    v_mfma_f32_16x16x32_bf16 v[232:235], a[196:199], a[168:171], v[232:235]
    v_cvt_pk_bf16_f32 v165, v166, v167
    v_cvt_pk_bf16_f32 v166, v172, v173
    v_cvt_pk_bf16_f32 v167, v174, v175
    v_mfma_f32_16x16x32_bf16 v[240:243], a[200:203], a[168:171], v[240:243]
    buffer_store_dwordx4 v[164:167], v3, s[4:7], s71 offen offset:3072 sc1
    s_add_u32 s71, s70, 528384
    v_mfma_f32_16x16x32_bf16 v[248:251], a[204:207], a[168:171], v[248:251]
    v_mul_f32 v176, v16, v176
    v_mul_f32 v177, v17, v177
    v_mul_f32 v178, v18, v178
    s_waitcnt lgkmcnt(8)
    v_mfma_f32_16x16x32_bf16 v[252:255], a[204:207], a[172:175], v[252:255]
    v_mul_f32 v179, v19, v179
    v_mul_f32 v184, v4, v184
    v_mfma_f32_16x16x32_bf16 v[244:247], a[200:203], a[172:175], v[244:247]
    v_mul_f32 v185, v5, v185
    v_mul_f32 v186, v6, v186
    v_mul_f32 v187, v7, v187
    v_mfma_f32_16x16x32_bf16 v[236:239], a[196:199], a[172:175], v[236:239]
    v_cvt_pk_bf16_f32 v176, v176, v177
    v_cvt_pk_bf16_f32 v177, v178, v179
    v_mfma_f32_16x16x32_bf16 v[228:231], a[192:195], a[172:175], v[228:231]
    v_cvt_pk_bf16_f32 v178, v184, v185
    v_cvt_pk_bf16_f32 v179, v186, v187
    buffer_store_dwordx4 v[176:179], v3, s[4:7], s71 offen offset:2048 sc1
    v_mfma_f32_16x16x32_bf16 v[192:195], a[240:243], a[128:131], v[192:195]
    v_mul_f32 v180, v16, v180
    v_mul_f32 v181, v17, v181
    v_mfma_f32_16x16x32_bf16 v[200:203], a[244:247], a[128:131], v[200:203]
    v_mul_f32 v182, v18, v182
    v_mul_f32 v183, v19, v183
    v_mul_f32 v188, v4, v188
    v_mfma_f32_16x16x32_bf16 v[208:211], a[248:251], a[128:131], v[208:211]
    v_mul_f32 v189, v5, v189
    v_mul_f32 v190, v6, v190
    v_mfma_f32_16x16x32_bf16 v[216:219], a[252:255], a[128:131], v[216:219]
    v_mul_f32 v191, v7, v191
    v_cvt_pk_bf16_f32 v180, v180, v181
    v_cvt_pk_bf16_f32 v181, v182, v183
    v_mfma_f32_16x16x4_4b_bf16 v[224:239], a[228:229], a[226:227], v[224:239]
    v_cvt_pk_bf16_f32 v182, v188, v189
    v_cvt_pk_bf16_f32 v183, v190, v191
    buffer_store_dwordx4 v[180:183], v3, s[4:7], s71 offen offset:3072 sc1
    s_add_u32 s71, s70, 1572864
    v_accvgpr_read_b32 v32, a64
    v_mfma_f32_16x16x32_bf16 v[220:223], a[252:255], a[132:135], v[220:223]
    v_accvgpr_read_b32 v33, a65
    v_accvgpr_read_b32 v34, a66
    v_mfma_f32_16x16x32_bf16 v[212:215], a[248:251], a[132:135], v[212:215]
    v_accvgpr_read_b32 v35, a67
    v_accvgpr_read_b32 v36, a72
    v_accvgpr_read_b32 v37, a73
    v_mfma_f32_16x16x32_bf16 v[204:207], a[244:247], a[132:135], v[204:207]
    v_accvgpr_read_b32 v38, a74
    v_accvgpr_read_b32 v39, a75
    v_mfma_f32_16x16x32_bf16 v[196:199], a[240:243], a[132:135], v[196:199]
    v_mul_f32 v32, v20, v32
    v_mul_f32 v33, v21, v33
    v_mul_f32 v34, v22, v34
    v_mfma_f32_16x16x32_bf16 v[224:227], a[240:243], a[136:139], v[224:227]
    v_mul_f32 v35, v23, v35
    v_mul_f32 v36, v24, v36
    v_mfma_f32_16x16x32_bf16 v[232:235], a[244:247], a[136:139], v[232:235]
    v_mul_f32 v37, v25, v37
    v_mul_f32 v38, v26, v38
    v_mul_f32 v39, v27, v39
    v_mfma_f32_16x16x32_bf16 v[240:243], a[248:251], a[136:139], v[240:243]
    v_cvt_pk_bf16_f32 v32, v32, v33
    v_cvt_pk_bf16_f32 v33, v34, v35
    v_mfma_f32_16x16x32_bf16 v[248:251], a[252:255], a[136:139], v[248:251]
    v_cvt_pk_bf16_f32 v34, v36, v37
    v_cvt_pk_bf16_f32 v35, v38, v39
    buffer_store_dwordx4 v[32:35], v3, s[4:7], s71 offen offset:2048 sc1
    v_mfma_f32_16x16x4_4b_bf16 v[192:207], a[228:229], a[224:225], v[192:207]
    v_accvgpr_read_b32 v40, a68
    v_accvgpr_read_b32 v41, a69
    v_accvgpr_read_b32 v42, a70
    v_accvgpr_read_b32 v43, a71
    v_accvgpr_read_b32 v44, a76
    v_mfma_f32_16x16x32_bf16 v[252:255], a[252:255], a[140:143], v[252:255]
    v_accvgpr_read_b32 v45, a77
    v_accvgpr_read_b32 v46, a78
    v_mfma_f32_16x16x32_bf16 v[244:247], a[248:251], a[140:143], v[244:247]
    v_accvgpr_read_b32 v47, a79
    v_mul_f32 v40, v20, v40
    v_mul_f32 v41, v21, v41
    v_mfma_f32_16x16x32_bf16 v[236:239], a[244:247], a[140:143], v[236:239]
    v_mul_f32 v42, v22, v42
    v_mul_f32 v43, v23, v43
    v_mfma_f32_16x16x32_bf16 v[228:231], a[240:243], a[140:143], v[228:231]
    v_mul_f32 v44, v24, v44
    v_mul_f32 v45, v25, v45
    v_mul_f32 v46, v26, v46
    s_waitcnt lgkmcnt(6)
    v_mfma_f32_16x16x32_bf16 v[192:195], a[176:179], a[144:147], v[192:195]
    v_mul_f32 v47, v27, v47
    v_cvt_pk_bf16_f32 v40, v40, v41
    v_mfma_f32_16x16x32_bf16 v[200:203], a[180:183], a[144:147], v[200:203]
    v_cvt_pk_bf16_f32 v41, v42, v43
    v_cvt_pk_bf16_f32 v42, v44, v45
    v_cvt_pk_bf16_f32 v43, v46, v47
    v_mfma_f32_16x16x32_bf16 v[208:211], a[184:187], a[144:147], v[208:211]
    buffer_store_dwordx4 v[40:43], v3, s[4:7], s71 offen offset:3072 sc1
    s_add_u32 s71, s70, 1576960
    v_mfma_f32_16x16x32_bf16 v[216:219], a[188:191], a[144:147], v[216:219]
    v_accvgpr_read_b32 v48, a80
    v_accvgpr_read_b32 v49, a81
    v_accvgpr_read_b32 v50, a82
    v_mfma_f32_16x16x4_4b_bf16 v[240:255], a[230:231], a[226:227], v[240:255]
    v_accvgpr_read_b32 v51, a83
    v_accvgpr_read_b32 v52, a88
    v_accvgpr_read_b32 v53, a89
    v_accvgpr_read_b32 v54, a90
    v_accvgpr_read_b32 v55, a91
    s_waitcnt lgkmcnt(4)
    v_mfma_f32_16x16x32_bf16 v[220:223], a[188:191], a[148:151], v[220:223]
    v_mul_f32 v48, v16, v48
    v_mul_f32 v49, v17, v49
    v_mfma_f32_16x16x32_bf16 v[212:215], a[184:187], a[148:151], v[212:215]
    v_mul_f32 v50, v18, v50
    v_mul_f32 v51, v19, v51
    v_mul_f32 v52, v4, v52
    v_mfma_f32_16x16x32_bf16 v[204:207], a[180:183], a[148:151], v[204:207]
    v_mul_f32 v53, v5, v53
    v_mul_f32 v54, v6, v54
    v_mfma_f32_16x16x32_bf16 v[196:199], a[176:179], a[148:151], v[196:199]
    v_mul_f32 v55, v7, v55
    v_cvt_pk_bf16_f32 v48, v48, v49
    v_cvt_pk_bf16_f32 v49, v50, v51
    s_waitcnt lgkmcnt(2)
    v_mfma_f32_16x16x32_bf16 v[224:227], a[176:179], a[152:155], v[224:227]
    v_cvt_pk_bf16_f32 v50, v52, v53
    v_cvt_pk_bf16_f32 v51, v54, v55
    v_mfma_f32_16x16x32_bf16 v[232:235], a[180:183], a[152:155], v[232:235]
    buffer_store_dwordx4 v[48:51], v3, s[4:7], s71 offen offset:2048 sc1
    v_accvgpr_read_b32 v56, a84
    v_accvgpr_read_b32 v57, a85
    v_mfma_f32_16x16x32_bf16 v[240:243], a[184:187], a[152:155], v[240:243]
    v_accvgpr_read_b32 v58, a86
    v_accvgpr_read_b32 v59, a87
    v_mfma_f32_16x16x32_bf16 v[248:251], a[188:191], a[152:155], v[248:251]
    v_accvgpr_read_b32 v60, a92
    v_accvgpr_read_b32 v61, a93
    v_accvgpr_read_b32 v62, a94
    v_mfma_f32_16x16x4_4b_bf16 v[208:223], a[230:231], a[224:225], v[208:223]
    v_accvgpr_read_b32 v63, a95
    v_mul_f32 v56, v16, v56
    v_mul_f32 v57, v17, v57
    v_mul_f32 v58, v18, v58
    v_mul_f32 v59, v19, v59
    s_waitcnt lgkmcnt(0)
    v_mfma_f32_16x16x32_bf16 v[252:255], a[188:191], a[156:159], v[252:255]
    v_mul_f32 v60, v4, v60
    v_mul_f32 v61, v5, v61
    v_mfma_f32_16x16x32_bf16 v[244:247], a[184:187], a[156:159], v[244:247]
    v_mul_f32 v62, v6, v62
    v_mul_f32 v63, v7, v63
    v_cvt_pk_bf16_f32 v56, v56, v57
    v_mfma_f32_16x16x32_bf16 v[236:239], a[180:183], a[156:159], v[236:239]
    v_cvt_pk_bf16_f32 v57, v58, v59
    v_cvt_pk_bf16_f32 v58, v60, v61
    v_mfma_f32_16x16x32_bf16 v[228:231], a[176:179], a[156:159], v[228:231]
    v_cvt_pk_bf16_f32 v59, v62, v63
    buffer_store_dwordx4 v[56:59], v3, s[4:7], s71 offen offset:3072 sc1
    s_add_u32 s71, s70, 786432
    v_mul_f32 v192, v20, v192
    v_mul_f32 v193, v21, v193
    v_mul_f32 v194, v22, v194
    v_mul_f32 v195, v23, v195
    v_mul_f32 v200, v24, v200
    v_mul_f32 v201, v25, v201
    v_mul_f32 v202, v26, v202
    v_mul_f32 v203, v27, v203
    v_cvt_pk_bf16_f32 v192, v192, v193
    v_cvt_pk_bf16_f32 v193, v194, v195
    v_cvt_pk_bf16_f32 v194, v200, v201
    v_cvt_pk_bf16_f32 v195, v202, v203
    buffer_store_dwordx4 v[192:195], v3, s[4:7], s71 offen offset:2048 sc1
    v_mul_f32 v196, v20, v196
    v_mul_f32 v197, v21, v197
    v_mul_f32 v198, v22, v198
    v_mul_f32 v199, v23, v199
    v_mul_f32 v204, v24, v204
    v_mul_f32 v205, v25, v205
    v_mul_f32 v206, v26, v206
    v_mul_f32 v207, v27, v207
    v_cvt_pk_bf16_f32 v196, v196, v197
    v_cvt_pk_bf16_f32 v197, v198, v199
    v_cvt_pk_bf16_f32 v198, v204, v205
    v_cvt_pk_bf16_f32 v199, v206, v207
    buffer_store_dwordx4 v[196:199], v3, s[4:7], s71 offen offset:3072 sc1
    s_add_u32 s71, s70, 790528
    v_mul_f32 v208, v16, v208
    v_mul_f32 v209, v17, v209
    v_mul_f32 v210, v18, v210
    v_mul_f32 v211, v19, v211
    v_mul_f32 v216, v4, v216
    v_mul_f32 v217, v5, v217
    v_mul_f32 v218, v6, v218
    v_mul_f32 v219, v7, v219
    v_cvt_pk_bf16_f32 v208, v208, v209
    v_cvt_pk_bf16_f32 v209, v210, v211
    v_cvt_pk_bf16_f32 v210, v216, v217
    v_cvt_pk_bf16_f32 v211, v218, v219
    buffer_store_dwordx4 v[208:211], v3, s[4:7], s71 offen offset:2048 sc1
    v_mul_f32 v212, v16, v212
    v_mul_f32 v213, v17, v213
    v_mul_f32 v214, v18, v214
    v_mul_f32 v215, v19, v215
    v_mul_f32 v220, v4, v220
    v_mul_f32 v221, v5, v221
    v_mul_f32 v222, v6, v222
    v_mul_f32 v223, v7, v223
    v_cvt_pk_bf16_f32 v212, v212, v213
    v_cvt_pk_bf16_f32 v213, v214, v215
    v_cvt_pk_bf16_f32 v214, v220, v221
    v_cvt_pk_bf16_f32 v215, v222, v223
    buffer_store_dwordx4 v[212:215], v3, s[4:7], s71 offen offset:3072 sc1
    s_add_u32 s71, s70, 1835008
    v_mul_f32 v224, v20, v224
    v_mul_f32 v225, v21, v225
    v_mul_f32 v226, v22, v226
    v_mul_f32 v227, v23, v227
    v_mul_f32 v232, v24, v232
    v_mul_f32 v233, v25, v233
    v_mul_f32 v234, v26, v234
    v_mul_f32 v235, v27, v235
    v_cvt_pk_bf16_f32 v224, v224, v225
    v_cvt_pk_bf16_f32 v225, v226, v227
    v_cvt_pk_bf16_f32 v226, v232, v233
    v_cvt_pk_bf16_f32 v227, v234, v235
    buffer_store_dwordx4 v[224:227], v3, s[4:7], s71 offen offset:2048 sc1
    v_mul_f32 v228, v20, v228
    v_mul_f32 v229, v21, v229
    v_mul_f32 v230, v22, v230
    v_mul_f32 v231, v23, v231
    v_mul_f32 v236, v24, v236
    v_mul_f32 v237, v25, v237
    v_mul_f32 v238, v26, v238
    v_mul_f32 v239, v27, v239
    v_cvt_pk_bf16_f32 v228, v228, v229
    v_cvt_pk_bf16_f32 v229, v230, v231
    v_cvt_pk_bf16_f32 v230, v236, v237
    v_cvt_pk_bf16_f32 v231, v238, v239
    buffer_store_dwordx4 v[228:231], v3, s[4:7], s71 offen offset:3072 sc1
    s_add_u32 s71, s70, 1839104
    v_mul_f32 v240, v16, v240
    v_mul_f32 v241, v17, v241
    v_mul_f32 v242, v18, v242
    v_mul_f32 v243, v19, v243
    v_mul_f32 v248, v4, v248
    v_mul_f32 v249, v5, v249
    v_mul_f32 v250, v6, v250
    v_mul_f32 v251, v7, v251
    v_cvt_pk_bf16_f32 v240, v240, v241
    v_cvt_pk_bf16_f32 v241, v242, v243
    v_cvt_pk_bf16_f32 v242, v248, v249
    v_cvt_pk_bf16_f32 v243, v250, v251
    buffer_store_dwordx4 v[240:243], v3, s[4:7], s71 offen offset:2048 sc1
    v_mul_f32 v244, v16, v244
    v_mul_f32 v245, v17, v245
    v_mul_f32 v246, v18, v246
    v_mul_f32 v247, v19, v247
    v_mul_f32 v252, v4, v252
    v_mul_f32 v253, v5, v253
    v_mul_f32 v254, v6, v254
    v_mul_f32 v255, v7, v255
    v_cvt_pk_bf16_f32 v244, v244, v245
    v_cvt_pk_bf16_f32 v245, v246, v247
    v_cvt_pk_bf16_f32 v246, v252, v253
    v_cvt_pk_bf16_f32 v247, v254, v255
    buffer_store_dwordx4 v[244:247], v3, s[4:7], s71 offen offset:3072 sc1
    s_endpgm
L_cs2_0:
    s_waitcnt lgkmcnt(0)
    s_cmp_lg_u32 s28, 0
    s_cbranch_scc1 L_cs2_0_1
    v_mfma_f32_16x16x32_bf16 a[208:211], a[96:99], v[28:31], a[208:211]
    v_mfma_f32_16x16x32_bf16 a[212:215], a[100:103], v[28:31], a[212:215]
    v_mfma_f32_16x16x32_bf16 a[216:219], a[104:107], v[28:31], a[216:219]
    v_mfma_f32_16x16x32_bf16 a[220:223], a[108:111], v[28:31], a[220:223]
    v_mfma_f32_16x16x32_bf16 a[224:227], a[112:115], v[28:31], a[224:227]
    s_branch L_csr2_0
L_cs2_0_1:
    s_cmp_lg_u32 s28, 1
    s_cbranch_scc1 L_cs2_0_2
    v_mfma_f32_16x16x32_bf16 a[208:211], a[116:119], v[28:31], a[208:211]
    v_mfma_f32_16x16x32_bf16 a[212:215], a[120:123], v[28:31], a[212:215]
    v_mfma_f32_16x16x32_bf16 a[216:219], a[124:127], v[28:31], a[216:219]
    v_mfma_f32_16x16x32_bf16 a[220:223], a[128:131], v[28:31], a[220:223]
    v_mfma_f32_16x16x32_bf16 a[224:227], a[132:135], v[28:31], a[224:227]
    s_branch L_csr2_0
L_cs2_0_2:
    s_cmp_lg_u32 s28, 2
    s_cbranch_scc1 L_cs2_0_3
    v_mfma_f32_16x16x32_bf16 a[208:211], a[136:139], v[28:31], a[208:211]
    v_mfma_f32_16x16x32_bf16 a[212:215], a[140:143], v[28:31], a[212:215]
    v_mfma_f32_16x16x32_bf16 a[216:219], a[144:147], v[28:31], a[216:219]
    v_mfma_f32_16x16x32_bf16 a[220:223], a[148:151], v[28:31], a[220:223]
    v_mfma_f32_16x16x32_bf16 a[224:227], a[152:155], v[28:31], a[224:227]
    s_branch L_csr2_0
L_cs2_0_3:
    v_mfma_f32_16x16x32_bf16 a[208:211], a[156:159], v[28:31], a[208:211]
    v_mfma_f32_16x16x32_bf16 a[212:215], a[160:163], v[28:31], a[212:215]
    v_mfma_f32_16x16x32_bf16 a[216:219], a[164:167], v[28:31], a[216:219]
    v_mfma_f32_16x16x32_bf16 a[220:223], a[168:171], v[28:31], a[220:223]
    v_mfma_f32_16x16x32_bf16 a[224:227], a[172:175], v[28:31], a[224:227]
    s_branch L_csr2_0
L_cs2_1:
    s_waitcnt lgkmcnt(0)
    s_cmp_lg_u32 s28, 0
    s_cbranch_scc1 L_cs2_1_1
    v_mfma_f32_16x16x32_bf16 a[208:211], a[96:99], v[28:31], a[208:211]
    v_mfma_f32_16x16x32_bf16 a[212:215], a[100:103], v[28:31], a[212:215]
    v_mfma_f32_16x16x32_bf16 a[216:219], a[104:107], v[28:31], a[216:219]
    v_mfma_f32_16x16x32_bf16 a[220:223], a[108:111], v[28:31], a[220:223]
    v_mfma_f32_16x16x32_bf16 a[224:227], a[112:115], v[28:31], a[224:227]
    s_branch L_csr2_1
L_cs2_1_1:
    s_cmp_lg_u32 s28, 1
    s_cbranch_scc1 L_cs2_1_2
    v_mfma_f32_16x16x32_bf16 a[208:211], a[116:119], v[28:31], a[208:211]
    v_mfma_f32_16x16x32_bf16 a[212:215], a[120:123], v[28:31], a[212:215]
    v_mfma_f32_16x16x32_bf16 a[216:219], a[124:127], v[28:31], a[216:219]
    v_mfma_f32_16x16x32_bf16 a[220:223], a[128:131], v[28:31], a[220:223]
    v_mfma_f32_16x16x32_bf16 a[224:227], a[132:135], v[28:31], a[224:227]
    s_branch L_csr2_1
L_cs2_1_2:
    s_cmp_lg_u32 s28, 2
    s_cbranch_scc1 L_cs2_1_3
    v_mfma_f32_16x16x32_bf16 a[208:211], a[136:139], v[28:31], a[208:211]
    v_mfma_f32_16x16x32_bf16 a[212:215], a[140:143], v[28:31], a[212:215]
    v_mfma_f32_16x16x32_bf16 a[216:219], a[144:147], v[28:31], a[216:219]
    v_mfma_f32_16x16x32_bf16 a[220:223], a[148:151], v[28:31], a[220:223]
    v_mfma_f32_16x16x32_bf16 a[224:227], a[152:155], v[28:31], a[224:227]
    s_branch L_csr2_1
L_cs2_1_3:
    v_mfma_f32_16x16x32_bf16 a[208:211], a[156:159], v[28:31], a[208:211]
    v_mfma_f32_16x16x32_bf16 a[212:215], a[160:163], v[28:31], a[212:215]
    v_mfma_f32_16x16x32_bf16 a[216:219], a[164:167], v[28:31], a[216:219]
    v_mfma_f32_16x16x32_bf16 a[220:223], a[168:171], v[28:31], a[220:223]
    v_mfma_f32_16x16x32_bf16 a[224:227], a[172:175], v[28:31], a[224:227]
    s_branch L_csr2_1
L_cs2_2:
    s_waitcnt lgkmcnt(0)
    s_cmp_lg_u32 s28, 0
    s_cbranch_scc1 L_cs2_2_1
    v_mfma_f32_16x16x32_bf16 a[208:211], a[96:99], v[28:31], a[208:211]
    v_mfma_f32_16x16x32_bf16 a[212:215], a[100:103], v[28:31], a[212:215]
    v_mfma_f32_16x16x32_bf16 a[216:219], a[104:107], v[28:31], a[216:219]
    v_mfma_f32_16x16x32_bf16 a[220:223], a[108:111], v[28:31], a[220:223]
    v_mfma_f32_16x16x32_bf16 a[224:227], a[112:115], v[28:31], a[224:227]
    s_branch L_csr2_2
L_cs2_2_1:
    s_cmp_lg_u32 s28, 1
    s_cbranch_scc1 L_cs2_2_2
    v_mfma_f32_16x16x32_bf16 a[208:211], a[116:119], v[28:31], a[208:211]
    v_mfma_f32_16x16x32_bf16 a[212:215], a[120:123], v[28:31], a[212:215]
    v_mfma_f32_16x16x32_bf16 a[216:219], a[124:127], v[28:31], a[216:219]
    v_mfma_f32_16x16x32_bf16 a[220:223], a[128:131], v[28:31], a[220:223]
    v_mfma_f32_16x16x32_bf16 a[224:227], a[132:135], v[28:31], a[224:227]
    s_branch L_csr2_2
L_cs2_2_2:
    s_cmp_lg_u32 s28, 2
    s_cbranch_scc1 L_cs2_2_3
    v_mfma_f32_16x16x32_bf16 a[208:211], a[136:139], v[28:31], a[208:211]
    v_mfma_f32_16x16x32_bf16 a[212:215], a[140:143], v[28:31], a[212:215]
    v_mfma_f32_16x16x32_bf16 a[216:219], a[144:147], v[28:31], a[216:219]
    v_mfma_f32_16x16x32_bf16 a[220:223], a[148:151], v[28:31], a[220:223]
    v_mfma_f32_16x16x32_bf16 a[224:227], a[152:155], v[28:31], a[224:227]
    s_branch L_csr2_2
L_cs2_2_3:
    v_mfma_f32_16x16x32_bf16 a[208:211], a[156:159], v[28:31], a[208:211]
    v_mfma_f32_16x16x32_bf16 a[212:215], a[160:163], v[28:31], a[212:215]
    v_mfma_f32_16x16x32_bf16 a[216:219], a[164:167], v[28:31], a[216:219]
    v_mfma_f32_16x16x32_bf16 a[220:223], a[168:171], v[28:31], a[220:223]
    v_mfma_f32_16x16x32_bf16 a[224:227], a[172:175], v[28:31], a[224:227]
    s_branch L_csr2_2
L_cs2_3:
    s_waitcnt lgkmcnt(0)
    s_cmp_lg_u32 s28, 0
    s_cbranch_scc1 L_cs2_3_1
    v_mfma_f32_16x16x32_bf16 a[208:211], a[96:99], v[28:31], a[208:211]
    v_mfma_f32_16x16x32_bf16 a[212:215], a[100:103], v[28:31], a[212:215]
    v_mfma_f32_16x16x32_bf16 a[216:219], a[104:107], v[28:31], a[216:219]
    v_mfma_f32_16x16x32_bf16 a[220:223], a[108:111], v[28:31], a[220:223]
    v_mfma_f32_16x16x32_bf16 a[224:227], a[112:115], v[28:31], a[224:227]
    s_branch L_csr2_3
L_cs2_3_1:
    s_cmp_lg_u32 s28, 1
    s_cbranch_scc1 L_cs2_3_2
    v_mfma_f32_16x16x32_bf16 a[208:211], a[116:119], v[28:31], a[208:211]
    v_mfma_f32_16x16x32_bf16 a[212:215], a[120:123], v[28:31], a[212:215]
    v_mfma_f32_16x16x32_bf16 a[216:219], a[124:127], v[28:31], a[216:219]
    v_mfma_f32_16x16x32_bf16 a[220:223], a[128:131], v[28:31], a[220:223]
    v_mfma_f32_16x16x32_bf16 a[224:227], a[132:135], v[28:31], a[224:227]
    s_branch L_csr2_3
L_cs2_3_2:
    s_cmp_lg_u32 s28, 2
    s_cbranch_scc1 L_cs2_3_3
    v_mfma_f32_16x16x32_bf16 a[208:211], a[136:139], v[28:31], a[208:211]
    v_mfma_f32_16x16x32_bf16 a[212:215], a[140:143], v[28:31], a[212:215]
    v_mfma_f32_16x16x32_bf16 a[216:219], a[144:147], v[28:31], a[216:219]
    v_mfma_f32_16x16x32_bf16 a[220:223], a[148:151], v[28:31], a[220:223]
    v_mfma_f32_16x16x32_bf16 a[224:227], a[152:155], v[28:31], a[224:227]
    s_branch L_csr2_3
L_cs2_3_3:
    v_mfma_f32_16x16x32_bf16 a[208:211], a[156:159], v[28:31], a[208:211]
    v_mfma_f32_16x16x32_bf16 a[212:215], a[160:163], v[28:31], a[212:215]
    v_mfma_f32_16x16x32_bf16 a[216:219], a[164:167], v[28:31], a[216:219]
    v_mfma_f32_16x16x32_bf16 a[220:223], a[168:171], v[28:31], a[220:223]
    v_mfma_f32_16x16x32_bf16 a[224:227], a[172:175], v[28:31], a[224:227]
    s_branch L_csr2_3
L_cst2:
    v_and_b32 v18, 48, v1
    s_mov_b32 exec_lo, 0x10001
    s_mov_b32 exec_hi, 0x10001
    buffer_store_dwordx4 a[208:211], v18, s[4:7], s78 offen offset:0 sc1
    buffer_store_dwordx4 a[212:215], v18, s[4:7], s78 offen offset:64 sc1
    buffer_store_dwordx4 a[216:219], v18, s[4:7], s78 offen offset:128 sc1
    buffer_store_dwordx4 a[220:223], v18, s[4:7], s78 offen offset:192 sc1
    buffer_store_dwordx4 a[224:227], v18, s[4:7], s78 offen offset:256 sc1
    s_mov_b64 exec, -1
    s_nop 1
    v_accvgpr_write_b32 a208, 0
    v_accvgpr_write_b32 a209, 0
    v_accvgpr_write_b32 a210, 0
    v_accvgpr_write_b32 a211, 0
    v_accvgpr_write_b32 a212, 0
    v_accvgpr_write_b32 a213, 0
    v_accvgpr_write_b32 a214, 0
    v_accvgpr_write_b32 a215, 0
    v_accvgpr_write_b32 a216, 0
    v_accvgpr_write_b32 a217, 0
    v_accvgpr_write_b32 a218, 0
    v_accvgpr_write_b32 a219, 0
    v_accvgpr_write_b32 a220, 0
    v_accvgpr_write_b32 a221, 0
    v_accvgpr_write_b32 a222, 0
    v_accvgpr_write_b32 a223, 0
    v_accvgpr_write_b32 a224, 0
    v_accvgpr_write_b32 a225, 0
    v_accvgpr_write_b32 a226, 0
    v_accvgpr_write_b32 a227, 0
    s_branch L_cstr2
L_sig2:
    s_mov_b64 exec, 1
    buffer_atomic_add v7, off, s[24:27], 0 sc1
    s_mov_b64 exec, -1
    s_branch L_sigr2
L_slow2:
    s_mov_b32 s29, 0x40000
L_slowl2:
    buffer_load_dword v18, off, s[24:27], 0 sc1
    s_waitcnt vmcnt(0)
    v_readfirstlane_b32 s77, v18
    s_cmp_ge_u32 s77, 256
    s_cbranch_scc1 L_slowr2
    s_sleep 2
    s_sub_u32 s29, s29, 1
    s_cmp_lg_u32 s29, 0
    s_cbranch_scc1 L_slowl2
    s_branch L_slowr2
L_g1_end:
    s_endpgm
.globl s3_kernel
.p2align 8
.type s3_kernel,@function
s3_kernel:
    s_cmp_ge_u32 s2, 256
    s_cbranch_scc1 L_s3_end
    s_load_dwordx2 s[50:51], s[0:1], 72
    s_load_dwordx2 s[48:49], s[0:1], 48
    s_load_dwordx2 s[52:53], s[0:1], 16
    s_load_dwordx2 s[54:55], s[0:1], 0
    s_load_dwordx2 s[44:45], s[0:1], 56
    v_lshrrev_b32 v15, 6, v0
    v_and_b32 v1, 63, v0
    v_readfirstlane_b32 s27, v15
    s_and_b32 s28, s27, 3
    s_cmp_ge_u32 s27, 4
    s_cbranch_scc1 L_s3_down
    s_and_b32 s56, s2, 7
    s_lshl_b32 s56, s56, 1
    s_bfe_u32 s57, s2, 0x10003
    s_add_u32 s56, s56, s57
    s_and_b32 s57, s2, 16
    s_add_u32 s56, s56, s57
    s_lshr_b32 s57, s2, 5
    v_lshlrev_b32 v2, 4, v1
    v_add_u32 v3, 0, v2
    s_lshl_b32 s58, s56, 6
    s_lshl_b32 s59, s57, 3
    s_lshl_b32 s60, s28, 1
    s_add_u32 s59, s59, s60
    s_add_u32 s60, s58, s59
    s_lshl_b32 s60, s60, 11
    s_add_u32 s60, s60, 0x400000
    s_lshl_b32 s33, s58, 12
    s_add_u32 s33, s33, 0x800000
    s_mov_b32 s36, s33
    s_lshl_b32 s41, s28, 11
    s_add_u32 s33, s33, s41
    s_add_u32 s41, s41, 0
    s_lshr_b32 s61, s59, 2
    s_mul_i32 s61, s61, 144
    s_add_u32 s61, s61, s56
    s_lshl_b32 s61, s61, 13
    s_and_b32 s62, s59, 3
    s_lshl_b32 s62, s62, 11
    s_add_u32 s61, s61, s62
    s_add_u32 s61, s61, 0x10e0000
    s_add_u32 s62, s61, 2048
    s_lshl_b32 s63, s59, 11
    s_lshl_b32 s67, s56, 7
    s_add_u32 s63, s63, s67
    s_add_u32 s63, s63, 0x3500000
    s_bfe_u32 s66, s2, 0x20001
    s_lshl_b32 s66, s66, 2
    s_bfe_u32 s67, s2, 0x20003
    s_add_u32 s66, s66, s67
    s_lshl_b32 s66, s66, 1
    s_add_u32 s66, s66, s28
    s_lshl_b32 s66, s66, 12
    s_add_u32 s66, s66, 0x3500000
    s_waitcnt lgkmcnt(0)
    s_mov_b32 s4, s50
    s_mov_b32 s5, s51
    s_mov_b32 s6, 0x3700000
    s_mov_b32 s7, 0x00020000
    s_add_u32 m0, s41, 0
    s_nop 0
    buffer_load_dwordx4 v2, s[4:7], s33 offen lds
    buffer_load_dwordx4 v2, s[4:7], s33 offen offset:1024 lds
    s_add_u32 s33, s33, 8192
    buffer_load_dwordx4 v[16:19], v2, s[4:7], s60 offen offset:0
    buffer_load_dwordx4 v[20:23], v2, s[4:7], s60 offen offset:1024
    buffer_load_dwordx4 v[24:27], v2, s[4:7], s60 offen offset:2048
    buffer_load_dwordx4 v[28:31], v2, s[4:7], s60 offen offset:3072
    s_add_u32 m0, s41, 8192
    s_nop 0
    buffer_load_dwordx4 v2, s[4:7], s33 offen lds
    buffer_load_dwordx4 v2, s[4:7], s33 offen offset:1024 lds
    s_add_u32 s33, s33, 8192
    s_add_u32 m0, s41, 16384
    s_nop 0
    buffer_load_dwordx4 v2, s[4:7], s33 offen lds
    buffer_load_dwordx4 v2, s[4:7], s33 offen offset:1024 lds
    s_add_u32 s33, s33, 8192
    s_add_u32 m0, s41, 24576
    s_nop 0
    buffer_load_dwordx4 v2, s[4:7], s33 offen lds
    buffer_load_dwordx4 v2, s[4:7], s33 offen offset:1024 lds
    s_add_u32 s33, s33, 8192
    v_mov_b32 v10, 0
    v_and_b32 v13, 3, v1
    v_lshlrev_b32 v13, 2, v13
    v_add_u32 v13, 155648, v13
    s_lshl_b32 s58, s28, 2
    s_add_u32 s58, s58, 155648
    v_mov_b32 v12, s58
    ds_write_b32 v12, v10
    ds_write_b32 v12, v10 offset:16
    ds_write_b32 v12, v10 offset:32
    s_mov_b32 s37, 0
    v_lshrrev_b32 v4, 4, v1
    v_xor_b32 v4, v4, v1
    v_and_b32 v4, 2, v4
    v_cmp_eq_u32 vcc, 0, v4
    v_mov_b32 v5, 0x3f803f80
    v_and_b32 v4, 1, v1
    v_mul_u32_u24 v4, 0xaaaa, v4
    v_cndmask_b32 v184, 0, v5, vcc
    v_cndmask_b32 v185, 0, v5, vcc
    v_cndmask_b32 v186, 0, v5, vcc
    v_cndmask_b32 v187, 0, v5, vcc
    v_add_u32 v14, 0x4444, v4
    v_mov_b32 v96, 0
    v_mov_b32 v97, 0
    v_mov_b32 v98, 0
    v_mov_b32 v99, 0
    v_mov_b32 v100, 0
    v_mov_b32 v101, 0
    v_mov_b32 v102, 0
    v_mov_b32 v103, 0
    v_mov_b32 v104, 0
    v_mov_b32 v105, 0
    v_mov_b32 v106, 0
    v_mov_b32 v107, 0
    v_mov_b32 v108, 0
    v_mov_b32 v109, 0
    v_mov_b32 v110, 0
    v_mov_b32 v111, 0
    v_mov_b32 v112, 0
    v_mov_b32 v113, 0
    v_mov_b32 v114, 0
    v_mov_b32 v115, 0
    v_mov_b32 v116, 0
    v_mov_b32 v117, 0
    v_mov_b32 v118, 0
    v_mov_b32 v119, 0
    v_mov_b32 v120, 0
    v_mov_b32 v121, 0
    v_mov_b32 v122, 0
    v_mov_b32 v123, 0
    v_mov_b32 v124, 0
    v_mov_b32 v125, 0
    v_mov_b32 v126, 0
    v_mov_b32 v127, 0
    v_mov_b32 v128, 0
    v_mov_b32 v129, 0
    v_mov_b32 v130, 0
    v_mov_b32 v131, 0
    v_mov_b32 v132, 0
    v_mov_b32 v133, 0
    v_mov_b32 v134, 0
    v_mov_b32 v135, 0
    s_waitcnt vmcnt(6) lgkmcnt(0)
    s_barrier
    ds_read_b128 v[152:155], v3 offset:0
    ds_read_b128 v[156:159], v3 offset:1024
    ds_read_b128 v[168:171], v3 offset:2048
    ds_read_b128 v[172:175], v3 offset:3072
    s_waitcnt lgkmcnt(0)
    v_mfma_f32_16x16x32_bf16 v[32:35], v[152:155], v[16:19], 0
    v_mfma_f32_16x16x32_bf16 v[36:39], v[156:159], v[16:19], 0
    v_mfma_f32_16x16x32_bf16 v[40:43], v[152:155], v[20:23], 0
    v_mfma_f32_16x16x32_bf16 v[44:47], v[156:159], v[20:23], 0
    v_mfma_f32_16x16x32_bf16 v[48:51], v[152:155], v[24:27], 0
    v_mfma_f32_16x16x32_bf16 v[52:55], v[156:159], v[24:27], 0
    v_mfma_f32_16x16x32_bf16 v[56:59], v[152:155], v[28:31], 0
    v_mfma_f32_16x16x32_bf16 v[60:63], v[156:159], v[28:31], 0
    s_nop 4
    v_max3_f32 v136, v32, v33, v34
    v_max3_f32 v140, v35, v36, v37
    v_max3_f32 v136, v136, v38, v39
    v_max_f32 v136, v136, v140
    v_max3_f32 v137, v40, v41, v42
    v_max3_f32 v141, v43, v44, v45
    v_max3_f32 v137, v137, v46, v47
    v_max_f32 v137, v137, v141
    v_max3_f32 v138, v48, v49, v50
    v_max3_f32 v142, v51, v52, v53
    v_max3_f32 v138, v138, v54, v55
    v_max_f32 v138, v138, v142
    v_max3_f32 v139, v56, v57, v58
    v_max3_f32 v143, v59, v60, v61
    v_max3_f32 v139, v139, v62, v63
    v_max_f32 v139, v139, v143
    v_mov_b32 v140, v136
    v_mov_b32 v141, v137
    v_mov_b32 v142, v138
    v_mov_b32 v143, v139
    v_permlane32_swap_b32 v136, v140
    v_permlane32_swap_b32 v137, v141
    v_permlane32_swap_b32 v138, v142
    v_permlane32_swap_b32 v139, v143
    v_max_f32 v136, v136, v140
    v_max_f32 v137, v137, v141
    v_max_f32 v138, v138, v142
    v_max_f32 v139, v139, v143
    v_mov_b32 v140, v136
    v_mov_b32 v141, v137
    v_mov_b32 v142, v138
    v_mov_b32 v143, v139
    v_permlane16_swap_b32 v136, v140
    v_permlane16_swap_b32 v137, v141
    v_permlane16_swap_b32 v138, v142
    v_permlane16_swap_b32 v139, v143
    v_max_f32 v136, v136, v140
    v_max_f32 v137, v137, v141
    v_max_f32 v138, v138, v142
    v_max_f32 v139, v139, v143
    v_sub_f32 v64, 0, v136
    v_sub_f32 v65, 0, v136
    v_sub_f32 v66, 0, v136
    v_sub_f32 v67, 0, v136
    v_sub_f32 v68, 0, v137
    v_sub_f32 v69, 0, v137
    v_sub_f32 v70, 0, v137
    v_sub_f32 v71, 0, v137
    v_sub_f32 v80, 0, v138
    v_sub_f32 v81, 0, v138
    v_sub_f32 v82, 0, v138
    v_sub_f32 v83, 0, v138
    v_sub_f32 v84, 0, v139
    v_sub_f32 v85, 0, v139
    v_sub_f32 v86, 0, v139
    v_sub_f32 v87, 0, v139
    v_sub_f32 v32, v32, v136
    v_sub_f32 v33, v33, v136
    v_sub_f32 v34, v34, v136
    v_sub_f32 v35, v35, v136
    v_sub_f32 v36, v36, v136
    v_sub_f32 v37, v37, v136
    v_sub_f32 v38, v38, v136
    v_sub_f32 v39, v39, v136
    v_sub_f32 v40, v40, v137
    v_sub_f32 v41, v41, v137
    v_sub_f32 v42, v42, v137
    v_sub_f32 v43, v43, v137
    v_sub_f32 v44, v44, v137
    v_sub_f32 v45, v45, v137
    v_sub_f32 v46, v46, v137
    v_sub_f32 v47, v47, v137
    v_mfma_f32_16x16x32_bf16 v[48:51], v[152:155], v[24:27], v[80:83]
    ds_read_b128 v[160:163], v3 offset:4096
    ds_read_b128 v[164:167], v3 offset:5120
    v_exp_f32 v32, v32
    v_exp_f32 v33, v33
    v_exp_f32 v34, v34
    v_cvt_pk_bf16_f32 v136, v32, v33
    v_exp_f32 v35, v35
    v_exp_f32 v36, v36
    v_mfma_f32_16x16x32_bf16 v[52:55], v[156:159], v[24:27], v[80:83]
    v_add_u32 v10, 1, v10
    s_waitcnt vmcnt(4)
    ds_write_b32 v12, v10
    v_cvt_pk_bf16_f32 v137, v34, v35
    v_exp_f32 v37, v37
    v_exp_f32 v38, v38
    v_cvt_pk_bf16_f32 v138, v36, v37
    v_exp_f32 v39, v39
    v_exp_f32 v40, v40
    v_mfma_f32_16x16x32_bf16 v[60:63], v[156:159], v[28:31], v[84:87]
    v_cvt_pk_bf16_f32 v139, v38, v39
    v_exp_f32 v41, v41
    v_exp_f32 v42, v42
    v_cvt_pk_bf16_f32 v140, v40, v41
    v_exp_f32 v43, v43
    v_exp_f32 v44, v44
    v_mfma_f32_16x16x32_bf16 v[56:59], v[152:155], v[28:31], v[84:87]
    v_cvt_pk_bf16_f32 v141, v42, v43
    v_exp_f32 v45, v45
    v_exp_f32 v46, v46
    v_exp_f32 v47, v47
    v_cvt_pk_bf16_f32 v142, v44, v45
    v_cvt_pk_bf16_f32 v143, v46, v47
    s_waitcnt lgkmcnt(2)
    v_mfma_f32_16x16x32_bf16 v[32:35], v[160:163], v[16:19], v[64:67]
    ds_read_b128 v[176:179], v3 offset:6144
    ds_read_b128 v[180:183], v3 offset:7168
    v_exp_f32 v48, v48
    v_exp_f32 v49, v49
    v_exp_f32 v50, v50
    s_waitcnt lgkmcnt(3)
    v_mfma_f32_16x16x32_bf16 v[36:39], v[164:167], v[16:19], v[64:67]
    v_cvt_pk_bf16_f32 v144, v48, v49
    v_exp_f32 v51, v51
    v_exp_f32 v52, v52
    v_mfma_f32_16x16x32_bf16 v[44:47], v[164:167], v[20:23], v[68:71]
    v_cvt_pk_bf16_f32 v145, v50, v51
    v_exp_f32 v53, v53
    v_exp_f32 v54, v54
    v_mfma_f32_16x16x32_bf16 v[40:43], v[160:163], v[20:23], v[68:71]
    v_cvt_pk_bf16_f32 v146, v52, v53
    v_exp_f32 v55, v55
    v_exp_f32 v56, v56
    v_smfmac_f32_16x16x64_bf16 v[128:131], v[184:187], v[136:143], v14
    v_mfma_f32_16x16x32_bf16 v[96:99], v[168:171], v[136:139], v[96:99]
    v_cvt_pk_bf16_f32 v147, v54, v55
    v_exp_f32 v57, v57
    v_exp_f32 v58, v58
    v_mfma_f32_16x16x32_bf16 v[100:103], v[172:175], v[136:139], v[100:103]
    v_cvt_pk_bf16_f32 v148, v56, v57
    v_exp_f32 v59, v59
    v_exp_f32 v60, v60
    v_mfma_f32_16x16x32_bf16 v[108:111], v[172:175], v[140:143], v[108:111]
    ds_read_b32 v11, v13
    v_cvt_pk_bf16_f32 v149, v58, v59
    v_exp_f32 v61, v61
    v_exp_f32 v62, v62
    v_mfma_f32_16x16x32_bf16 v[104:107], v[168:171], v[140:143], v[104:107]
    v_exp_f32 v63, v63
    v_cvt_pk_bf16_f32 v150, v60, v61
    v_cvt_pk_bf16_f32 v151, v62, v63
    s_mov_b32 s29, 5
L_att_loop:
    v_mfma_f32_16x16x32_bf16 v[48:51], v[160:163], v[24:27], v[80:83]
    s_waitcnt lgkmcnt(0)
    v_cmp_ge_u32 vcc, s37, v11
    s_cbranch_vccnz L_att_slow0
L_att_ret0:
    s_add_u32 s37, s37, 1
    ds_read_b128 v[152:155], v3 offset:8192
    ds_read_b128 v[156:159], v3 offset:9216
    v_exp_f32 v32, v32
    v_exp_f32 v33, v33
    v_exp_f32 v34, v34
    v_mfma_f32_16x16x32_bf16 v[52:55], v[164:167], v[24:27], v[80:83]
    s_add_u32 m0, s41, 32768
    v_cvt_pk_bf16_f32 v136, v32, v33
    v_exp_f32 v35, v35
    v_exp_f32 v36, v36
    v_mfma_f32_16x16x32_bf16 v[60:63], v[164:167], v[28:31], v[84:87]
    buffer_load_dwordx4 v2, s[4:7], s33 offen lds
    v_cvt_pk_bf16_f32 v137, v34, v35
    v_exp_f32 v37, v37
    v_exp_f32 v38, v38
    v_mfma_f32_16x16x32_bf16 v[56:59], v[160:163], v[28:31], v[84:87]
    buffer_load_dwordx4 v2, s[4:7], s33 offen offset:1024 lds
    s_add_u32 s33, s33, 8192
    v_cvt_pk_bf16_f32 v138, v36, v37
    v_exp_f32 v39, v39
    v_exp_f32 v40, v40
    v_smfmac_f32_16x16x64_bf16 v[132:135], v[184:187], v[144:151], v14
    v_mfma_f32_16x16x32_bf16 v[112:115], v[168:171], v[144:147], v[112:115]
    v_cvt_pk_bf16_f32 v139, v38, v39
    v_exp_f32 v41, v41
    v_exp_f32 v42, v42
    v_mfma_f32_16x16x32_bf16 v[116:119], v[172:175], v[144:147], v[116:119]
    v_cvt_pk_bf16_f32 v140, v40, v41
    v_exp_f32 v43, v43
    v_exp_f32 v44, v44
    v_mfma_f32_16x16x32_bf16 v[124:127], v[172:175], v[148:151], v[124:127]
    v_cvt_pk_bf16_f32 v141, v42, v43
    v_exp_f32 v45, v45
    v_exp_f32 v46, v46
    v_mfma_f32_16x16x32_bf16 v[120:123], v[168:171], v[148:151], v[120:123]
    v_exp_f32 v47, v47
    v_cvt_pk_bf16_f32 v142, v44, v45
    v_cvt_pk_bf16_f32 v143, v46, v47
    s_waitcnt lgkmcnt(1)
    v_mfma_f32_16x16x32_bf16 v[32:35], v[152:155], v[16:19], v[64:67]
    ds_read_b128 v[168:171], v3 offset:10240
    ds_read_b128 v[172:175], v3 offset:11264
    v_exp_f32 v48, v48
    v_exp_f32 v49, v49
    v_exp_f32 v50, v50
    s_waitcnt lgkmcnt(2)
    v_mfma_f32_16x16x32_bf16 v[36:39], v[156:159], v[16:19], v[64:67]
    v_cvt_pk_bf16_f32 v144, v48, v49
    v_exp_f32 v51, v51
    v_exp_f32 v52, v52
    v_mfma_f32_16x16x32_bf16 v[44:47], v[156:159], v[20:23], v[68:71]
    v_cvt_pk_bf16_f32 v145, v50, v51
    v_exp_f32 v53, v53
    v_exp_f32 v54, v54
    v_mfma_f32_16x16x32_bf16 v[40:43], v[152:155], v[20:23], v[68:71]
    v_cvt_pk_bf16_f32 v146, v52, v53
    v_exp_f32 v55, v55
    v_exp_f32 v56, v56
    v_smfmac_f32_16x16x64_bf16 v[128:131], v[184:187], v[136:143], v14
    v_mfma_f32_16x16x32_bf16 v[96:99], v[176:179], v[136:139], v[96:99]
    v_cvt_pk_bf16_f32 v147, v54, v55
    v_exp_f32 v57, v57
    v_exp_f32 v58, v58
    v_mfma_f32_16x16x32_bf16 v[100:103], v[180:183], v[136:139], v[100:103]
    v_cvt_pk_bf16_f32 v148, v56, v57
    v_exp_f32 v59, v59
    v_exp_f32 v60, v60
    v_mfma_f32_16x16x32_bf16 v[108:111], v[180:183], v[140:143], v[108:111]
    v_cvt_pk_bf16_f32 v149, v58, v59
    v_exp_f32 v61, v61
    v_exp_f32 v62, v62
    v_mfma_f32_16x16x32_bf16 v[104:107], v[176:179], v[140:143], v[104:107]
    v_exp_f32 v63, v63
    v_cvt_pk_bf16_f32 v150, v60, v61
    v_cvt_pk_bf16_f32 v151, v62, v63
    v_mfma_f32_16x16x32_bf16 v[48:51], v[152:155], v[24:27], v[80:83]
    ds_read_b128 v[160:163], v3 offset:12288
    ds_read_b128 v[164:167], v3 offset:13312
    v_exp_f32 v32, v32
    v_exp_f32 v33, v33
    v_exp_f32 v34, v34
    v_mfma_f32_16x16x32_bf16 v[52:55], v[156:159], v[24:27], v[80:83]
    v_add_u32 v10, 1, v10
    s_waitcnt vmcnt(4)
    ds_write_b32 v12, v10
    v_cvt_pk_bf16_f32 v136, v32, v33
    v_exp_f32 v35, v35
    v_exp_f32 v36, v36
    v_mfma_f32_16x16x32_bf16 v[60:63], v[156:159], v[28:31], v[84:87]
    v_cvt_pk_bf16_f32 v137, v34, v35
    v_exp_f32 v37, v37
    v_exp_f32 v38, v38
    v_mfma_f32_16x16x32_bf16 v[56:59], v[152:155], v[28:31], v[84:87]
    v_cvt_pk_bf16_f32 v138, v36, v37
    v_exp_f32 v39, v39
    v_exp_f32 v40, v40
    v_smfmac_f32_16x16x64_bf16 v[132:135], v[184:187], v[144:151], v14
    v_mfma_f32_16x16x32_bf16 v[112:115], v[176:179], v[144:147], v[112:115]
    v_cvt_pk_bf16_f32 v139, v38, v39
    v_exp_f32 v41, v41
    v_exp_f32 v42, v42
    v_mfma_f32_16x16x32_bf16 v[116:119], v[180:183], v[144:147], v[116:119]
    v_cvt_pk_bf16_f32 v140, v40, v41
    v_exp_f32 v43, v43
    v_exp_f32 v44, v44
    v_mfma_f32_16x16x32_bf16 v[124:127], v[180:183], v[148:151], v[124:127]
    v_cvt_pk_bf16_f32 v141, v42, v43
    v_exp_f32 v45, v45
    v_exp_f32 v46, v46
    v_mfma_f32_16x16x32_bf16 v[120:123], v[176:179], v[148:151], v[120:123]
    v_exp_f32 v47, v47
    v_cvt_pk_bf16_f32 v142, v44, v45
    v_cvt_pk_bf16_f32 v143, v46, v47
    s_waitcnt lgkmcnt(2)
    v_mfma_f32_16x16x32_bf16 v[32:35], v[160:163], v[16:19], v[64:67]
    ds_read_b128 v[176:179], v3 offset:14336
    ds_read_b128 v[180:183], v3 offset:15360
    v_exp_f32 v48, v48
    v_exp_f32 v49, v49
    v_exp_f32 v50, v50
    s_waitcnt lgkmcnt(3)
    v_mfma_f32_16x16x32_bf16 v[36:39], v[164:167], v[16:19], v[64:67]
    v_cvt_pk_bf16_f32 v144, v48, v49
    v_exp_f32 v51, v51
    v_exp_f32 v52, v52
    v_mfma_f32_16x16x32_bf16 v[44:47], v[164:167], v[20:23], v[68:71]
    v_cvt_pk_bf16_f32 v145, v50, v51
    v_exp_f32 v53, v53
    v_exp_f32 v54, v54
    v_mfma_f32_16x16x32_bf16 v[40:43], v[160:163], v[20:23], v[68:71]
    v_cvt_pk_bf16_f32 v146, v52, v53
    v_exp_f32 v55, v55
    v_exp_f32 v56, v56
    v_smfmac_f32_16x16x64_bf16 v[128:131], v[184:187], v[136:143], v14
    v_mfma_f32_16x16x32_bf16 v[96:99], v[168:171], v[136:139], v[96:99]
    v_cvt_pk_bf16_f32 v147, v54, v55
    v_exp_f32 v57, v57
    v_exp_f32 v58, v58
    v_mfma_f32_16x16x32_bf16 v[100:103], v[172:175], v[136:139], v[100:103]
    v_cvt_pk_bf16_f32 v148, v56, v57
    v_exp_f32 v59, v59
    v_exp_f32 v60, v60
    v_mfma_f32_16x16x32_bf16 v[108:111], v[172:175], v[140:143], v[108:111]
    ds_read_b32 v11, v13
    v_cvt_pk_bf16_f32 v149, v58, v59
    v_exp_f32 v61, v61
    v_exp_f32 v62, v62
    v_mfma_f32_16x16x32_bf16 v[104:107], v[168:171], v[140:143], v[104:107]
    v_exp_f32 v63, v63
    v_cvt_pk_bf16_f32 v150, v60, v61
    v_cvt_pk_bf16_f32 v151, v62, v63
    v_mfma_f32_16x16x32_bf16 v[48:51], v[160:163], v[24:27], v[80:83]
    s_waitcnt lgkmcnt(0)
    v_cmp_ge_u32 vcc, s37, v11
    s_cbranch_vccnz L_att_slow1
L_att_ret1:
    s_add_u32 s37, s37, 1
    ds_read_b128 v[152:155], v3 offset:16384
    ds_read_b128 v[156:159], v3 offset:17408
    v_exp_f32 v32, v32
    v_exp_f32 v33, v33
    v_exp_f32 v34, v34
    v_mfma_f32_16x16x32_bf16 v[52:55], v[164:167], v[24:27], v[80:83]
    s_add_u32 m0, s41, 0
    v_cvt_pk_bf16_f32 v136, v32, v33
    v_exp_f32 v35, v35
    v_exp_f32 v36, v36
    v_mfma_f32_16x16x32_bf16 v[60:63], v[164:167], v[28:31], v[84:87]
    buffer_load_dwordx4 v2, s[4:7], s33 offen lds
    v_cvt_pk_bf16_f32 v137, v34, v35
    v_exp_f32 v37, v37
    v_exp_f32 v38, v38
    v_mfma_f32_16x16x32_bf16 v[56:59], v[160:163], v[28:31], v[84:87]
    buffer_load_dwordx4 v2, s[4:7], s33 offen offset:1024 lds
    s_add_u32 s33, s33, 8192
    v_cvt_pk_bf16_f32 v138, v36, v37
    v_exp_f32 v39, v39
    v_exp_f32 v40, v40
    v_smfmac_f32_16x16x64_bf16 v[132:135], v[184:187], v[144:151], v14
    v_mfma_f32_16x16x32_bf16 v[112:115], v[168:171], v[144:147], v[112:115]
    v_cvt_pk_bf16_f32 v139, v38, v39
    v_exp_f32 v41, v41
    v_exp_f32 v42, v42
    v_mfma_f32_16x16x32_bf16 v[116:119], v[172:175], v[144:147], v[116:119]
    v_cvt_pk_bf16_f32 v140, v40, v41
    v_exp_f32 v43, v43
    v_exp_f32 v44, v44
    v_mfma_f32_16x16x32_bf16 v[124:127], v[172:175], v[148:151], v[124:127]
    v_cvt_pk_bf16_f32 v141, v42, v43
    v_exp_f32 v45, v45
    v_exp_f32 v46, v46
    v_mfma_f32_16x16x32_bf16 v[120:123], v[168:171], v[148:151], v[120:123]
    v_exp_f32 v47, v47
    v_cvt_pk_bf16_f32 v142, v44, v45
    v_cvt_pk_bf16_f32 v143, v46, v47
    s_waitcnt lgkmcnt(1)
    v_mfma_f32_16x16x32_bf16 v[32:35], v[152:155], v[16:19], v[64:67]
    ds_read_b128 v[168:171], v3 offset:18432
    ds_read_b128 v[172:175], v3 offset:19456
    v_exp_f32 v48, v48
    v_exp_f32 v49, v49
    v_exp_f32 v50, v50
    s_waitcnt lgkmcnt(2)
    v_mfma_f32_16x16x32_bf16 v[36:39], v[156:159], v[16:19], v[64:67]
    v_cvt_pk_bf16_f32 v144, v48, v49
    v_exp_f32 v51, v51
    v_exp_f32 v52, v52
    v_mfma_f32_16x16x32_bf16 v[44:47], v[156:159], v[20:23], v[68:71]
    v_cvt_pk_bf16_f32 v145, v50, v51
    v_exp_f32 v53, v53
    v_exp_f32 v54, v54
    v_mfma_f32_16x16x32_bf16 v[40:43], v[152:155], v[20:23], v[68:71]
    v_cvt_pk_bf16_f32 v146, v52, v53
    v_exp_f32 v55, v55
    v_exp_f32 v56, v56
    v_smfmac_f32_16x16x64_bf16 v[128:131], v[184:187], v[136:143], v14
    v_mfma_f32_16x16x32_bf16 v[96:99], v[176:179], v[136:139], v[96:99]
    v_cvt_pk_bf16_f32 v147, v54, v55
    v_exp_f32 v57, v57
    v_exp_f32 v58, v58
    v_mfma_f32_16x16x32_bf16 v[100:103], v[180:183], v[136:139], v[100:103]
    v_cvt_pk_bf16_f32 v148, v56, v57
    v_exp_f32 v59, v59
    v_exp_f32 v60, v60
    v_mfma_f32_16x16x32_bf16 v[108:111], v[180:183], v[140:143], v[108:111]
    v_cvt_pk_bf16_f32 v149, v58, v59
    v_exp_f32 v61, v61
    v_exp_f32 v62, v62
    v_mfma_f32_16x16x32_bf16 v[104:107], v[176:179], v[140:143], v[104:107]
    v_exp_f32 v63, v63
    v_cvt_pk_bf16_f32 v150, v60, v61
    v_cvt_pk_bf16_f32 v151, v62, v63
    v_mfma_f32_16x16x32_bf16 v[48:51], v[152:155], v[24:27], v[80:83]
    ds_read_b128 v[160:163], v3 offset:20480
    ds_read_b128 v[164:167], v3 offset:21504
    v_exp_f32 v32, v32
    v_exp_f32 v33, v33
    v_exp_f32 v34, v34
    v_mfma_f32_16x16x32_bf16 v[52:55], v[156:159], v[24:27], v[80:83]
    v_add_u32 v10, 1, v10
    s_waitcnt vmcnt(4)
    ds_write_b32 v12, v10
    v_cvt_pk_bf16_f32 v136, v32, v33
    v_exp_f32 v35, v35
    v_exp_f32 v36, v36
    v_mfma_f32_16x16x32_bf16 v[60:63], v[156:159], v[28:31], v[84:87]
    v_cvt_pk_bf16_f32 v137, v34, v35
    v_exp_f32 v37, v37
    v_exp_f32 v38, v38
    v_mfma_f32_16x16x32_bf16 v[56:59], v[152:155], v[28:31], v[84:87]
    v_cvt_pk_bf16_f32 v138, v36, v37
    v_exp_f32 v39, v39
    v_exp_f32 v40, v40
    v_smfmac_f32_16x16x64_bf16 v[132:135], v[184:187], v[144:151], v14
    v_mfma_f32_16x16x32_bf16 v[112:115], v[176:179], v[144:147], v[112:115]
    v_cvt_pk_bf16_f32 v139, v38, v39
    v_exp_f32 v41, v41
    v_exp_f32 v42, v42
    v_mfma_f32_16x16x32_bf16 v[116:119], v[180:183], v[144:147], v[116:119]
    v_cvt_pk_bf16_f32 v140, v40, v41
    v_exp_f32 v43, v43
    v_exp_f32 v44, v44
    v_mfma_f32_16x16x32_bf16 v[124:127], v[180:183], v[148:151], v[124:127]
    v_cvt_pk_bf16_f32 v141, v42, v43
    v_exp_f32 v45, v45
    v_exp_f32 v46, v46
    v_mfma_f32_16x16x32_bf16 v[120:123], v[176:179], v[148:151], v[120:123]
    v_exp_f32 v47, v47
    v_cvt_pk_bf16_f32 v142, v44, v45
    v_cvt_pk_bf16_f32 v143, v46, v47
    s_waitcnt lgkmcnt(2)
    v_mfma_f32_16x16x32_bf16 v[32:35], v[160:163], v[16:19], v[64:67]
    ds_read_b128 v[176:179], v3 offset:22528
    ds_read_b128 v[180:183], v3 offset:23552
    v_exp_f32 v48, v48
    v_exp_f32 v49, v49
    v_exp_f32 v50, v50
    s_waitcnt lgkmcnt(3)
    v_mfma_f32_16x16x32_bf16 v[36:39], v[164:167], v[16:19], v[64:67]
    v_cvt_pk_bf16_f32 v144, v48, v49
    v_exp_f32 v51, v51
    v_exp_f32 v52, v52
    v_mfma_f32_16x16x32_bf16 v[44:47], v[164:167], v[20:23], v[68:71]
    v_cvt_pk_bf16_f32 v145, v50, v51
    v_exp_f32 v53, v53
    v_exp_f32 v54, v54
    v_mfma_f32_16x16x32_bf16 v[40:43], v[160:163], v[20:23], v[68:71]
    v_cvt_pk_bf16_f32 v146, v52, v53
    v_exp_f32 v55, v55
    v_exp_f32 v56, v56
    v_smfmac_f32_16x16x64_bf16 v[128:131], v[184:187], v[136:143], v14
    v_mfma_f32_16x16x32_bf16 v[96:99], v[168:171], v[136:139], v[96:99]
    v_cvt_pk_bf16_f32 v147, v54, v55
    v_exp_f32 v57, v57
    v_exp_f32 v58, v58
    v_mfma_f32_16x16x32_bf16 v[100:103], v[172:175], v[136:139], v[100:103]
    v_cvt_pk_bf16_f32 v148, v56, v57
    v_exp_f32 v59, v59
    v_exp_f32 v60, v60
    v_mfma_f32_16x16x32_bf16 v[108:111], v[172:175], v[140:143], v[108:111]
    ds_read_b32 v11, v13
    v_cvt_pk_bf16_f32 v149, v58, v59
    v_exp_f32 v61, v61
    v_exp_f32 v62, v62
    v_mfma_f32_16x16x32_bf16 v[104:107], v[168:171], v[140:143], v[104:107]
    v_exp_f32 v63, v63
    v_cvt_pk_bf16_f32 v150, v60, v61
    v_cvt_pk_bf16_f32 v151, v62, v63
    v_mfma_f32_16x16x32_bf16 v[48:51], v[160:163], v[24:27], v[80:83]
    s_waitcnt lgkmcnt(0)
    v_cmp_ge_u32 vcc, s37, v11
    s_cbranch_vccnz L_att_slow2
L_att_ret2:
    s_add_u32 s37, s37, 1
    ds_read_b128 v[152:155], v3 offset:24576
    ds_read_b128 v[156:159], v3 offset:25600
    v_exp_f32 v32, v32
    v_exp_f32 v33, v33
    v_exp_f32 v34, v34
    v_mfma_f32_16x16x32_bf16 v[52:55], v[164:167], v[24:27], v[80:83]
    s_add_u32 m0, s41, 8192
    v_cvt_pk_bf16_f32 v136, v32, v33
    v_exp_f32 v35, v35
    v_exp_f32 v36, v36
    v_mfma_f32_16x16x32_bf16 v[60:63], v[164:167], v[28:31], v[84:87]
    buffer_load_dwordx4 v2, s[4:7], s33 offen lds
    v_cvt_pk_bf16_f32 v137, v34, v35
    v_exp_f32 v37, v37
    v_exp_f32 v38, v38
    v_mfma_f32_16x16x32_bf16 v[56:59], v[160:163], v[28:31], v[84:87]
    buffer_load_dwordx4 v2, s[4:7], s33 offen offset:1024 lds
    s_add_u32 s33, s33, 8192
    v_cvt_pk_bf16_f32 v138, v36, v37
    v_exp_f32 v39, v39
    v_exp_f32 v40, v40
    v_smfmac_f32_16x16x64_bf16 v[132:135], v[184:187], v[144:151], v14
    v_mfma_f32_16x16x32_bf16 v[112:115], v[168:171], v[144:147], v[112:115]
    v_cvt_pk_bf16_f32 v139, v38, v39
    v_exp_f32 v41, v41
    v_exp_f32 v42, v42
    v_mfma_f32_16x16x32_bf16 v[116:119], v[172:175], v[144:147], v[116:119]
    v_cvt_pk_bf16_f32 v140, v40, v41
    v_exp_f32 v43, v43
    v_exp_f32 v44, v44
    v_mfma_f32_16x16x32_bf16 v[124:127], v[172:175], v[148:151], v[124:127]
    v_cvt_pk_bf16_f32 v141, v42, v43
    v_exp_f32 v45, v45
    v_exp_f32 v46, v46
    v_mfma_f32_16x16x32_bf16 v[120:123], v[168:171], v[148:151], v[120:123]
    v_exp_f32 v47, v47
    v_cvt_pk_bf16_f32 v142, v44, v45
    v_cvt_pk_bf16_f32 v143, v46, v47
    s_waitcnt lgkmcnt(1)
    v_mfma_f32_16x16x32_bf16 v[32:35], v[152:155], v[16:19], v[64:67]
    ds_read_b128 v[168:171], v3 offset:26624
    ds_read_b128 v[172:175], v3 offset:27648
    v_exp_f32 v48, v48
    v_exp_f32 v49, v49
    v_exp_f32 v50, v50
    s_waitcnt lgkmcnt(2)
    v_mfma_f32_16x16x32_bf16 v[36:39], v[156:159], v[16:19], v[64:67]
    v_cvt_pk_bf16_f32 v144, v48, v49
    v_exp_f32 v51, v51
    v_exp_f32 v52, v52
    v_mfma_f32_16x16x32_bf16 v[44:47], v[156:159], v[20:23], v[68:71]
    v_cvt_pk_bf16_f32 v145, v50, v51
    v_exp_f32 v53, v53
    v_exp_f32 v54, v54
    v_mfma_f32_16x16x32_bf16 v[40:43], v[152:155], v[20:23], v[68:71]
    v_cvt_pk_bf16_f32 v146, v52, v53
    v_exp_f32 v55, v55
    v_exp_f32 v56, v56
    v_smfmac_f32_16x16x64_bf16 v[128:131], v[184:187], v[136:143], v14
    v_mfma_f32_16x16x32_bf16 v[96:99], v[176:179], v[136:139], v[96:99]
    v_cvt_pk_bf16_f32 v147, v54, v55
    v_exp_f32 v57, v57
    v_exp_f32 v58, v58
    v_mfma_f32_16x16x32_bf16 v[100:103], v[180:183], v[136:139], v[100:103]
    v_cvt_pk_bf16_f32 v148, v56, v57
    v_exp_f32 v59, v59
    v_exp_f32 v60, v60
    v_mfma_f32_16x16x32_bf16 v[108:111], v[180:183], v[140:143], v[108:111]
    v_cvt_pk_bf16_f32 v149, v58, v59
    v_exp_f32 v61, v61
    v_exp_f32 v62, v62
    v_mfma_f32_16x16x32_bf16 v[104:107], v[176:179], v[140:143], v[104:107]
    v_exp_f32 v63, v63
    v_cvt_pk_bf16_f32 v150, v60, v61
    v_cvt_pk_bf16_f32 v151, v62, v63
    v_mfma_f32_16x16x32_bf16 v[48:51], v[152:155], v[24:27], v[80:83]
    ds_read_b128 v[160:163], v3 offset:28672
    ds_read_b128 v[164:167], v3 offset:29696
    v_exp_f32 v32, v32
    v_exp_f32 v33, v33
    v_exp_f32 v34, v34
    v_mfma_f32_16x16x32_bf16 v[52:55], v[156:159], v[24:27], v[80:83]
    v_add_u32 v10, 1, v10
    s_waitcnt vmcnt(4)
    ds_write_b32 v12, v10
    v_cvt_pk_bf16_f32 v136, v32, v33
    v_exp_f32 v35, v35
    v_exp_f32 v36, v36
    v_mfma_f32_16x16x32_bf16 v[60:63], v[156:159], v[28:31], v[84:87]
    v_cvt_pk_bf16_f32 v137, v34, v35
    v_exp_f32 v37, v37
    v_exp_f32 v38, v38
    v_mfma_f32_16x16x32_bf16 v[56:59], v[152:155], v[28:31], v[84:87]
    v_cvt_pk_bf16_f32 v138, v36, v37
    v_exp_f32 v39, v39
    v_exp_f32 v40, v40
    v_smfmac_f32_16x16x64_bf16 v[132:135], v[184:187], v[144:151], v14
    v_mfma_f32_16x16x32_bf16 v[112:115], v[176:179], v[144:147], v[112:115]
    v_cvt_pk_bf16_f32 v139, v38, v39
    v_exp_f32 v41, v41
    v_exp_f32 v42, v42
    v_mfma_f32_16x16x32_bf16 v[116:119], v[180:183], v[144:147], v[116:119]
    v_cvt_pk_bf16_f32 v140, v40, v41
    v_exp_f32 v43, v43
    v_exp_f32 v44, v44
    v_mfma_f32_16x16x32_bf16 v[124:127], v[180:183], v[148:151], v[124:127]
    v_cvt_pk_bf16_f32 v141, v42, v43
    v_exp_f32 v45, v45
    v_exp_f32 v46, v46
    v_mfma_f32_16x16x32_bf16 v[120:123], v[176:179], v[148:151], v[120:123]
    v_exp_f32 v47, v47
    v_cvt_pk_bf16_f32 v142, v44, v45
    v_cvt_pk_bf16_f32 v143, v46, v47
    s_waitcnt lgkmcnt(2)
    v_mfma_f32_16x16x32_bf16 v[32:35], v[160:163], v[16:19], v[64:67]
    ds_read_b128 v[176:179], v3 offset:30720
    ds_read_b128 v[180:183], v3 offset:31744
    v_exp_f32 v48, v48
    v_exp_f32 v49, v49
    v_exp_f32 v50, v50
    s_waitcnt lgkmcnt(3)
    v_mfma_f32_16x16x32_bf16 v[36:39], v[164:167], v[16:19], v[64:67]
    v_cvt_pk_bf16_f32 v144, v48, v49
    v_exp_f32 v51, v51
    v_exp_f32 v52, v52
    v_mfma_f32_16x16x32_bf16 v[44:47], v[164:167], v[20:23], v[68:71]
    v_cvt_pk_bf16_f32 v145, v50, v51
    v_exp_f32 v53, v53
    v_exp_f32 v54, v54
    v_mfma_f32_16x16x32_bf16 v[40:43], v[160:163], v[20:23], v[68:71]
    v_cvt_pk_bf16_f32 v146, v52, v53
    v_exp_f32 v55, v55
    v_exp_f32 v56, v56
    v_smfmac_f32_16x16x64_bf16 v[128:131], v[184:187], v[136:143], v14
    v_mfma_f32_16x16x32_bf16 v[96:99], v[168:171], v[136:139], v[96:99]
    v_cvt_pk_bf16_f32 v147, v54, v55
    v_exp_f32 v57, v57
    v_exp_f32 v58, v58
    v_mfma_f32_16x16x32_bf16 v[100:103], v[172:175], v[136:139], v[100:103]
    v_cvt_pk_bf16_f32 v148, v56, v57
    v_exp_f32 v59, v59
    v_exp_f32 v60, v60
    v_mfma_f32_16x16x32_bf16 v[108:111], v[172:175], v[140:143], v[108:111]
    ds_read_b32 v11, v13
    v_cvt_pk_bf16_f32 v149, v58, v59
    v_exp_f32 v61, v61
    v_exp_f32 v62, v62
    v_mfma_f32_16x16x32_bf16 v[104:107], v[168:171], v[140:143], v[104:107]
    v_exp_f32 v63, v63
    v_cvt_pk_bf16_f32 v150, v60, v61
    v_cvt_pk_bf16_f32 v151, v62, v63
    v_mfma_f32_16x16x32_bf16 v[48:51], v[160:163], v[24:27], v[80:83]
    s_waitcnt lgkmcnt(0)
    v_cmp_ge_u32 vcc, s37, v11
    s_cbranch_vccnz L_att_slow3
L_att_ret3:
    s_add_u32 s37, s37, 1
    ds_read_b128 v[152:155], v3 offset:32768
    ds_read_b128 v[156:159], v3 offset:33792
    v_exp_f32 v32, v32
    v_exp_f32 v33, v33
    v_exp_f32 v34, v34
    v_mfma_f32_16x16x32_bf16 v[52:55], v[164:167], v[24:27], v[80:83]
    s_add_u32 m0, s41, 16384
    v_cvt_pk_bf16_f32 v136, v32, v33
    v_exp_f32 v35, v35
    v_exp_f32 v36, v36
    v_mfma_f32_16x16x32_bf16 v[60:63], v[164:167], v[28:31], v[84:87]
    buffer_load_dwordx4 v2, s[4:7], s33 offen lds
    v_cvt_pk_bf16_f32 v137, v34, v35
    v_exp_f32 v37, v37
    v_exp_f32 v38, v38
    v_mfma_f32_16x16x32_bf16 v[56:59], v[160:163], v[28:31], v[84:87]
    buffer_load_dwordx4 v2, s[4:7], s33 offen offset:1024 lds
    s_add_u32 s33, s33, 8192
    v_cvt_pk_bf16_f32 v138, v36, v37
    v_exp_f32 v39, v39
    v_exp_f32 v40, v40
    v_smfmac_f32_16x16x64_bf16 v[132:135], v[184:187], v[144:151], v14
    v_mfma_f32_16x16x32_bf16 v[112:115], v[168:171], v[144:147], v[112:115]
    v_cvt_pk_bf16_f32 v139, v38, v39
    v_exp_f32 v41, v41
    v_exp_f32 v42, v42
    v_mfma_f32_16x16x32_bf16 v[116:119], v[172:175], v[144:147], v[116:119]
    v_cvt_pk_bf16_f32 v140, v40, v41
    v_exp_f32 v43, v43
    v_exp_f32 v44, v44
    v_mfma_f32_16x16x32_bf16 v[124:127], v[172:175], v[148:151], v[124:127]
    v_cvt_pk_bf16_f32 v141, v42, v43
    v_exp_f32 v45, v45
    v_exp_f32 v46, v46
    v_mfma_f32_16x16x32_bf16 v[120:123], v[168:171], v[148:151], v[120:123]
    v_exp_f32 v47, v47
    v_cvt_pk_bf16_f32 v142, v44, v45
    v_cvt_pk_bf16_f32 v143, v46, v47
    s_waitcnt lgkmcnt(1)
    v_mfma_f32_16x16x32_bf16 v[32:35], v[152:155], v[16:19], v[64:67]
    ds_read_b128 v[168:171], v3 offset:34816
    ds_read_b128 v[172:175], v3 offset:35840
    v_exp_f32 v48, v48
    v_exp_f32 v49, v49
    v_exp_f32 v50, v50
    s_waitcnt lgkmcnt(2)
    v_mfma_f32_16x16x32_bf16 v[36:39], v[156:159], v[16:19], v[64:67]
    v_cvt_pk_bf16_f32 v144, v48, v49
    v_exp_f32 v51, v51
    v_exp_f32 v52, v52
    v_mfma_f32_16x16x32_bf16 v[44:47], v[156:159], v[20:23], v[68:71]
    v_cvt_pk_bf16_f32 v145, v50, v51
    v_exp_f32 v53, v53
    v_exp_f32 v54, v54
    v_mfma_f32_16x16x32_bf16 v[40:43], v[152:155], v[20:23], v[68:71]
    v_cvt_pk_bf16_f32 v146, v52, v53
    v_exp_f32 v55, v55
    v_exp_f32 v56, v56
    v_smfmac_f32_16x16x64_bf16 v[128:131], v[184:187], v[136:143], v14
    v_mfma_f32_16x16x32_bf16 v[96:99], v[176:179], v[136:139], v[96:99]
    v_cvt_pk_bf16_f32 v147, v54, v55
    v_exp_f32 v57, v57
    v_exp_f32 v58, v58
    v_mfma_f32_16x16x32_bf16 v[100:103], v[180:183], v[136:139], v[100:103]
    v_cvt_pk_bf16_f32 v148, v56, v57
    v_exp_f32 v59, v59
    v_exp_f32 v60, v60
    v_mfma_f32_16x16x32_bf16 v[108:111], v[180:183], v[140:143], v[108:111]
    v_cvt_pk_bf16_f32 v149, v58, v59
    v_exp_f32 v61, v61
    v_exp_f32 v62, v62
    v_mfma_f32_16x16x32_bf16 v[104:107], v[176:179], v[140:143], v[104:107]
    v_exp_f32 v63, v63
    v_cvt_pk_bf16_f32 v150, v60, v61
    v_cvt_pk_bf16_f32 v151, v62, v63
    v_mfma_f32_16x16x32_bf16 v[48:51], v[152:155], v[24:27], v[80:83]
    ds_read_b128 v[160:163], v3 offset:36864
    ds_read_b128 v[164:167], v3 offset:37888
    v_exp_f32 v32, v32
    v_exp_f32 v33, v33
    v_exp_f32 v34, v34
    v_mfma_f32_16x16x32_bf16 v[52:55], v[156:159], v[24:27], v[80:83]
    v_add_u32 v10, 1, v10
    s_waitcnt vmcnt(4)
    ds_write_b32 v12, v10
    v_cvt_pk_bf16_f32 v136, v32, v33
    v_exp_f32 v35, v35
    v_exp_f32 v36, v36
    v_mfma_f32_16x16x32_bf16 v[60:63], v[156:159], v[28:31], v[84:87]
    v_cvt_pk_bf16_f32 v137, v34, v35
    v_exp_f32 v37, v37
    v_exp_f32 v38, v38
    v_mfma_f32_16x16x32_bf16 v[56:59], v[152:155], v[28:31], v[84:87]
    v_cvt_pk_bf16_f32 v138, v36, v37
    v_exp_f32 v39, v39
    v_exp_f32 v40, v40
    v_smfmac_f32_16x16x64_bf16 v[132:135], v[184:187], v[144:151], v14
    v_mfma_f32_16x16x32_bf16 v[112:115], v[176:179], v[144:147], v[112:115]
    v_cvt_pk_bf16_f32 v139, v38, v39
    v_exp_f32 v41, v41
    v_exp_f32 v42, v42
    v_mfma_f32_16x16x32_bf16 v[116:119], v[180:183], v[144:147], v[116:119]
    v_cvt_pk_bf16_f32 v140, v40, v41
    v_exp_f32 v43, v43
    v_exp_f32 v44, v44
    v_mfma_f32_16x16x32_bf16 v[124:127], v[180:183], v[148:151], v[124:127]
    v_cvt_pk_bf16_f32 v141, v42, v43
    v_exp_f32 v45, v45
    v_exp_f32 v46, v46
    v_mfma_f32_16x16x32_bf16 v[120:123], v[176:179], v[148:151], v[120:123]
    v_exp_f32 v47, v47
    v_cvt_pk_bf16_f32 v142, v44, v45
    v_cvt_pk_bf16_f32 v143, v46, v47
    s_waitcnt lgkmcnt(2)
    v_mfma_f32_16x16x32_bf16 v[32:35], v[160:163], v[16:19], v[64:67]
    ds_read_b128 v[176:179], v3 offset:38912
    ds_read_b128 v[180:183], v3 offset:39936
    v_exp_f32 v48, v48
    v_exp_f32 v49, v49
    v_exp_f32 v50, v50
    s_waitcnt lgkmcnt(3)
    v_mfma_f32_16x16x32_bf16 v[36:39], v[164:167], v[16:19], v[64:67]
    v_cvt_pk_bf16_f32 v144, v48, v49
    v_exp_f32 v51, v51
    v_exp_f32 v52, v52
    v_mfma_f32_16x16x32_bf16 v[44:47], v[164:167], v[20:23], v[68:71]
    v_cvt_pk_bf16_f32 v145, v50, v51
    v_exp_f32 v53, v53
    v_exp_f32 v54, v54
    v_mfma_f32_16x16x32_bf16 v[40:43], v[160:163], v[20:23], v[68:71]
    v_cvt_pk_bf16_f32 v146, v52, v53
    v_exp_f32 v55, v55
    v_exp_f32 v56, v56
    v_smfmac_f32_16x16x64_bf16 v[128:131], v[184:187], v[136:143], v14
    v_mfma_f32_16x16x32_bf16 v[96:99], v[168:171], v[136:139], v[96:99]
    v_cvt_pk_bf16_f32 v147, v54, v55
    v_exp_f32 v57, v57
    v_exp_f32 v58, v58
    v_mfma_f32_16x16x32_bf16 v[100:103], v[172:175], v[136:139], v[100:103]
    v_cvt_pk_bf16_f32 v148, v56, v57
    v_exp_f32 v59, v59
    v_exp_f32 v60, v60
    v_mfma_f32_16x16x32_bf16 v[108:111], v[172:175], v[140:143], v[108:111]
    ds_read_b32 v11, v13
    v_cvt_pk_bf16_f32 v149, v58, v59
    v_exp_f32 v61, v61
    v_exp_f32 v62, v62
    v_mfma_f32_16x16x32_bf16 v[104:107], v[168:171], v[140:143], v[104:107]
    v_exp_f32 v63, v63
    v_cvt_pk_bf16_f32 v150, v60, v61
    v_cvt_pk_bf16_f32 v151, v62, v63
    v_mfma_f32_16x16x32_bf16 v[48:51], v[160:163], v[24:27], v[80:83]
    s_waitcnt lgkmcnt(0)
    v_cmp_ge_u32 vcc, s37, v11
    s_cbranch_vccnz L_att_slow4
L_att_ret4:
    s_add_u32 s37, s37, 1
    ds_read_b128 v[152:155], v3 offset:0
    ds_read_b128 v[156:159], v3 offset:1024
    v_exp_f32 v32, v32
    v_exp_f32 v33, v33
    v_exp_f32 v34, v34
    v_mfma_f32_16x16x32_bf16 v[52:55], v[164:167], v[24:27], v[80:83]
    s_add_u32 m0, s41, 24576
    v_cvt_pk_bf16_f32 v136, v32, v33
    v_exp_f32 v35, v35
    v_exp_f32 v36, v36
    v_mfma_f32_16x16x32_bf16 v[60:63], v[164:167], v[28:31], v[84:87]
    buffer_load_dwordx4 v2, s[4:7], s33 offen lds
    v_cvt_pk_bf16_f32 v137, v34, v35
    v_exp_f32 v37, v37
    v_exp_f32 v38, v38
    v_mfma_f32_16x16x32_bf16 v[56:59], v[160:163], v[28:31], v[84:87]
    buffer_load_dwordx4 v2, s[4:7], s33 offen offset:1024 lds
    s_add_u32 s33, s33, 8192
    v_cvt_pk_bf16_f32 v138, v36, v37
    v_exp_f32 v39, v39
    v_exp_f32 v40, v40
    v_smfmac_f32_16x16x64_bf16 v[132:135], v[184:187], v[144:151], v14
    v_mfma_f32_16x16x32_bf16 v[112:115], v[168:171], v[144:147], v[112:115]
    v_cvt_pk_bf16_f32 v139, v38, v39
    v_exp_f32 v41, v41
    v_exp_f32 v42, v42
    v_mfma_f32_16x16x32_bf16 v[116:119], v[172:175], v[144:147], v[116:119]
    v_cvt_pk_bf16_f32 v140, v40, v41
    v_exp_f32 v43, v43
    v_exp_f32 v44, v44
    v_mfma_f32_16x16x32_bf16 v[124:127], v[172:175], v[148:151], v[124:127]
    v_cvt_pk_bf16_f32 v141, v42, v43
    v_exp_f32 v45, v45
    v_exp_f32 v46, v46
    v_mfma_f32_16x16x32_bf16 v[120:123], v[168:171], v[148:151], v[120:123]
    v_exp_f32 v47, v47
    v_cvt_pk_bf16_f32 v142, v44, v45
    v_cvt_pk_bf16_f32 v143, v46, v47
    s_waitcnt lgkmcnt(1)
    v_mfma_f32_16x16x32_bf16 v[32:35], v[152:155], v[16:19], v[64:67]
    ds_read_b128 v[168:171], v3 offset:2048
    ds_read_b128 v[172:175], v3 offset:3072
    v_exp_f32 v48, v48
    v_exp_f32 v49, v49
    v_exp_f32 v50, v50
    s_waitcnt lgkmcnt(2)
    v_mfma_f32_16x16x32_bf16 v[36:39], v[156:159], v[16:19], v[64:67]
    v_cvt_pk_bf16_f32 v144, v48, v49
    v_exp_f32 v51, v51
    v_exp_f32 v52, v52
    v_mfma_f32_16x16x32_bf16 v[44:47], v[156:159], v[20:23], v[68:71]
    v_cvt_pk_bf16_f32 v145, v50, v51
    v_exp_f32 v53, v53
    v_exp_f32 v54, v54
    v_mfma_f32_16x16x32_bf16 v[40:43], v[152:155], v[20:23], v[68:71]
    v_cvt_pk_bf16_f32 v146, v52, v53
    v_exp_f32 v55, v55
    v_exp_f32 v56, v56
    v_smfmac_f32_16x16x64_bf16 v[128:131], v[184:187], v[136:143], v14
    v_mfma_f32_16x16x32_bf16 v[96:99], v[176:179], v[136:139], v[96:99]
    v_cvt_pk_bf16_f32 v147, v54, v55
    v_exp_f32 v57, v57
    v_exp_f32 v58, v58
    v_mfma_f32_16x16x32_bf16 v[100:103], v[180:183], v[136:139], v[100:103]
    v_cvt_pk_bf16_f32 v148, v56, v57
    v_exp_f32 v59, v59
    v_exp_f32 v60, v60
    v_mfma_f32_16x16x32_bf16 v[108:111], v[180:183], v[140:143], v[108:111]
    v_cvt_pk_bf16_f32 v149, v58, v59
    v_exp_f32 v61, v61
    v_exp_f32 v62, v62
    v_mfma_f32_16x16x32_bf16 v[104:107], v[176:179], v[140:143], v[104:107]
    v_exp_f32 v63, v63
    v_cvt_pk_bf16_f32 v150, v60, v61
    v_cvt_pk_bf16_f32 v151, v62, v63
    v_mfma_f32_16x16x32_bf16 v[48:51], v[152:155], v[24:27], v[80:83]
    ds_read_b128 v[160:163], v3 offset:4096
    ds_read_b128 v[164:167], v3 offset:5120
    v_exp_f32 v32, v32
    v_exp_f32 v33, v33
    v_exp_f32 v34, v34
    v_mfma_f32_16x16x32_bf16 v[52:55], v[156:159], v[24:27], v[80:83]
    v_add_u32 v10, 1, v10
    s_waitcnt vmcnt(4)
    ds_write_b32 v12, v10
    v_cvt_pk_bf16_f32 v136, v32, v33
    v_exp_f32 v35, v35
    v_exp_f32 v36, v36
    v_mfma_f32_16x16x32_bf16 v[60:63], v[156:159], v[28:31], v[84:87]
    v_cvt_pk_bf16_f32 v137, v34, v35
    v_exp_f32 v37, v37
    v_exp_f32 v38, v38
    v_mfma_f32_16x16x32_bf16 v[56:59], v[152:155], v[28:31], v[84:87]
    v_cvt_pk_bf16_f32 v138, v36, v37
    v_exp_f32 v39, v39
    v_exp_f32 v40, v40
    v_smfmac_f32_16x16x64_bf16 v[132:135], v[184:187], v[144:151], v14
    v_mfma_f32_16x16x32_bf16 v[112:115], v[176:179], v[144:147], v[112:115]
    v_cvt_pk_bf16_f32 v139, v38, v39
    v_exp_f32 v41, v41
    v_exp_f32 v42, v42
    v_mfma_f32_16x16x32_bf16 v[116:119], v[180:183], v[144:147], v[116:119]
    v_cvt_pk_bf16_f32 v140, v40, v41
    v_exp_f32 v43, v43
    v_exp_f32 v44, v44
    v_mfma_f32_16x16x32_bf16 v[124:127], v[180:183], v[148:151], v[124:127]
    v_cvt_pk_bf16_f32 v141, v42, v43
    v_exp_f32 v45, v45
    v_exp_f32 v46, v46
    v_mfma_f32_16x16x32_bf16 v[120:123], v[176:179], v[148:151], v[120:123]
    v_exp_f32 v47, v47
    v_cvt_pk_bf16_f32 v142, v44, v45
    v_cvt_pk_bf16_f32 v143, v46, v47
    s_waitcnt lgkmcnt(2)
    v_mfma_f32_16x16x32_bf16 v[32:35], v[160:163], v[16:19], v[64:67]
    ds_read_b128 v[176:179], v3 offset:6144
    ds_read_b128 v[180:183], v3 offset:7168
    v_exp_f32 v48, v48
    v_exp_f32 v49, v49
    v_exp_f32 v50, v50
    s_waitcnt lgkmcnt(3)
    v_mfma_f32_16x16x32_bf16 v[36:39], v[164:167], v[16:19], v[64:67]
    v_cvt_pk_bf16_f32 v144, v48, v49
    v_exp_f32 v51, v51
    v_exp_f32 v52, v52
    v_mfma_f32_16x16x32_bf16 v[44:47], v[164:167], v[20:23], v[68:71]
    v_cvt_pk_bf16_f32 v145, v50, v51
    v_exp_f32 v53, v53
    v_exp_f32 v54, v54
    v_mfma_f32_16x16x32_bf16 v[40:43], v[160:163], v[20:23], v[68:71]
    v_cvt_pk_bf16_f32 v146, v52, v53
    v_exp_f32 v55, v55
    v_exp_f32 v56, v56
    v_smfmac_f32_16x16x64_bf16 v[128:131], v[184:187], v[136:143], v14
    v_mfma_f32_16x16x32_bf16 v[96:99], v[168:171], v[136:139], v[96:99]
    v_cvt_pk_bf16_f32 v147, v54, v55
    v_exp_f32 v57, v57
    v_exp_f32 v58, v58
    v_mfma_f32_16x16x32_bf16 v[100:103], v[172:175], v[136:139], v[100:103]
    v_cvt_pk_bf16_f32 v148, v56, v57
    v_exp_f32 v59, v59
    v_exp_f32 v60, v60
    v_mfma_f32_16x16x32_bf16 v[108:111], v[172:175], v[140:143], v[108:111]
    ds_read_b32 v11, v13
    v_cvt_pk_bf16_f32 v149, v58, v59
    v_exp_f32 v61, v61
    v_exp_f32 v62, v62
    v_mfma_f32_16x16x32_bf16 v[104:107], v[168:171], v[140:143], v[104:107]
    v_exp_f32 v63, v63
    v_cvt_pk_bf16_f32 v150, v60, v61
    v_cvt_pk_bf16_f32 v151, v62, v63
    s_sub_u32 s29, s29, 1
    s_cmp_lg_u32 s29, 0
    s_cbranch_scc1 L_att_loop
    v_mfma_f32_16x16x32_bf16 v[48:51], v[160:163], v[24:27], v[80:83]
    s_waitcnt lgkmcnt(0)
    v_cmp_ge_u32 vcc, s37, v11
    s_cbranch_vccnz L_att_slow5
L_att_ret5:
    s_add_u32 s37, s37, 1
    ds_read_b128 v[152:155], v3 offset:8192
    ds_read_b128 v[156:159], v3 offset:9216
    v_exp_f32 v32, v32
    v_exp_f32 v33, v33
    v_exp_f32 v34, v34
    v_mfma_f32_16x16x32_bf16 v[52:55], v[164:167], v[24:27], v[80:83]
    s_add_u32 m0, s41, 32768
    v_cvt_pk_bf16_f32 v136, v32, v33
    v_exp_f32 v35, v35
    v_exp_f32 v36, v36
    v_mfma_f32_16x16x32_bf16 v[60:63], v[164:167], v[28:31], v[84:87]
    buffer_load_dwordx4 v2, s[4:7], s33 offen lds
    v_cvt_pk_bf16_f32 v137, v34, v35
    v_exp_f32 v37, v37
    v_exp_f32 v38, v38
    v_mfma_f32_16x16x32_bf16 v[56:59], v[160:163], v[28:31], v[84:87]
    buffer_load_dwordx4 v2, s[4:7], s33 offen offset:1024 lds
    s_add_u32 s33, s33, 8192
    v_cvt_pk_bf16_f32 v138, v36, v37
    v_exp_f32 v39, v39
    v_exp_f32 v40, v40
    v_smfmac_f32_16x16x64_bf16 v[132:135], v[184:187], v[144:151], v14
    v_mfma_f32_16x16x32_bf16 v[112:115], v[168:171], v[144:147], v[112:115]
    v_cvt_pk_bf16_f32 v139, v38, v39
    v_exp_f32 v41, v41
    v_exp_f32 v42, v42
    v_mfma_f32_16x16x32_bf16 v[116:119], v[172:175], v[144:147], v[116:119]
    v_cvt_pk_bf16_f32 v140, v40, v41
    v_exp_f32 v43, v43
    v_exp_f32 v44, v44
    v_mfma_f32_16x16x32_bf16 v[124:127], v[172:175], v[148:151], v[124:127]
    v_cvt_pk_bf16_f32 v141, v42, v43
    v_exp_f32 v45, v45
    v_exp_f32 v46, v46
    v_mfma_f32_16x16x32_bf16 v[120:123], v[168:171], v[148:151], v[120:123]
    v_exp_f32 v47, v47
    v_cvt_pk_bf16_f32 v142, v44, v45
    v_cvt_pk_bf16_f32 v143, v46, v47
    s_waitcnt lgkmcnt(1)
    v_mfma_f32_16x16x32_bf16 v[32:35], v[152:155], v[16:19], v[64:67]
    ds_read_b128 v[168:171], v3 offset:10240
    ds_read_b128 v[172:175], v3 offset:11264
    v_exp_f32 v48, v48
    v_exp_f32 v49, v49
    v_exp_f32 v50, v50
    s_waitcnt lgkmcnt(2)
    v_mfma_f32_16x16x32_bf16 v[36:39], v[156:159], v[16:19], v[64:67]
    v_cvt_pk_bf16_f32 v144, v48, v49
    v_exp_f32 v51, v51
    v_exp_f32 v52, v52
    v_mfma_f32_16x16x32_bf16 v[44:47], v[156:159], v[20:23], v[68:71]
    v_cvt_pk_bf16_f32 v145, v50, v51
    v_exp_f32 v53, v53
    v_exp_f32 v54, v54
    v_mfma_f32_16x16x32_bf16 v[40:43], v[152:155], v[20:23], v[68:71]
    v_cvt_pk_bf16_f32 v146, v52, v53
    v_exp_f32 v55, v55
    v_exp_f32 v56, v56
    v_smfmac_f32_16x16x64_bf16 v[128:131], v[184:187], v[136:143], v14
    v_mfma_f32_16x16x32_bf16 v[96:99], v[176:179], v[136:139], v[96:99]
    v_cvt_pk_bf16_f32 v147, v54, v55
    v_exp_f32 v57, v57
    v_exp_f32 v58, v58
    v_mfma_f32_16x16x32_bf16 v[100:103], v[180:183], v[136:139], v[100:103]
    v_cvt_pk_bf16_f32 v148, v56, v57
    v_exp_f32 v59, v59
    v_exp_f32 v60, v60
    v_mfma_f32_16x16x32_bf16 v[108:111], v[180:183], v[140:143], v[108:111]
    v_cvt_pk_bf16_f32 v149, v58, v59
    v_exp_f32 v61, v61
    v_exp_f32 v62, v62
    v_mfma_f32_16x16x32_bf16 v[104:107], v[176:179], v[140:143], v[104:107]
    v_exp_f32 v63, v63
    v_cvt_pk_bf16_f32 v150, v60, v61
    v_cvt_pk_bf16_f32 v151, v62, v63
    v_mfma_f32_16x16x32_bf16 v[48:51], v[152:155], v[24:27], v[80:83]
    ds_read_b128 v[160:163], v3 offset:12288
    ds_read_b128 v[164:167], v3 offset:13312
    v_exp_f32 v32, v32
    v_exp_f32 v33, v33
    v_exp_f32 v34, v34
    v_mfma_f32_16x16x32_bf16 v[52:55], v[156:159], v[24:27], v[80:83]
    v_add_u32 v10, 1, v10
    s_waitcnt vmcnt(4)
    ds_write_b32 v12, v10
    v_cvt_pk_bf16_f32 v136, v32, v33
    v_exp_f32 v35, v35
    v_exp_f32 v36, v36
    v_mfma_f32_16x16x32_bf16 v[60:63], v[156:159], v[28:31], v[84:87]
    v_cvt_pk_bf16_f32 v137, v34, v35
    v_exp_f32 v37, v37
    v_exp_f32 v38, v38
    v_mfma_f32_16x16x32_bf16 v[56:59], v[152:155], v[28:31], v[84:87]
    v_cvt_pk_bf16_f32 v138, v36, v37
    v_exp_f32 v39, v39
    v_exp_f32 v40, v40
    v_smfmac_f32_16x16x64_bf16 v[132:135], v[184:187], v[144:151], v14
    v_mfma_f32_16x16x32_bf16 v[112:115], v[176:179], v[144:147], v[112:115]
    v_cvt_pk_bf16_f32 v139, v38, v39
    v_exp_f32 v41, v41
    v_exp_f32 v42, v42
    v_mfma_f32_16x16x32_bf16 v[116:119], v[180:183], v[144:147], v[116:119]
    v_cvt_pk_bf16_f32 v140, v40, v41
    v_exp_f32 v43, v43
    v_exp_f32 v44, v44
    v_mfma_f32_16x16x32_bf16 v[124:127], v[180:183], v[148:151], v[124:127]
    v_cvt_pk_bf16_f32 v141, v42, v43
    v_exp_f32 v45, v45
    v_exp_f32 v46, v46
    v_mfma_f32_16x16x32_bf16 v[120:123], v[176:179], v[148:151], v[120:123]
    v_exp_f32 v47, v47
    v_cvt_pk_bf16_f32 v142, v44, v45
    v_cvt_pk_bf16_f32 v143, v46, v47
    s_waitcnt lgkmcnt(2)
    v_mfma_f32_16x16x32_bf16 v[32:35], v[160:163], v[16:19], v[64:67]
    ds_read_b128 v[176:179], v3 offset:14336
    ds_read_b128 v[180:183], v3 offset:15360
    v_exp_f32 v48, v48
    v_exp_f32 v49, v49
    v_exp_f32 v50, v50
    s_waitcnt lgkmcnt(3)
    v_mfma_f32_16x16x32_bf16 v[36:39], v[164:167], v[16:19], v[64:67]
    v_cvt_pk_bf16_f32 v144, v48, v49
    v_exp_f32 v51, v51
    v_exp_f32 v52, v52
    v_mfma_f32_16x16x32_bf16 v[44:47], v[164:167], v[20:23], v[68:71]
    v_cvt_pk_bf16_f32 v145, v50, v51
    v_exp_f32 v53, v53
    v_exp_f32 v54, v54
    v_mfma_f32_16x16x32_bf16 v[40:43], v[160:163], v[20:23], v[68:71]
    v_cvt_pk_bf16_f32 v146, v52, v53
    v_exp_f32 v55, v55
    v_exp_f32 v56, v56
    v_smfmac_f32_16x16x64_bf16 v[128:131], v[184:187], v[136:143], v14
    v_mfma_f32_16x16x32_bf16 v[96:99], v[168:171], v[136:139], v[96:99]
    v_cvt_pk_bf16_f32 v147, v54, v55
    v_exp_f32 v57, v57
    v_exp_f32 v58, v58
    v_mfma_f32_16x16x32_bf16 v[100:103], v[172:175], v[136:139], v[100:103]
    v_cvt_pk_bf16_f32 v148, v56, v57
    v_exp_f32 v59, v59
    v_exp_f32 v60, v60
    v_mfma_f32_16x16x32_bf16 v[108:111], v[172:175], v[140:143], v[108:111]
    ds_read_b32 v11, v13
    v_cvt_pk_bf16_f32 v149, v58, v59
    v_exp_f32 v61, v61
    v_exp_f32 v62, v62
    v_mfma_f32_16x16x32_bf16 v[104:107], v[168:171], v[140:143], v[104:107]
    v_exp_f32 v63, v63
    v_cvt_pk_bf16_f32 v150, v60, v61
    v_cvt_pk_bf16_f32 v151, v62, v63
    v_mfma_f32_16x16x32_bf16 v[48:51], v[160:163], v[24:27], v[80:83]
    s_waitcnt lgkmcnt(0)
    v_cmp_ge_u32 vcc, s37, v11
    s_cbranch_vccnz L_att_slow6
L_att_ret6:
    s_add_u32 s37, s37, 1
    ds_read_b128 v[152:155], v3 offset:16384
    ds_read_b128 v[156:159], v3 offset:17408
    v_exp_f32 v32, v32
    v_exp_f32 v33, v33
    v_exp_f32 v34, v34
    v_mfma_f32_16x16x32_bf16 v[52:55], v[164:167], v[24:27], v[80:83]
    s_add_u32 m0, s41, 0
    v_cvt_pk_bf16_f32 v136, v32, v33
    v_exp_f32 v35, v35
    v_exp_f32 v36, v36
    v_mfma_f32_16x16x32_bf16 v[60:63], v[164:167], v[28:31], v[84:87]
    buffer_load_dwordx4 v2, s[4:7], s33 offen lds
    v_cvt_pk_bf16_f32 v137, v34, v35
    v_exp_f32 v37, v37
    v_exp_f32 v38, v38
    v_mfma_f32_16x16x32_bf16 v[56:59], v[160:163], v[28:31], v[84:87]
    buffer_load_dwordx4 v2, s[4:7], s33 offen offset:1024 lds
    s_add_u32 s33, s33, 8192
    v_cvt_pk_bf16_f32 v138, v36, v37
    v_exp_f32 v39, v39
    v_exp_f32 v40, v40
    v_smfmac_f32_16x16x64_bf16 v[132:135], v[184:187], v[144:151], v14
    v_mfma_f32_16x16x32_bf16 v[112:115], v[168:171], v[144:147], v[112:115]
    v_cvt_pk_bf16_f32 v139, v38, v39
    v_exp_f32 v41, v41
    v_exp_f32 v42, v42
    v_mfma_f32_16x16x32_bf16 v[116:119], v[172:175], v[144:147], v[116:119]
    v_cvt_pk_bf16_f32 v140, v40, v41
    v_exp_f32 v43, v43
    v_exp_f32 v44, v44
    v_mfma_f32_16x16x32_bf16 v[124:127], v[172:175], v[148:151], v[124:127]
    v_cvt_pk_bf16_f32 v141, v42, v43
    v_exp_f32 v45, v45
    v_exp_f32 v46, v46
    v_mfma_f32_16x16x32_bf16 v[120:123], v[168:171], v[148:151], v[120:123]
    v_exp_f32 v47, v47
    v_cvt_pk_bf16_f32 v142, v44, v45
    v_cvt_pk_bf16_f32 v143, v46, v47
    s_waitcnt lgkmcnt(1)
    v_mfma_f32_16x16x32_bf16 v[32:35], v[152:155], v[16:19], v[64:67]
    ds_read_b128 v[168:171], v3 offset:18432
    ds_read_b128 v[172:175], v3 offset:19456
    v_exp_f32 v48, v48
    v_exp_f32 v49, v49
    v_exp_f32 v50, v50
    s_waitcnt lgkmcnt(2)
    v_mfma_f32_16x16x32_bf16 v[36:39], v[156:159], v[16:19], v[64:67]
    v_cvt_pk_bf16_f32 v144, v48, v49
    v_exp_f32 v51, v51
    v_exp_f32 v52, v52
    v_mfma_f32_16x16x32_bf16 v[44:47], v[156:159], v[20:23], v[68:71]
    v_cvt_pk_bf16_f32 v145, v50, v51
    v_exp_f32 v53, v53
    v_exp_f32 v54, v54
    v_mfma_f32_16x16x32_bf16 v[40:43], v[152:155], v[20:23], v[68:71]
    v_cvt_pk_bf16_f32 v146, v52, v53
    v_exp_f32 v55, v55
    v_exp_f32 v56, v56
    v_smfmac_f32_16x16x64_bf16 v[128:131], v[184:187], v[136:143], v14
    v_mfma_f32_16x16x32_bf16 v[96:99], v[176:179], v[136:139], v[96:99]
    v_cvt_pk_bf16_f32 v147, v54, v55
    v_exp_f32 v57, v57
    v_exp_f32 v58, v58
    v_mfma_f32_16x16x32_bf16 v[100:103], v[180:183], v[136:139], v[100:103]
    v_cvt_pk_bf16_f32 v148, v56, v57
    v_exp_f32 v59, v59
    v_exp_f32 v60, v60
    v_mfma_f32_16x16x32_bf16 v[108:111], v[180:183], v[140:143], v[108:111]
    v_cvt_pk_bf16_f32 v149, v58, v59
    v_exp_f32 v61, v61
    v_exp_f32 v62, v62
    v_mfma_f32_16x16x32_bf16 v[104:107], v[176:179], v[140:143], v[104:107]
    v_exp_f32 v63, v63
    v_cvt_pk_bf16_f32 v150, v60, v61
    v_cvt_pk_bf16_f32 v151, v62, v63
    v_mfma_f32_16x16x32_bf16 v[48:51], v[152:155], v[24:27], v[80:83]
    ds_read_b128 v[160:163], v3 offset:20480
    ds_read_b128 v[164:167], v3 offset:21504
    v_exp_f32 v32, v32
    v_exp_f32 v33, v33
    v_exp_f32 v34, v34
    v_mfma_f32_16x16x32_bf16 v[52:55], v[156:159], v[24:27], v[80:83]
    v_add_u32 v10, 1, v10
    s_waitcnt vmcnt(4)
    ds_write_b32 v12, v10
    v_cvt_pk_bf16_f32 v136, v32, v33
    v_exp_f32 v35, v35
    v_exp_f32 v36, v36
    v_mfma_f32_16x16x32_bf16 v[60:63], v[156:159], v[28:31], v[84:87]
    v_cvt_pk_bf16_f32 v137, v34, v35
    v_exp_f32 v37, v37
    v_exp_f32 v38, v38
    v_mfma_f32_16x16x32_bf16 v[56:59], v[152:155], v[28:31], v[84:87]
    v_cvt_pk_bf16_f32 v138, v36, v37
    v_exp_f32 v39, v39
    v_exp_f32 v40, v40
    v_smfmac_f32_16x16x64_bf16 v[132:135], v[184:187], v[144:151], v14
    v_mfma_f32_16x16x32_bf16 v[112:115], v[176:179], v[144:147], v[112:115]
    v_cvt_pk_bf16_f32 v139, v38, v39
    v_exp_f32 v41, v41
    v_exp_f32 v42, v42
    v_mfma_f32_16x16x32_bf16 v[116:119], v[180:183], v[144:147], v[116:119]
    v_cvt_pk_bf16_f32 v140, v40, v41
    v_exp_f32 v43, v43
    v_exp_f32 v44, v44
    v_mfma_f32_16x16x32_bf16 v[124:127], v[180:183], v[148:151], v[124:127]
    v_cvt_pk_bf16_f32 v141, v42, v43
    v_exp_f32 v45, v45
    v_exp_f32 v46, v46
    v_mfma_f32_16x16x32_bf16 v[120:123], v[176:179], v[148:151], v[120:123]
    v_exp_f32 v47, v47
    v_cvt_pk_bf16_f32 v142, v44, v45
    v_cvt_pk_bf16_f32 v143, v46, v47
    s_waitcnt lgkmcnt(2)
    v_mfma_f32_16x16x32_bf16 v[32:35], v[160:163], v[16:19], v[64:67]
    ds_read_b128 v[176:179], v3 offset:22528
    ds_read_b128 v[180:183], v3 offset:23552
    v_exp_f32 v48, v48
    v_exp_f32 v49, v49
    v_exp_f32 v50, v50
    s_waitcnt lgkmcnt(3)
    v_mfma_f32_16x16x32_bf16 v[36:39], v[164:167], v[16:19], v[64:67]
    v_cvt_pk_bf16_f32 v144, v48, v49
    v_exp_f32 v51, v51
    v_exp_f32 v52, v52
    v_mfma_f32_16x16x32_bf16 v[44:47], v[164:167], v[20:23], v[68:71]
    v_cvt_pk_bf16_f32 v145, v50, v51
    v_exp_f32 v53, v53
    v_exp_f32 v54, v54
    v_mfma_f32_16x16x32_bf16 v[40:43], v[160:163], v[20:23], v[68:71]
    v_cvt_pk_bf16_f32 v146, v52, v53
    v_exp_f32 v55, v55
    v_exp_f32 v56, v56
    v_smfmac_f32_16x16x64_bf16 v[128:131], v[184:187], v[136:143], v14
    v_mfma_f32_16x16x32_bf16 v[96:99], v[168:171], v[136:139], v[96:99]
    v_cvt_pk_bf16_f32 v147, v54, v55
    v_exp_f32 v57, v57
    v_exp_f32 v58, v58
    v_mfma_f32_16x16x32_bf16 v[100:103], v[172:175], v[136:139], v[100:103]
    v_cvt_pk_bf16_f32 v148, v56, v57
    v_exp_f32 v59, v59
    v_exp_f32 v60, v60
    v_mfma_f32_16x16x32_bf16 v[108:111], v[172:175], v[140:143], v[108:111]
    ds_read_b32 v11, v13
    v_cvt_pk_bf16_f32 v149, v58, v59
    v_exp_f32 v61, v61
    v_exp_f32 v62, v62
    v_mfma_f32_16x16x32_bf16 v[104:107], v[168:171], v[140:143], v[104:107]
    v_exp_f32 v63, v63
    v_cvt_pk_bf16_f32 v150, v60, v61
    v_cvt_pk_bf16_f32 v151, v62, v63
    v_mfma_f32_16x16x32_bf16 v[48:51], v[160:163], v[24:27], v[80:83]
    s_waitcnt lgkmcnt(0)
    v_cmp_ge_u32 vcc, s37, v11
    s_cbranch_vccnz L_att_slow7
L_att_ret7:
    s_add_u32 s37, s37, 1
    ds_read_b128 v[152:155], v3 offset:24576
    ds_read_b128 v[156:159], v3 offset:25600
    v_exp_f32 v32, v32
    v_exp_f32 v33, v33
    v_exp_f32 v34, v34
    v_mfma_f32_16x16x32_bf16 v[52:55], v[164:167], v[24:27], v[80:83]
    s_add_u32 m0, s41, 8192
    v_cvt_pk_bf16_f32 v136, v32, v33
    v_exp_f32 v35, v35
    v_exp_f32 v36, v36
    v_mfma_f32_16x16x32_bf16 v[60:63], v[164:167], v[28:31], v[84:87]
    buffer_load_dwordx4 v2, s[4:7], s33 offen lds
    v_cvt_pk_bf16_f32 v137, v34, v35
    v_exp_f32 v37, v37
    v_exp_f32 v38, v38
    v_mfma_f32_16x16x32_bf16 v[56:59], v[160:163], v[28:31], v[84:87]
    buffer_load_dwordx4 v2, s[4:7], s33 offen offset:1024 lds
    s_add_u32 s33, s33, 8192
    v_cvt_pk_bf16_f32 v138, v36, v37
    v_exp_f32 v39, v39
    v_exp_f32 v40, v40
    v_smfmac_f32_16x16x64_bf16 v[132:135], v[184:187], v[144:151], v14
    v_mfma_f32_16x16x32_bf16 v[112:115], v[168:171], v[144:147], v[112:115]
    v_cvt_pk_bf16_f32 v139, v38, v39
    v_exp_f32 v41, v41
    v_exp_f32 v42, v42
    v_mfma_f32_16x16x32_bf16 v[116:119], v[172:175], v[144:147], v[116:119]
    v_cvt_pk_bf16_f32 v140, v40, v41
    v_exp_f32 v43, v43
    v_exp_f32 v44, v44
    v_mfma_f32_16x16x32_bf16 v[124:127], v[172:175], v[148:151], v[124:127]
    v_cvt_pk_bf16_f32 v141, v42, v43
    v_exp_f32 v45, v45
    v_exp_f32 v46, v46
    v_mfma_f32_16x16x32_bf16 v[120:123], v[168:171], v[148:151], v[120:123]
    v_exp_f32 v47, v47
    v_cvt_pk_bf16_f32 v142, v44, v45
    v_cvt_pk_bf16_f32 v143, v46, v47
    s_waitcnt lgkmcnt(1)
    v_mfma_f32_16x16x32_bf16 v[32:35], v[152:155], v[16:19], v[64:67]
    ds_read_b128 v[168:171], v3 offset:26624
    ds_read_b128 v[172:175], v3 offset:27648
    v_exp_f32 v48, v48
    v_exp_f32 v49, v49
    v_exp_f32 v50, v50
    s_waitcnt lgkmcnt(2)
    v_mfma_f32_16x16x32_bf16 v[36:39], v[156:159], v[16:19], v[64:67]
    v_cvt_pk_bf16_f32 v144, v48, v49
    v_exp_f32 v51, v51
    v_exp_f32 v52, v52
    v_mfma_f32_16x16x32_bf16 v[44:47], v[156:159], v[20:23], v[68:71]
    v_cvt_pk_bf16_f32 v145, v50, v51
    v_exp_f32 v53, v53
    v_exp_f32 v54, v54
    v_mfma_f32_16x16x32_bf16 v[40:43], v[152:155], v[20:23], v[68:71]
    v_cvt_pk_bf16_f32 v146, v52, v53
    v_exp_f32 v55, v55
    v_exp_f32 v56, v56
    v_smfmac_f32_16x16x64_bf16 v[128:131], v[184:187], v[136:143], v14
    v_mfma_f32_16x16x32_bf16 v[96:99], v[176:179], v[136:139], v[96:99]
    v_cvt_pk_bf16_f32 v147, v54, v55
    v_exp_f32 v57, v57
    v_exp_f32 v58, v58
    v_mfma_f32_16x16x32_bf16 v[100:103], v[180:183], v[136:139], v[100:103]
    v_cvt_pk_bf16_f32 v148, v56, v57
    v_exp_f32 v59, v59
    v_exp_f32 v60, v60
    v_mfma_f32_16x16x32_bf16 v[108:111], v[180:183], v[140:143], v[108:111]
    v_cvt_pk_bf16_f32 v149, v58, v59
    v_exp_f32 v61, v61
    v_exp_f32 v62, v62
    v_mfma_f32_16x16x32_bf16 v[104:107], v[176:179], v[140:143], v[104:107]
    v_exp_f32 v63, v63
    v_cvt_pk_bf16_f32 v150, v60, v61
    v_cvt_pk_bf16_f32 v151, v62, v63
    v_mfma_f32_16x16x32_bf16 v[48:51], v[152:155], v[24:27], v[80:83]
    ds_read_b128 v[160:163], v3 offset:28672
    ds_read_b128 v[164:167], v3 offset:29696
    v_exp_f32 v32, v32
    v_exp_f32 v33, v33
    v_exp_f32 v34, v34
    v_mfma_f32_16x16x32_bf16 v[52:55], v[156:159], v[24:27], v[80:83]
    v_add_u32 v10, 1, v10
    s_waitcnt vmcnt(4)
    ds_write_b32 v12, v10
    v_cvt_pk_bf16_f32 v136, v32, v33
    v_exp_f32 v35, v35
    v_exp_f32 v36, v36
    v_mfma_f32_16x16x32_bf16 v[60:63], v[156:159], v[28:31], v[84:87]
    v_cvt_pk_bf16_f32 v137, v34, v35
    v_exp_f32 v37, v37
    v_exp_f32 v38, v38
    v_mfma_f32_16x16x32_bf16 v[56:59], v[152:155], v[28:31], v[84:87]
    v_cvt_pk_bf16_f32 v138, v36, v37
    v_exp_f32 v39, v39
    v_exp_f32 v40, v40
    v_smfmac_f32_16x16x64_bf16 v[132:135], v[184:187], v[144:151], v14
    v_mfma_f32_16x16x32_bf16 v[112:115], v[176:179], v[144:147], v[112:115]
    v_cvt_pk_bf16_f32 v139, v38, v39
    v_exp_f32 v41, v41
    v_exp_f32 v42, v42
    v_mfma_f32_16x16x32_bf16 v[116:119], v[180:183], v[144:147], v[116:119]
    v_cvt_pk_bf16_f32 v140, v40, v41
    v_exp_f32 v43, v43
    v_exp_f32 v44, v44
    v_mfma_f32_16x16x32_bf16 v[124:127], v[180:183], v[148:151], v[124:127]
    v_cvt_pk_bf16_f32 v141, v42, v43
    v_exp_f32 v45, v45
    v_exp_f32 v46, v46
    v_mfma_f32_16x16x32_bf16 v[120:123], v[176:179], v[148:151], v[120:123]
    v_exp_f32 v47, v47
    v_cvt_pk_bf16_f32 v142, v44, v45
    v_cvt_pk_bf16_f32 v143, v46, v47
    s_waitcnt lgkmcnt(2)
    v_mfma_f32_16x16x32_bf16 v[32:35], v[160:163], v[16:19], v[64:67]
    ds_read_b128 v[176:179], v3 offset:30720
    ds_read_b128 v[180:183], v3 offset:31744
    v_exp_f32 v48, v48
    v_exp_f32 v49, v49
    v_exp_f32 v50, v50
    s_waitcnt lgkmcnt(3)
    v_mfma_f32_16x16x32_bf16 v[36:39], v[164:167], v[16:19], v[64:67]
    v_cvt_pk_bf16_f32 v144, v48, v49
    v_exp_f32 v51, v51
    v_exp_f32 v52, v52
    v_mfma_f32_16x16x32_bf16 v[44:47], v[164:167], v[20:23], v[68:71]
    v_cvt_pk_bf16_f32 v145, v50, v51
    v_exp_f32 v53, v53
    v_exp_f32 v54, v54
    v_mfma_f32_16x16x32_bf16 v[40:43], v[160:163], v[20:23], v[68:71]
    v_cvt_pk_bf16_f32 v146, v52, v53
    v_exp_f32 v55, v55
    v_exp_f32 v56, v56
    v_smfmac_f32_16x16x64_bf16 v[128:131], v[184:187], v[136:143], v14
    v_mfma_f32_16x16x32_bf16 v[96:99], v[168:171], v[136:139], v[96:99]
    v_cvt_pk_bf16_f32 v147, v54, v55
    v_exp_f32 v57, v57
    v_exp_f32 v58, v58
    v_mfma_f32_16x16x32_bf16 v[100:103], v[172:175], v[136:139], v[100:103]
    v_cvt_pk_bf16_f32 v148, v56, v57
    v_exp_f32 v59, v59
    v_exp_f32 v60, v60
    v_mfma_f32_16x16x32_bf16 v[108:111], v[172:175], v[140:143], v[108:111]
    ds_read_b32 v11, v13
    v_cvt_pk_bf16_f32 v149, v58, v59
    v_exp_f32 v61, v61
    v_exp_f32 v62, v62
    v_mfma_f32_16x16x32_bf16 v[104:107], v[168:171], v[140:143], v[104:107]
    v_exp_f32 v63, v63
    v_cvt_pk_bf16_f32 v150, v60, v61
    v_cvt_pk_bf16_f32 v151, v62, v63
    v_mfma_f32_16x16x32_bf16 v[48:51], v[160:163], v[24:27], v[80:83]
    s_waitcnt lgkmcnt(0)
    v_cmp_ge_u32 vcc, s37, v11
    s_cbranch_vccnz L_att_slow8
L_att_ret8:
    s_add_u32 s37, s37, 1
    ds_read_b128 v[152:155], v3 offset:32768
    ds_read_b128 v[156:159], v3 offset:33792
    v_exp_f32 v32, v32
    v_exp_f32 v33, v33
    v_exp_f32 v34, v34
    v_mfma_f32_16x16x32_bf16 v[52:55], v[164:167], v[24:27], v[80:83]
    v_cvt_pk_bf16_f32 v136, v32, v33
    v_exp_f32 v35, v35
    v_exp_f32 v36, v36
    v_mfma_f32_16x16x32_bf16 v[60:63], v[164:167], v[28:31], v[84:87]
    v_cvt_pk_bf16_f32 v137, v34, v35
    v_exp_f32 v37, v37
    v_exp_f32 v38, v38
    v_mfma_f32_16x16x32_bf16 v[56:59], v[160:163], v[28:31], v[84:87]
    v_cvt_pk_bf16_f32 v138, v36, v37
    v_exp_f32 v39, v39
    v_exp_f32 v40, v40
    v_smfmac_f32_16x16x64_bf16 v[132:135], v[184:187], v[144:151], v14
    v_mfma_f32_16x16x32_bf16 v[112:115], v[168:171], v[144:147], v[112:115]
    v_cvt_pk_bf16_f32 v139, v38, v39
    v_exp_f32 v41, v41
    v_exp_f32 v42, v42
    v_mfma_f32_16x16x32_bf16 v[116:119], v[172:175], v[144:147], v[116:119]
    v_cvt_pk_bf16_f32 v140, v40, v41
    v_exp_f32 v43, v43
    v_exp_f32 v44, v44
    v_mfma_f32_16x16x32_bf16 v[124:127], v[172:175], v[148:151], v[124:127]
    v_cvt_pk_bf16_f32 v141, v42, v43
    v_exp_f32 v45, v45
    v_exp_f32 v46, v46
    v_mfma_f32_16x16x32_bf16 v[120:123], v[168:171], v[148:151], v[120:123]
    v_exp_f32 v47, v47
    v_cvt_pk_bf16_f32 v142, v44, v45
    v_cvt_pk_bf16_f32 v143, v46, v47
    s_waitcnt lgkmcnt(1)
    v_mfma_f32_16x16x32_bf16 v[32:35], v[152:155], v[16:19], v[64:67]
    ds_read_b128 v[168:171], v3 offset:34816
    ds_read_b128 v[172:175], v3 offset:35840
    v_exp_f32 v48, v48
    v_exp_f32 v49, v49
    v_exp_f32 v50, v50
    s_waitcnt lgkmcnt(2)
    v_mfma_f32_16x16x32_bf16 v[36:39], v[156:159], v[16:19], v[64:67]
    v_cvt_pk_bf16_f32 v144, v48, v49
    v_exp_f32 v51, v51
    v_exp_f32 v52, v52
    v_mfma_f32_16x16x32_bf16 v[44:47], v[156:159], v[20:23], v[68:71]
    v_cvt_pk_bf16_f32 v145, v50, v51
    v_exp_f32 v53, v53
    v_exp_f32 v54, v54
    v_mfma_f32_16x16x32_bf16 v[40:43], v[152:155], v[20:23], v[68:71]
    v_cvt_pk_bf16_f32 v146, v52, v53
    v_exp_f32 v55, v55
    v_exp_f32 v56, v56
    v_smfmac_f32_16x16x64_bf16 v[128:131], v[184:187], v[136:143], v14
    v_mfma_f32_16x16x32_bf16 v[96:99], v[176:179], v[136:139], v[96:99]
    v_cvt_pk_bf16_f32 v147, v54, v55
    v_exp_f32 v57, v57
    v_exp_f32 v58, v58
    v_mfma_f32_16x16x32_bf16 v[100:103], v[180:183], v[136:139], v[100:103]
    v_cvt_pk_bf16_f32 v148, v56, v57
    v_exp_f32 v59, v59
    v_exp_f32 v60, v60
    v_mfma_f32_16x16x32_bf16 v[108:111], v[180:183], v[140:143], v[108:111]
    v_cvt_pk_bf16_f32 v149, v58, v59
    v_exp_f32 v61, v61
    v_exp_f32 v62, v62
    v_mfma_f32_16x16x32_bf16 v[104:107], v[176:179], v[140:143], v[104:107]
    v_exp_f32 v63, v63
    v_cvt_pk_bf16_f32 v150, v60, v61
    v_cvt_pk_bf16_f32 v151, v62, v63
    v_mfma_f32_16x16x32_bf16 v[48:51], v[152:155], v[24:27], v[80:83]
    ds_read_b128 v[160:163], v3 offset:36864
    ds_read_b128 v[164:167], v3 offset:37888
    v_exp_f32 v32, v32
    v_exp_f32 v33, v33
    v_exp_f32 v34, v34
    v_mfma_f32_16x16x32_bf16 v[52:55], v[156:159], v[24:27], v[80:83]
    v_add_u32 v10, 1, v10
    s_waitcnt vmcnt(2)
    ds_write_b32 v12, v10
    v_cvt_pk_bf16_f32 v136, v32, v33
    v_exp_f32 v35, v35
    v_exp_f32 v36, v36
    v_mfma_f32_16x16x32_bf16 v[60:63], v[156:159], v[28:31], v[84:87]
    v_cvt_pk_bf16_f32 v137, v34, v35
    v_exp_f32 v37, v37
    v_exp_f32 v38, v38
    v_mfma_f32_16x16x32_bf16 v[56:59], v[152:155], v[28:31], v[84:87]
    v_cvt_pk_bf16_f32 v138, v36, v37
    v_exp_f32 v39, v39
    v_exp_f32 v40, v40
    v_smfmac_f32_16x16x64_bf16 v[132:135], v[184:187], v[144:151], v14
    v_mfma_f32_16x16x32_bf16 v[112:115], v[176:179], v[144:147], v[112:115]
    v_cvt_pk_bf16_f32 v139, v38, v39
    v_exp_f32 v41, v41
    v_exp_f32 v42, v42
    v_mfma_f32_16x16x32_bf16 v[116:119], v[180:183], v[144:147], v[116:119]
    v_cvt_pk_bf16_f32 v140, v40, v41
    v_exp_f32 v43, v43
    v_exp_f32 v44, v44
    v_mfma_f32_16x16x32_bf16 v[124:127], v[180:183], v[148:151], v[124:127]
    v_cvt_pk_bf16_f32 v141, v42, v43
    v_exp_f32 v45, v45
    v_exp_f32 v46, v46
    v_mfma_f32_16x16x32_bf16 v[120:123], v[176:179], v[148:151], v[120:123]
    v_exp_f32 v47, v47
    v_cvt_pk_bf16_f32 v142, v44, v45
    v_cvt_pk_bf16_f32 v143, v46, v47
    s_waitcnt lgkmcnt(2)
    v_mfma_f32_16x16x32_bf16 v[32:35], v[160:163], v[16:19], v[64:67]
    ds_read_b128 v[176:179], v3 offset:38912
    ds_read_b128 v[180:183], v3 offset:39936
    v_exp_f32 v48, v48
    v_exp_f32 v49, v49
    v_exp_f32 v50, v50
    s_waitcnt lgkmcnt(3)
    v_mfma_f32_16x16x32_bf16 v[36:39], v[164:167], v[16:19], v[64:67]
    v_cvt_pk_bf16_f32 v144, v48, v49
    v_exp_f32 v51, v51
    v_exp_f32 v52, v52
    v_mfma_f32_16x16x32_bf16 v[44:47], v[164:167], v[20:23], v[68:71]
    v_cvt_pk_bf16_f32 v145, v50, v51
    v_exp_f32 v53, v53
    v_exp_f32 v54, v54
    v_mfma_f32_16x16x32_bf16 v[40:43], v[160:163], v[20:23], v[68:71]
    v_cvt_pk_bf16_f32 v146, v52, v53
    v_exp_f32 v55, v55
    v_exp_f32 v56, v56
    v_smfmac_f32_16x16x64_bf16 v[128:131], v[184:187], v[136:143], v14
    v_mfma_f32_16x16x32_bf16 v[96:99], v[168:171], v[136:139], v[96:99]
    v_cvt_pk_bf16_f32 v147, v54, v55
    v_exp_f32 v57, v57
    v_exp_f32 v58, v58
    v_mfma_f32_16x16x32_bf16 v[100:103], v[172:175], v[136:139], v[100:103]
    v_cvt_pk_bf16_f32 v148, v56, v57
    v_exp_f32 v59, v59
    v_exp_f32 v60, v60
    v_mfma_f32_16x16x32_bf16 v[108:111], v[172:175], v[140:143], v[108:111]
    ds_read_b32 v11, v13
    v_cvt_pk_bf16_f32 v149, v58, v59
    v_exp_f32 v61, v61
    v_exp_f32 v62, v62
    v_mfma_f32_16x16x32_bf16 v[104:107], v[168:171], v[140:143], v[104:107]
    v_exp_f32 v63, v63
    v_cvt_pk_bf16_f32 v150, v60, v61
    v_cvt_pk_bf16_f32 v151, v62, v63
    v_mfma_f32_16x16x32_bf16 v[48:51], v[160:163], v[24:27], v[80:83]
    s_waitcnt lgkmcnt(0)
    v_cmp_ge_u32 vcc, s37, v11
    s_cbranch_vccnz L_att_slow9
L_att_ret9:
    s_add_u32 s37, s37, 1
    ds_read_b128 v[152:155], v3 offset:0
    ds_read_b128 v[156:159], v3 offset:1024
    v_exp_f32 v32, v32
    v_exp_f32 v33, v33
    v_exp_f32 v34, v34
    v_mfma_f32_16x16x32_bf16 v[52:55], v[164:167], v[24:27], v[80:83]
    v_cvt_pk_bf16_f32 v136, v32, v33
    v_exp_f32 v35, v35
    v_exp_f32 v36, v36
    v_mfma_f32_16x16x32_bf16 v[60:63], v[164:167], v[28:31], v[84:87]
    v_cvt_pk_bf16_f32 v137, v34, v35
    v_exp_f32 v37, v37
    v_exp_f32 v38, v38
    v_mfma_f32_16x16x32_bf16 v[56:59], v[160:163], v[28:31], v[84:87]
    v_cvt_pk_bf16_f32 v138, v36, v37
    v_exp_f32 v39, v39
    v_exp_f32 v40, v40
    v_smfmac_f32_16x16x64_bf16 v[132:135], v[184:187], v[144:151], v14
    v_mfma_f32_16x16x32_bf16 v[112:115], v[168:171], v[144:147], v[112:115]
    v_cvt_pk_bf16_f32 v139, v38, v39
    v_exp_f32 v41, v41
    v_exp_f32 v42, v42
    v_mfma_f32_16x16x32_bf16 v[116:119], v[172:175], v[144:147], v[116:119]
    v_cvt_pk_bf16_f32 v140, v40, v41
    v_exp_f32 v43, v43
    v_exp_f32 v44, v44
    v_mfma_f32_16x16x32_bf16 v[124:127], v[172:175], v[148:151], v[124:127]
    v_cvt_pk_bf16_f32 v141, v42, v43
    v_exp_f32 v45, v45
    v_exp_f32 v46, v46
    v_mfma_f32_16x16x32_bf16 v[120:123], v[168:171], v[148:151], v[120:123]
    v_exp_f32 v47, v47
    v_cvt_pk_bf16_f32 v142, v44, v45
    v_cvt_pk_bf16_f32 v143, v46, v47
    s_waitcnt lgkmcnt(1)
    v_mfma_f32_16x16x32_bf16 v[32:35], v[152:155], v[16:19], v[64:67]
    ds_read_b128 v[168:171], v3 offset:2048
    ds_read_b128 v[172:175], v3 offset:3072
    v_exp_f32 v48, v48
    v_exp_f32 v49, v49
    v_exp_f32 v50, v50
    s_waitcnt lgkmcnt(2)
    v_mfma_f32_16x16x32_bf16 v[36:39], v[156:159], v[16:19], v[64:67]
    v_cvt_pk_bf16_f32 v144, v48, v49
    v_exp_f32 v51, v51
    v_exp_f32 v52, v52
    v_mfma_f32_16x16x32_bf16 v[44:47], v[156:159], v[20:23], v[68:71]
    v_cvt_pk_bf16_f32 v145, v50, v51
    v_exp_f32 v53, v53
    v_exp_f32 v54, v54
    v_mfma_f32_16x16x32_bf16 v[40:43], v[152:155], v[20:23], v[68:71]
    v_cvt_pk_bf16_f32 v146, v52, v53
    v_exp_f32 v55, v55
    v_exp_f32 v56, v56
    v_smfmac_f32_16x16x64_bf16 v[128:131], v[184:187], v[136:143], v14
    v_mfma_f32_16x16x32_bf16 v[96:99], v[176:179], v[136:139], v[96:99]
    v_cvt_pk_bf16_f32 v147, v54, v55
    v_exp_f32 v57, v57
    v_exp_f32 v58, v58
    v_mfma_f32_16x16x32_bf16 v[100:103], v[180:183], v[136:139], v[100:103]
    v_cvt_pk_bf16_f32 v148, v56, v57
    v_exp_f32 v59, v59
    v_exp_f32 v60, v60
    v_mfma_f32_16x16x32_bf16 v[108:111], v[180:183], v[140:143], v[108:111]
    v_cvt_pk_bf16_f32 v149, v58, v59
    v_exp_f32 v61, v61
    v_exp_f32 v62, v62
    v_mfma_f32_16x16x32_bf16 v[104:107], v[176:179], v[140:143], v[104:107]
    v_exp_f32 v63, v63
    v_cvt_pk_bf16_f32 v150, v60, v61
    v_cvt_pk_bf16_f32 v151, v62, v63
    v_mfma_f32_16x16x32_bf16 v[48:51], v[152:155], v[24:27], v[80:83]
    ds_read_b128 v[160:163], v3 offset:4096
    ds_read_b128 v[164:167], v3 offset:5120
    v_exp_f32 v32, v32
    v_exp_f32 v33, v33
    v_exp_f32 v34, v34
    v_mfma_f32_16x16x32_bf16 v[52:55], v[156:159], v[24:27], v[80:83]
    v_add_u32 v10, 1, v10
    s_waitcnt vmcnt(0)
    ds_write_b32 v12, v10
    v_cvt_pk_bf16_f32 v136, v32, v33
    v_exp_f32 v35, v35
    v_exp_f32 v36, v36
    v_mfma_f32_16x16x32_bf16 v[60:63], v[156:159], v[28:31], v[84:87]
    v_cvt_pk_bf16_f32 v137, v34, v35
    v_exp_f32 v37, v37
    v_exp_f32 v38, v38
    v_mfma_f32_16x16x32_bf16 v[56:59], v[152:155], v[28:31], v[84:87]
    v_cvt_pk_bf16_f32 v138, v36, v37
    v_exp_f32 v39, v39
    v_exp_f32 v40, v40
    v_smfmac_f32_16x16x64_bf16 v[132:135], v[184:187], v[144:151], v14
    v_mfma_f32_16x16x32_bf16 v[112:115], v[176:179], v[144:147], v[112:115]
    v_cvt_pk_bf16_f32 v139, v38, v39
    v_exp_f32 v41, v41
    v_exp_f32 v42, v42
    v_mfma_f32_16x16x32_bf16 v[116:119], v[180:183], v[144:147], v[116:119]
    v_cvt_pk_bf16_f32 v140, v40, v41
    v_exp_f32 v43, v43
    v_exp_f32 v44, v44
    v_mfma_f32_16x16x32_bf16 v[124:127], v[180:183], v[148:151], v[124:127]
    v_cvt_pk_bf16_f32 v141, v42, v43
    v_exp_f32 v45, v45
    v_exp_f32 v46, v46
    v_mfma_f32_16x16x32_bf16 v[120:123], v[176:179], v[148:151], v[120:123]
    v_exp_f32 v47, v47
    v_cvt_pk_bf16_f32 v142, v44, v45
    v_cvt_pk_bf16_f32 v143, v46, v47
    s_waitcnt lgkmcnt(2)
    v_mfma_f32_16x16x32_bf16 v[32:35], v[160:163], v[16:19], v[64:67]
    ds_read_b128 v[176:179], v3 offset:6144
    ds_read_b128 v[180:183], v3 offset:7168
    v_exp_f32 v48, v48
    v_exp_f32 v49, v49
    v_exp_f32 v50, v50
    s_waitcnt lgkmcnt(3)
    v_mfma_f32_16x16x32_bf16 v[36:39], v[164:167], v[16:19], v[64:67]
    v_cvt_pk_bf16_f32 v144, v48, v49
    v_exp_f32 v51, v51
    v_exp_f32 v52, v52
    v_mfma_f32_16x16x32_bf16 v[44:47], v[164:167], v[20:23], v[68:71]
    v_cvt_pk_bf16_f32 v145, v50, v51
    v_exp_f32 v53, v53
    v_exp_f32 v54, v54
    v_mfma_f32_16x16x32_bf16 v[40:43], v[160:163], v[20:23], v[68:71]
    v_cvt_pk_bf16_f32 v146, v52, v53
    v_exp_f32 v55, v55
    v_exp_f32 v56, v56
    v_smfmac_f32_16x16x64_bf16 v[128:131], v[184:187], v[136:143], v14
    v_mfma_f32_16x16x32_bf16 v[96:99], v[168:171], v[136:139], v[96:99]
    v_cvt_pk_bf16_f32 v147, v54, v55
    v_exp_f32 v57, v57
    v_exp_f32 v58, v58
    v_mfma_f32_16x16x32_bf16 v[100:103], v[172:175], v[136:139], v[100:103]
    v_cvt_pk_bf16_f32 v148, v56, v57
    v_exp_f32 v59, v59
    v_exp_f32 v60, v60
    v_mfma_f32_16x16x32_bf16 v[108:111], v[172:175], v[140:143], v[108:111]
    ds_read_b32 v11, v13
    v_cvt_pk_bf16_f32 v149, v58, v59
    v_exp_f32 v61, v61
    v_exp_f32 v62, v62
    v_mfma_f32_16x16x32_bf16 v[104:107], v[168:171], v[140:143], v[104:107]
    v_exp_f32 v63, v63
    v_cvt_pk_bf16_f32 v150, v60, v61
    v_cvt_pk_bf16_f32 v151, v62, v63
    v_mfma_f32_16x16x32_bf16 v[48:51], v[160:163], v[24:27], v[80:83]
    s_waitcnt lgkmcnt(0)
    v_cmp_ge_u32 vcc, s37, v11
    s_cbranch_vccnz L_att_slow10
L_att_ret10:
    s_add_u32 s37, s37, 1
    ds_read_b128 v[152:155], v3 offset:8192
    ds_read_b128 v[156:159], v3 offset:9216
    v_exp_f32 v32, v32
    v_exp_f32 v33, v33
    v_exp_f32 v34, v34
    v_mfma_f32_16x16x32_bf16 v[52:55], v[164:167], v[24:27], v[80:83]
    v_cvt_pk_bf16_f32 v136, v32, v33
    v_exp_f32 v35, v35
    v_exp_f32 v36, v36
    v_mfma_f32_16x16x32_bf16 v[60:63], v[164:167], v[28:31], v[84:87]
    v_cvt_pk_bf16_f32 v137, v34, v35
    v_exp_f32 v37, v37
    v_exp_f32 v38, v38
    v_mfma_f32_16x16x32_bf16 v[56:59], v[160:163], v[28:31], v[84:87]
    v_cvt_pk_bf16_f32 v138, v36, v37
    v_exp_f32 v39, v39
    v_exp_f32 v40, v40
    v_smfmac_f32_16x16x64_bf16 v[132:135], v[184:187], v[144:151], v14
    v_mfma_f32_16x16x32_bf16 v[112:115], v[168:171], v[144:147], v[112:115]
    v_cvt_pk_bf16_f32 v139, v38, v39
    v_exp_f32 v41, v41
    v_exp_f32 v42, v42
    v_mfma_f32_16x16x32_bf16 v[116:119], v[172:175], v[144:147], v[116:119]
    v_cvt_pk_bf16_f32 v140, v40, v41
    v_exp_f32 v43, v43
    v_exp_f32 v44, v44
    v_mfma_f32_16x16x32_bf16 v[124:127], v[172:175], v[148:151], v[124:127]
    v_cvt_pk_bf16_f32 v141, v42, v43
    v_exp_f32 v45, v45
    v_exp_f32 v46, v46
    v_mfma_f32_16x16x32_bf16 v[120:123], v[168:171], v[148:151], v[120:123]
    v_exp_f32 v47, v47
    v_cvt_pk_bf16_f32 v142, v44, v45
    v_cvt_pk_bf16_f32 v143, v46, v47
    s_waitcnt lgkmcnt(1)
    v_mfma_f32_16x16x32_bf16 v[32:35], v[152:155], v[16:19], v[64:67]
    ds_read_b128 v[168:171], v3 offset:10240
    ds_read_b128 v[172:175], v3 offset:11264
    v_exp_f32 v48, v48
    v_exp_f32 v49, v49
    v_exp_f32 v50, v50
    s_waitcnt lgkmcnt(2)
    v_mfma_f32_16x16x32_bf16 v[36:39], v[156:159], v[16:19], v[64:67]
    v_cvt_pk_bf16_f32 v144, v48, v49
    v_exp_f32 v51, v51
    v_exp_f32 v52, v52
    v_mfma_f32_16x16x32_bf16 v[44:47], v[156:159], v[20:23], v[68:71]
    v_cvt_pk_bf16_f32 v145, v50, v51
    v_exp_f32 v53, v53
    v_exp_f32 v54, v54
    v_mfma_f32_16x16x32_bf16 v[40:43], v[152:155], v[20:23], v[68:71]
    v_cvt_pk_bf16_f32 v146, v52, v53
    v_exp_f32 v55, v55
    v_exp_f32 v56, v56
    v_smfmac_f32_16x16x64_bf16 v[128:131], v[184:187], v[136:143], v14
    v_mfma_f32_16x16x32_bf16 v[96:99], v[176:179], v[136:139], v[96:99]
    v_cvt_pk_bf16_f32 v147, v54, v55
    v_exp_f32 v57, v57
    v_exp_f32 v58, v58
    v_mfma_f32_16x16x32_bf16 v[100:103], v[180:183], v[136:139], v[100:103]
    v_cvt_pk_bf16_f32 v148, v56, v57
    v_exp_f32 v59, v59
    v_exp_f32 v60, v60
    v_mfma_f32_16x16x32_bf16 v[108:111], v[180:183], v[140:143], v[108:111]
    v_cvt_pk_bf16_f32 v149, v58, v59
    v_exp_f32 v61, v61
    v_exp_f32 v62, v62
    v_mfma_f32_16x16x32_bf16 v[104:107], v[176:179], v[140:143], v[104:107]
    v_exp_f32 v63, v63
    v_cvt_pk_bf16_f32 v150, v60, v61
    v_cvt_pk_bf16_f32 v151, v62, v63
    v_mfma_f32_16x16x32_bf16 v[48:51], v[152:155], v[24:27], v[80:83]
    ds_read_b128 v[160:163], v3 offset:12288
    ds_read_b128 v[164:167], v3 offset:13312
    v_exp_f32 v32, v32
    v_exp_f32 v33, v33
    v_exp_f32 v34, v34
    v_mfma_f32_16x16x32_bf16 v[52:55], v[156:159], v[24:27], v[80:83]
    v_cvt_pk_bf16_f32 v136, v32, v33
    v_exp_f32 v35, v35
    v_exp_f32 v36, v36
    v_mfma_f32_16x16x32_bf16 v[60:63], v[156:159], v[28:31], v[84:87]
    v_cvt_pk_bf16_f32 v137, v34, v35
    v_exp_f32 v37, v37
    v_exp_f32 v38, v38
    v_mfma_f32_16x16x32_bf16 v[56:59], v[152:155], v[28:31], v[84:87]
    v_cvt_pk_bf16_f32 v138, v36, v37
    v_exp_f32 v39, v39
    v_exp_f32 v40, v40
    v_smfmac_f32_16x16x64_bf16 v[132:135], v[184:187], v[144:151], v14
    v_mfma_f32_16x16x32_bf16 v[112:115], v[176:179], v[144:147], v[112:115]
    v_cvt_pk_bf16_f32 v139, v38, v39
    v_exp_f32 v41, v41
    v_exp_f32 v42, v42
    v_mfma_f32_16x16x32_bf16 v[116:119], v[180:183], v[144:147], v[116:119]
    v_cvt_pk_bf16_f32 v140, v40, v41
    v_exp_f32 v43, v43
    v_exp_f32 v44, v44
    v_mfma_f32_16x16x32_bf16 v[124:127], v[180:183], v[148:151], v[124:127]
    v_cvt_pk_bf16_f32 v141, v42, v43
    v_exp_f32 v45, v45
    v_exp_f32 v46, v46
    v_mfma_f32_16x16x32_bf16 v[120:123], v[176:179], v[148:151], v[120:123]
    v_exp_f32 v47, v47
    v_cvt_pk_bf16_f32 v142, v44, v45
    v_cvt_pk_bf16_f32 v143, v46, v47
    s_waitcnt lgkmcnt(1)
    v_mfma_f32_16x16x32_bf16 v[32:35], v[160:163], v[16:19], v[64:67]
    ds_read_b128 v[176:179], v3 offset:14336
    ds_read_b128 v[180:183], v3 offset:15360
    v_exp_f32 v48, v48
    v_exp_f32 v49, v49
    v_exp_f32 v50, v50
    s_waitcnt lgkmcnt(2)
    v_mfma_f32_16x16x32_bf16 v[36:39], v[164:167], v[16:19], v[64:67]
    v_cvt_pk_bf16_f32 v144, v48, v49
    v_exp_f32 v51, v51
    v_exp_f32 v52, v52
    v_mfma_f32_16x16x32_bf16 v[44:47], v[164:167], v[20:23], v[68:71]
    v_cvt_pk_bf16_f32 v145, v50, v51
    v_exp_f32 v53, v53
    v_exp_f32 v54, v54
    v_mfma_f32_16x16x32_bf16 v[40:43], v[160:163], v[20:23], v[68:71]
    v_cvt_pk_bf16_f32 v146, v52, v53
    v_exp_f32 v55, v55
    v_exp_f32 v56, v56
    v_smfmac_f32_16x16x64_bf16 v[128:131], v[184:187], v[136:143], v14
    v_mfma_f32_16x16x32_bf16 v[96:99], v[168:171], v[136:139], v[96:99]
    v_cvt_pk_bf16_f32 v147, v54, v55
    v_exp_f32 v57, v57
    v_exp_f32 v58, v58
    v_mfma_f32_16x16x32_bf16 v[100:103], v[172:175], v[136:139], v[100:103]
    v_cvt_pk_bf16_f32 v148, v56, v57
    v_exp_f32 v59, v59
    v_exp_f32 v60, v60
    v_mfma_f32_16x16x32_bf16 v[108:111], v[172:175], v[140:143], v[108:111]
    v_cvt_pk_bf16_f32 v149, v58, v59
    v_exp_f32 v61, v61
    v_exp_f32 v62, v62
    v_mfma_f32_16x16x32_bf16 v[104:107], v[168:171], v[140:143], v[104:107]
    v_exp_f32 v63, v63
    v_cvt_pk_bf16_f32 v150, v60, v61
    v_cvt_pk_bf16_f32 v151, v62, v63
    v_mfma_f32_16x16x32_bf16 v[48:51], v[160:163], v[24:27], v[80:83]
    v_exp_f32 v32, v32
    v_exp_f32 v33, v33
    v_exp_f32 v34, v34
    v_mfma_f32_16x16x32_bf16 v[52:55], v[164:167], v[24:27], v[80:83]
    v_cvt_pk_bf16_f32 v136, v32, v33
    v_exp_f32 v35, v35
    v_exp_f32 v36, v36
    v_mfma_f32_16x16x32_bf16 v[60:63], v[164:167], v[28:31], v[84:87]
    v_cvt_pk_bf16_f32 v137, v34, v35
    v_exp_f32 v37, v37
    v_exp_f32 v38, v38
    v_mfma_f32_16x16x32_bf16 v[56:59], v[160:163], v[28:31], v[84:87]
    v_cvt_pk_bf16_f32 v138, v36, v37
    v_exp_f32 v39, v39
    v_exp_f32 v40, v40
    v_smfmac_f32_16x16x64_bf16 v[132:135], v[184:187], v[144:151], v14
    v_mfma_f32_16x16x32_bf16 v[112:115], v[168:171], v[144:147], v[112:115]
    v_cvt_pk_bf16_f32 v139, v38, v39
    v_exp_f32 v41, v41
    v_exp_f32 v42, v42
    v_mfma_f32_16x16x32_bf16 v[116:119], v[172:175], v[144:147], v[116:119]
    v_cvt_pk_bf16_f32 v140, v40, v41
    v_exp_f32 v43, v43
    v_exp_f32 v44, v44
    v_mfma_f32_16x16x32_bf16 v[124:127], v[172:175], v[148:151], v[124:127]
    v_cvt_pk_bf16_f32 v141, v42, v43
    v_exp_f32 v45, v45
    v_exp_f32 v46, v46
    v_mfma_f32_16x16x32_bf16 v[120:123], v[168:171], v[148:151], v[120:123]
    v_exp_f32 v47, v47
    v_cvt_pk_bf16_f32 v142, v44, v45
    v_cvt_pk_bf16_f32 v143, v46, v47
    s_nop 1
    v_smfmac_f32_16x16x64_bf16 v[128:131], v[184:187], v[136:143], v14
    s_waitcnt lgkmcnt(1)
    v_mfma_f32_16x16x32_bf16 v[96:99], v[176:179], v[136:139], v[96:99]
    v_exp_f32 v48, v48
    v_exp_f32 v49, v49
    v_exp_f32 v50, v50
    v_cvt_pk_bf16_f32 v144, v48, v49
    v_exp_f32 v51, v51
    v_exp_f32 v52, v52
    s_waitcnt lgkmcnt(0)
    v_mfma_f32_16x16x32_bf16 v[100:103], v[180:183], v[136:139], v[100:103]
    v_cvt_pk_bf16_f32 v145, v50, v51
    v_exp_f32 v53, v53
    v_exp_f32 v54, v54
    v_cvt_pk_bf16_f32 v146, v52, v53
    v_exp_f32 v55, v55
    v_exp_f32 v56, v56
    v_mfma_f32_16x16x32_bf16 v[108:111], v[180:183], v[140:143], v[108:111]
    v_cvt_pk_bf16_f32 v147, v54, v55
    v_exp_f32 v57, v57
    v_exp_f32 v58, v58
    v_cvt_pk_bf16_f32 v148, v56, v57
    v_exp_f32 v59, v59
    v_exp_f32 v60, v60
    v_mfma_f32_16x16x32_bf16 v[104:107], v[176:179], v[140:143], v[104:107]
    v_cvt_pk_bf16_f32 v149, v58, v59
    v_exp_f32 v61, v61
    v_exp_f32 v62, v62
    v_exp_f32 v63, v63
    v_cvt_pk_bf16_f32 v150, v60, v61
    v_cvt_pk_bf16_f32 v151, v62, v63
    s_nop 1
    v_smfmac_f32_16x16x64_bf16 v[132:135], v[184:187], v[144:151], v14
    v_mfma_f32_16x16x32_bf16 v[112:115], v[176:179], v[144:147], v[112:115]
    v_mfma_f32_16x16x32_bf16 v[116:119], v[180:183], v[144:147], v[116:119]
    v_mfma_f32_16x16x32_bf16 v[124:127], v[180:183], v[148:151], v[124:127]
    v_mfma_f32_16x16x32_bf16 v[120:123], v[176:179], v[148:151], v[120:123]
    s_nop 7
    s_nop 7
    v_add_f32 v128, v128, v129
    v_add_f32 v130, v130, v131
    v_add_f32 v132, v132, v133
    v_add_f32 v134, v134, v135
    v_mov_b32 v8, 0x53800000
    v_add_f32 v9, v128, v130
    v_add_f32 v7, v132, v134
    v_add_f32 v9, v9, v7
    v_cmp_nle_f32 vcc, v9, v8
    s_cbranch_vccnz L_att_fb
L_att_fin:
    v_rcp_f32 v128, v128
    v_rcp_f32 v130, v130
    v_rcp_f32 v132, v132
    v_rcp_f32 v134, v134
    v_mul_f32 v96, v96, v128
    v_mul_f32 v97, v97, v128
    v_mul_f32 v98, v98, v128
    v_mul_f32 v99, v99, v128
    v_mul_f32 v100, v100, v128
    v_mul_f32 v101, v101, v128
    v_mul_f32 v102, v102, v128
    v_mul_f32 v103, v103, v128
    v_cvt_pk_bf16_f32 v136, v96, v97
    v_cvt_pk_bf16_f32 v137, v98, v99
    v_cvt_pk_bf16_f32 v138, v100, v101
    v_cvt_pk_bf16_f32 v139, v102, v103
    buffer_store_dwordx4 v[136:139], v2, s[4:7], s61 offen offset:0 sc1
    v_mul_f32 v104, v104, v130
    v_mul_f32 v105, v105, v130
    v_mul_f32 v106, v106, v130
    v_mul_f32 v107, v107, v130
    v_mul_f32 v108, v108, v130
    v_mul_f32 v109, v109, v130
    v_mul_f32 v110, v110, v130
    v_mul_f32 v111, v111, v130
    v_cvt_pk_bf16_f32 v140, v104, v105
    v_cvt_pk_bf16_f32 v141, v106, v107
    v_cvt_pk_bf16_f32 v142, v108, v109
    v_cvt_pk_bf16_f32 v143, v110, v111
    buffer_store_dwordx4 v[140:143], v2, s[4:7], s61 offen offset:1024 sc1
    v_mul_f32 v112, v112, v132
    v_mul_f32 v113, v113, v132
    v_mul_f32 v114, v114, v132
    v_mul_f32 v115, v115, v132
    v_mul_f32 v116, v116, v132
    v_mul_f32 v117, v117, v132
    v_mul_f32 v118, v118, v132
    v_mul_f32 v119, v119, v132
    v_cvt_pk_bf16_f32 v144, v112, v113
    v_cvt_pk_bf16_f32 v145, v114, v115
    v_cvt_pk_bf16_f32 v146, v116, v117
    v_cvt_pk_bf16_f32 v147, v118, v119
    buffer_store_dwordx4 v[144:147], v2, s[4:7], s61 offen offset:2048 sc1
    v_mul_f32 v120, v120, v134
    v_mul_f32 v121, v121, v134
    v_mul_f32 v122, v122, v134
    v_mul_f32 v123, v123, v134
    v_mul_f32 v124, v124, v134
    v_mul_f32 v125, v125, v134
    v_mul_f32 v126, v126, v134
    v_mul_f32 v127, v127, v134
    v_cvt_pk_bf16_f32 v148, v120, v121
    v_cvt_pk_bf16_f32 v149, v122, v123
    v_cvt_pk_bf16_f32 v150, v124, v125
    v_cvt_pk_bf16_f32 v151, v126, v127
    buffer_store_dwordx4 v[148:151], v2, s[4:7], s61 offen offset:3072 sc1
    v_mov_b32 v8, 1
    v_mov_b32 v64, 1
    v_mov_b32 v65, 1
    v_mov_b32 v66, 1
    v_mov_b32 v67, 1
    v_lshlrev_b32 v7, 7, v1
    v_lshlrev_b32 v9, 7, v1
    s_mov_b64 exec, 0xff
    s_waitcnt vmcnt(0)
    buffer_store_dwordx4 v[64:67], v2, s[4:7], s63 offen sc1
    v_mov_b32 v10, 64
    s_waitcnt vmcnt(0) lgkmcnt(0)
    ds_write_b32 v12, v10
    s_waitcnt lgkmcnt(0)
    s_cmp_ge_u32 s28, 2
    s_cbranch_scc1 L_att_end
    s_mov_b32 exec_lo, -1
    s_mov_b32 exec_hi, 0
    s_mov_b32 s29, 0x40000
L_poll:
    buffer_load_dword v32, v9, s[4:7], s66 offen sc1
    s_waitcnt vmcnt(0)
    v_cmp_ne_u32 vcc, 1, v32
    s_cbranch_vccz L_ready
    s_sleep 1
    s_sub_u32 s29, s29, 1
    s_cmp_lg_u32 s29, 0
    s_cbranch_scc1 L_poll
L_ready:
    ds_write_b32 v12, v8 offset:16
L_att_end:
    s_endpgm
L_att_slow0:
    ds_read_b32 v11, v13
    s_waitcnt lgkmcnt(0)
    v_cmp_ge_u32 vcc, s37, v11
    s_cbranch_vccnz L_att_slow0
    s_branch L_att_ret0
L_att_slow1:
    ds_read_b32 v11, v13
    s_waitcnt lgkmcnt(0)
    v_cmp_ge_u32 vcc, s37, v11
    s_cbranch_vccnz L_att_slow1
    s_branch L_att_ret1
L_att_slow2:
    ds_read_b32 v11, v13
    s_waitcnt lgkmcnt(0)
    v_cmp_ge_u32 vcc, s37, v11
    s_cbranch_vccnz L_att_slow2
    s_branch L_att_ret2
L_att_slow3:
    ds_read_b32 v11, v13
    s_waitcnt lgkmcnt(0)
    v_cmp_ge_u32 vcc, s37, v11
    s_cbranch_vccnz L_att_slow3
    s_branch L_att_ret3
L_att_slow4:
    ds_read_b32 v11, v13
    s_waitcnt lgkmcnt(0)
    v_cmp_ge_u32 vcc, s37, v11
    s_cbranch_vccnz L_att_slow4
    s_branch L_att_ret4
L_att_slow5:
    ds_read_b32 v11, v13
    s_waitcnt lgkmcnt(0)
    v_cmp_ge_u32 vcc, s37, v11
    s_cbranch_vccnz L_att_slow5
    s_branch L_att_ret5
L_att_slow6:
    ds_read_b32 v11, v13
    s_waitcnt lgkmcnt(0)
    v_cmp_ge_u32 vcc, s37, v11
    s_cbranch_vccnz L_att_slow6
    s_branch L_att_ret6
L_att_slow7:
    ds_read_b32 v11, v13
    s_waitcnt lgkmcnt(0)
    v_cmp_ge_u32 vcc, s37, v11
    s_cbranch_vccnz L_att_slow7
    s_branch L_att_ret7
L_att_slow8:
    ds_read_b32 v11, v13
    s_waitcnt lgkmcnt(0)
    v_cmp_ge_u32 vcc, s37, v11
    s_cbranch_vccnz L_att_slow8
    s_branch L_att_ret8
L_att_slow9:
    ds_read_b32 v11, v13
    s_waitcnt lgkmcnt(0)
    v_cmp_ge_u32 vcc, s37, v11
    s_cbranch_vccnz L_att_slow9
    s_branch L_att_ret9
L_att_slow10:
    ds_read_b32 v11, v13
    s_waitcnt lgkmcnt(0)
    v_cmp_ge_u32 vcc, s37, v11
    s_cbranch_vccnz L_att_slow10
    s_branch L_att_ret10
L_att_fb:
    v_mov_b32 v96, 0
    v_mov_b32 v97, 0
    v_mov_b32 v98, 0
    v_mov_b32 v99, 0
    v_mov_b32 v100, 0
    v_mov_b32 v101, 0
    v_mov_b32 v102, 0
    v_mov_b32 v103, 0
    v_mov_b32 v104, 0
    v_mov_b32 v105, 0
    v_mov_b32 v106, 0
    v_mov_b32 v107, 0
    v_mov_b32 v108, 0
    v_mov_b32 v109, 0
    v_mov_b32 v110, 0
    v_mov_b32 v111, 0
    v_mov_b32 v112, 0
    v_mov_b32 v113, 0
    v_mov_b32 v114, 0
    v_mov_b32 v115, 0
    v_mov_b32 v116, 0
    v_mov_b32 v117, 0
    v_mov_b32 v118, 0
    v_mov_b32 v119, 0
    v_mov_b32 v120, 0
    v_mov_b32 v121, 0
    v_mov_b32 v122, 0
    v_mov_b32 v123, 0
    v_mov_b32 v124, 0
    v_mov_b32 v125, 0
    v_mov_b32 v126, 0
    v_mov_b32 v127, 0
    v_mov_b32 v64, 0xff61b1e6
    v_mov_b32 v68, 0
    v_mov_b32 v65, 0xff61b1e6
    v_mov_b32 v69, 0
    v_mov_b32 v66, 0xff61b1e6
    v_mov_b32 v70, 0
    v_mov_b32 v67, 0xff61b1e6
    v_mov_b32 v71, 0
    s_mov_b32 s29, 64
L_att_fbloop:
    buffer_load_dwordx4 v[152:155], v2, s[4:7], s36 offen offset:0
    buffer_load_dwordx4 v[156:159], v2, s[4:7], s36 offen offset:1024
    buffer_load_dwordx4 v[168:171], v2, s[4:7], s36 offen offset:2048
    buffer_load_dwordx4 v[172:175], v2, s[4:7], s36 offen offset:3072
    s_add_u32 s36, s36, 4096
    s_waitcnt vmcnt(0)
    v_mfma_f32_16x16x32_bf16 v[32:35], v[152:155], v[16:19], 0
    v_mfma_f32_16x16x32_bf16 v[36:39], v[156:159], v[16:19], 0
    v_mfma_f32_16x16x32_bf16 v[40:43], v[152:155], v[20:23], 0
    v_mfma_f32_16x16x32_bf16 v[44:47], v[156:159], v[20:23], 0
    v_mfma_f32_16x16x32_bf16 v[48:51], v[152:155], v[24:27], 0
    v_mfma_f32_16x16x32_bf16 v[52:55], v[156:159], v[24:27], 0
    v_mfma_f32_16x16x32_bf16 v[56:59], v[152:155], v[28:31], 0
    v_mfma_f32_16x16x32_bf16 v[60:63], v[156:159], v[28:31], 0
    s_nop 7
    v_max3_f32 v72, v32, v33, v64
    v_max3_f32 v72, v72, v34, v35
    v_max3_f32 v72, v72, v36, v37
    v_max3_f32 v72, v72, v38, v39
    v_max3_f32 v73, v40, v41, v65
    v_max3_f32 v73, v73, v42, v43
    v_max3_f32 v73, v73, v44, v45
    v_max3_f32 v73, v73, v46, v47
    v_max3_f32 v74, v48, v49, v66
    v_max3_f32 v74, v74, v50, v51
    v_max3_f32 v74, v74, v52, v53
    v_max3_f32 v74, v74, v54, v55
    v_max3_f32 v75, v56, v57, v67
    v_max3_f32 v75, v75, v58, v59
    v_max3_f32 v75, v75, v60, v61
    v_max3_f32 v75, v75, v62, v63
    v_mov_b32 v76, v72
    v_mov_b32 v77, v73
    v_mov_b32 v78, v74
    v_mov_b32 v79, v75
    v_permlane32_swap_b32 v72, v76
    v_permlane32_swap_b32 v73, v77
    v_permlane32_swap_b32 v74, v78
    v_permlane32_swap_b32 v75, v79
    v_max_f32 v72, v72, v76
    v_max_f32 v73, v73, v77
    v_max_f32 v74, v74, v78
    v_max_f32 v75, v75, v79
    v_mov_b32 v76, v72
    v_mov_b32 v77, v73
    v_mov_b32 v78, v74
    v_mov_b32 v79, v75
    v_permlane16_swap_b32 v72, v76
    v_permlane16_swap_b32 v73, v77
    v_permlane16_swap_b32 v74, v78
    v_permlane16_swap_b32 v75, v79
    v_max_f32 v72, v72, v76
    v_max_f32 v73, v73, v77
    v_max_f32 v74, v74, v78
    v_max_f32 v75, v75, v79
    v_sub_f32 v76, v64, v72
    v_sub_f32 v77, v65, v73
    v_sub_f32 v78, v66, v74
    v_sub_f32 v79, v67, v75
    v_exp_f32 v76, v76
    v_exp_f32 v77, v77
    v_exp_f32 v78, v78
    v_exp_f32 v79, v79
    v_mov_b32 v64, v72
    v_mov_b32 v65, v73
    v_mov_b32 v66, v74
    v_mov_b32 v67, v75
    v_sub_f32 v32, v32, v72
    v_sub_f32 v33, v33, v72
    v_sub_f32 v34, v34, v72
    v_sub_f32 v35, v35, v72
    v_sub_f32 v36, v36, v72
    v_sub_f32 v37, v37, v72
    v_sub_f32 v38, v38, v72
    v_sub_f32 v39, v39, v72
    v_exp_f32 v32, v32
    v_exp_f32 v33, v33
    v_exp_f32 v34, v34
    v_exp_f32 v35, v35
    v_exp_f32 v36, v36
    v_exp_f32 v37, v37
    v_exp_f32 v38, v38
    v_exp_f32 v39, v39
    v_mul_f32 v68, v68, v76
    v_mul_f32 v96, v96, v76
    v_mul_f32 v97, v97, v76
    v_mul_f32 v98, v98, v76
    v_mul_f32 v99, v99, v76
    v_mul_f32 v100, v100, v76
    v_mul_f32 v101, v101, v76
    v_mul_f32 v102, v102, v76
    v_mul_f32 v103, v103, v76
    v_add_f32 v68, v68, v32
    v_add_f32 v68, v68, v33
    v_add_f32 v68, v68, v34
    v_add_f32 v68, v68, v35
    v_add_f32 v68, v68, v36
    v_add_f32 v68, v68, v37
    v_add_f32 v68, v68, v38
    v_add_f32 v68, v68, v39
    v_cvt_pk_bf16_f32 v136, v32, v33
    v_cvt_pk_bf16_f32 v137, v34, v35
    v_cvt_pk_bf16_f32 v138, v36, v37
    v_cvt_pk_bf16_f32 v139, v38, v39
    s_nop 1
    v_mfma_f32_16x16x32_bf16 v[96:99], v[168:171], v[136:139], v[96:99]
    v_mfma_f32_16x16x32_bf16 v[100:103], v[172:175], v[136:139], v[100:103]
    v_sub_f32 v40, v40, v73
    v_sub_f32 v41, v41, v73
    v_sub_f32 v42, v42, v73
    v_sub_f32 v43, v43, v73
    v_sub_f32 v44, v44, v73
    v_sub_f32 v45, v45, v73
    v_sub_f32 v46, v46, v73
    v_sub_f32 v47, v47, v73
    v_exp_f32 v40, v40
    v_exp_f32 v41, v41
    v_exp_f32 v42, v42
    v_exp_f32 v43, v43
    v_exp_f32 v44, v44
    v_exp_f32 v45, v45
    v_exp_f32 v46, v46
    v_exp_f32 v47, v47
    v_mul_f32 v69, v69, v77
    v_mul_f32 v104, v104, v77
    v_mul_f32 v105, v105, v77
    v_mul_f32 v106, v106, v77
    v_mul_f32 v107, v107, v77
    v_mul_f32 v108, v108, v77
    v_mul_f32 v109, v109, v77
    v_mul_f32 v110, v110, v77
    v_mul_f32 v111, v111, v77
    v_add_f32 v69, v69, v40
    v_add_f32 v69, v69, v41
    v_add_f32 v69, v69, v42
    v_add_f32 v69, v69, v43
    v_add_f32 v69, v69, v44
    v_add_f32 v69, v69, v45
    v_add_f32 v69, v69, v46
    v_add_f32 v69, v69, v47
    v_cvt_pk_bf16_f32 v140, v40, v41
    v_cvt_pk_bf16_f32 v141, v42, v43
    v_cvt_pk_bf16_f32 v142, v44, v45
    v_cvt_pk_bf16_f32 v143, v46, v47
    s_nop 1
    v_mfma_f32_16x16x32_bf16 v[104:107], v[168:171], v[140:143], v[104:107]
    v_mfma_f32_16x16x32_bf16 v[108:111], v[172:175], v[140:143], v[108:111]
    v_sub_f32 v48, v48, v74
    v_sub_f32 v49, v49, v74
    v_sub_f32 v50, v50, v74
    v_sub_f32 v51, v51, v74
    v_sub_f32 v52, v52, v74
    v_sub_f32 v53, v53, v74
    v_sub_f32 v54, v54, v74
    v_sub_f32 v55, v55, v74
    v_exp_f32 v48, v48
    v_exp_f32 v49, v49
    v_exp_f32 v50, v50
    v_exp_f32 v51, v51
    v_exp_f32 v52, v52
    v_exp_f32 v53, v53
    v_exp_f32 v54, v54
    v_exp_f32 v55, v55
    v_mul_f32 v70, v70, v78
    v_mul_f32 v112, v112, v78
    v_mul_f32 v113, v113, v78
    v_mul_f32 v114, v114, v78
    v_mul_f32 v115, v115, v78
    v_mul_f32 v116, v116, v78
    v_mul_f32 v117, v117, v78
    v_mul_f32 v118, v118, v78
    v_mul_f32 v119, v119, v78
    v_add_f32 v70, v70, v48
    v_add_f32 v70, v70, v49
    v_add_f32 v70, v70, v50
    v_add_f32 v70, v70, v51
    v_add_f32 v70, v70, v52
    v_add_f32 v70, v70, v53
    v_add_f32 v70, v70, v54
    v_add_f32 v70, v70, v55
    v_cvt_pk_bf16_f32 v144, v48, v49
    v_cvt_pk_bf16_f32 v145, v50, v51
    v_cvt_pk_bf16_f32 v146, v52, v53
    v_cvt_pk_bf16_f32 v147, v54, v55
    s_nop 1
    v_mfma_f32_16x16x32_bf16 v[112:115], v[168:171], v[144:147], v[112:115]
    v_mfma_f32_16x16x32_bf16 v[116:119], v[172:175], v[144:147], v[116:119]
    v_sub_f32 v56, v56, v75
    v_sub_f32 v57, v57, v75
    v_sub_f32 v58, v58, v75
    v_sub_f32 v59, v59, v75
    v_sub_f32 v60, v60, v75
    v_sub_f32 v61, v61, v75
    v_sub_f32 v62, v62, v75
    v_sub_f32 v63, v63, v75
    v_exp_f32 v56, v56
    v_exp_f32 v57, v57
    v_exp_f32 v58, v58
    v_exp_f32 v59, v59
    v_exp_f32 v60, v60
    v_exp_f32 v61, v61
    v_exp_f32 v62, v62
    v_exp_f32 v63, v63
    v_mul_f32 v71, v71, v79
    v_mul_f32 v120, v120, v79
    v_mul_f32 v121, v121, v79
    v_mul_f32 v122, v122, v79
    v_mul_f32 v123, v123, v79
    v_mul_f32 v124, v124, v79
    v_mul_f32 v125, v125, v79
    v_mul_f32 v126, v126, v79
    v_mul_f32 v127, v127, v79
    v_add_f32 v71, v71, v56
    v_add_f32 v71, v71, v57
    v_add_f32 v71, v71, v58
    v_add_f32 v71, v71, v59
    v_add_f32 v71, v71, v60
    v_add_f32 v71, v71, v61
    v_add_f32 v71, v71, v62
    v_add_f32 v71, v71, v63
    v_cvt_pk_bf16_f32 v148, v56, v57
    v_cvt_pk_bf16_f32 v149, v58, v59
    v_cvt_pk_bf16_f32 v150, v60, v61
    v_cvt_pk_bf16_f32 v151, v62, v63
    s_nop 1
    v_mfma_f32_16x16x32_bf16 v[120:123], v[168:171], v[148:151], v[120:123]
    v_mfma_f32_16x16x32_bf16 v[124:127], v[172:175], v[148:151], v[124:127]
    s_nop 7
    s_nop 7
    s_sub_u32 s29, s29, 1
    s_cmp_lg_u32 s29, 0
    s_cbranch_scc1 L_att_fbloop
    v_mov_b32 v76, v68
    v_mov_b32 v77, v69
    v_mov_b32 v78, v70
    v_mov_b32 v79, v71
    v_permlane32_swap_b32 v68, v76
    v_permlane32_swap_b32 v69, v77
    v_permlane32_swap_b32 v70, v78
    v_permlane32_swap_b32 v71, v79
    v_add_f32 v68, v68, v76
    v_add_f32 v69, v69, v77
    v_add_f32 v70, v70, v78
    v_add_f32 v71, v71, v79
    v_mov_b32 v76, v68
    v_mov_b32 v77, v69
    v_mov_b32 v78, v70
    v_mov_b32 v79, v71
    v_permlane16_swap_b32 v68, v76
    v_permlane16_swap_b32 v69, v77
    v_permlane16_swap_b32 v70, v78
    v_permlane16_swap_b32 v71, v79
    v_add_f32 v68, v68, v76
    v_add_f32 v69, v69, v77
    v_add_f32 v70, v70, v78
    v_add_f32 v71, v71, v79
    v_mov_b32 v128, v68
    v_mov_b32 v130, v69
    v_mov_b32 v132, v70
    v_mov_b32 v134, v71
    s_nop 0
    s_branch L_att_fin
L_s3_down:
    s_bfe_u32 s57, s2, 0x20001
    s_lshl_b32 s57, s57, 2
    s_bfe_u32 s58, s2, 0x20003
    s_add_u32 s57, s57, s58
    s_and_b32 s58, s2, 1
    s_lshl_b32 s58, s58, 3
    s_lshr_b32 s59, s2, 5
    s_add_u32 s58, s58, s59
    v_lshlrev_b32 v2, 4, v1
    s_mul_i32 s36, s57, 1179648
    s_add_u32 s36, s36, 0x1000000
    s_lshl_b32 s34, s28, 11
    s_lshl_b32 s33, s28, 16
    s_lshl_b32 s60, s58, 7
    s_add_u32 s33, s33, s60
    s_mov_b32 s61, s33
    s_lshl_b32 s42, s28, 12
    s_add_u32 s42, s42, 40960
    s_add_u32 s43, s42, 114688
    s_mov_b32 s40, s42
    v_lshrrev_b32 v20, 3, v1
    v_and_b32 v21, 6, v20
    v_and_b32 v22, 7, v1
    v_xor_b32 v21, v21, v22
    v_lshlrev_b32 v21, 4, v21
    v_lshl_add_u32 v4, v20, 11, v21
    v_add_u32 v5, 15360, v4
    v_add_u32 v6, 30720, v4
    v_add_u32 v7, 46080, v4
    v_lshrrev_b32 v20, 2, v1
    v_and_b32 v21, 3, v1
    v_lshlrev_b32 v21, 3, v21
    v_lshl_add_u32 v21, v20, 7, v21
    v_add_u32 v21, 40960, v21
    v_bfe_u32 v20, v1, 3, 2
    v_xor_b32 v22, 0, v20
    v_lshl_add_u32 v8, v22, 5, v21
    v_xor_b32 v22, 1, v20
    v_lshl_add_u32 v9, v22, 5, v21
    v_xor_b32 v22, 2, v20
    v_lshl_add_u32 v10, v22, 5, v21
    v_xor_b32 v22, 3, v20
    v_lshl_add_u32 v11, v22, 5, v21
    v_and_b32 v3, 15, v1
    v_lshlrev_b32 v3, 11, v3
    v_bfe_u32 v20, v1, 4, 1
    v_lshl_add_u32 v3, v20, 5, v3
    v_lshrrev_b32 v20, 5, v1
    v_lshl_add_u32 v3, v20, 4, v3
    v_and_b32 v0, 3, v1
    v_lshlrev_b32 v0, 2, v0
    v_add_u32 v0, 155680, v0
    s_lshl_b32 s59, s28, 2
    s_add_u32 s59, s59, 155680
    v_mov_b32 v14, s59
    v_mov_b32 v13, 0
    s_lshr_b32 s59, s28, 1
    s_lshl_b32 s59, s59, 2
    s_add_u32 s59, s59, 155664
    v_mov_b32 v12, s59
    s_mov_b32 s37, 0
    s_mov_b32 s38, 0
    s_mov_b32 s46, 16384
    s_mov_b32 s47, -98304
    s_lshl_b32 s64, s57, 2
    s_add_u32 s64, s64, s28
    s_lshl_b32 s64, s64, 16
    s_add_u32 s64, s64, s60
    s_add_u32 s65, s64, 32768
    s_waitcnt lgkmcnt(0)
    s_mov_b32 s4, s50
    s_mov_b32 s5, s51
    s_mov_b32 s6, 0x3700000
    s_mov_b32 s7, 0x00020000
    s_mov_b32 s24, s50
    s_mov_b32 s25, s51
    s_mov_b32 s26, 0x120000
    s_mov_b32 s27, 0x00020000
    s_add_u32 s24, s24, s36
    s_addc_u32 s25, s25, 0
    s_mov_b32 s8, s48
    s_mov_b32 s9, s49
    s_mov_b32 s10, 0x700000
    s_mov_b32 s11, 0x00020000
    s_mov_b32 s16, s54
    s_mov_b32 s17, s55
    s_mov_b32 s18, 0x400000
    s_mov_b32 s19, 0x00020000
    s_mov_b32 s20, s44
    s_mov_b32 s21, s45
    s_mov_b32 s22, 0x400000
    s_mov_b32 s23, 0x00020000
    s_barrier
    s_mov_b32 m0, s40
    s_add_u32 s40, s40, 16384
    buffer_load_dwordx4 v4, s[8:11], s33 offen offset:0 lds
    buffer_load_dwordx4 v5, s[8:11], s33 offen offset:1024 lds
    s_cmp_eq_u32 s40, s43
    s_cselect_b32 s40, s42, s40
    buffer_load_dwordx4 v6, s[8:11], s33 offen offset:2048 lds
    buffer_load_dwordx4 v7, s[8:11], s33 offen offset:3072 lds
    s_add_u32 s33, s33, 262144
    buffer_load_dwordx4 v[240:243], v3, s[16:19], s64 offen offset:0
    buffer_load_dwordx4 v[244:247], v3, s[16:19], s64 offen offset:64
    buffer_load_dwordx4 v[248:251], v3, s[16:19], s65 offen offset:0
    buffer_load_dwordx4 v[252:255], v3, s[16:19], s65 offen offset:64
    buffer_load_dwordx4 v[80:83], v2, s[24:27], s34 offen offset:0
    buffer_load_dwordx4 v[84:87], v2, s[24:27], s34 offen offset:1024
    s_add_u32 s34, s34, 8192
    buffer_load_dwordx4 v[88:91], v2, s[24:27], s34 offen offset:0
    buffer_load_dwordx4 v[92:95], v2, s[24:27], s34 offen offset:1024
    s_add_u32 s34, s34, 8192
    buffer_load_dwordx4 v[96:99], v2, s[24:27], s34 offen offset:0
    buffer_load_dwordx4 v[100:103], v2, s[24:27], s34 offen offset:1024
    s_add_u32 s34, s34, 8192
    buffer_load_dwordx4 v[104:107], v2, s[24:27], s34 offen offset:0
    buffer_load_dwordx4 v[108:111], v2, s[24:27], s34 offen offset:1024
    s_add_u32 s34, s34, 8192
    s_mov_b32 m0, s40
    s_add_u32 s40, s40, 16384
    buffer_load_dwordx4 v4, s[8:11], s33 offen offset:0 lds
    buffer_load_dwordx4 v5, s[8:11], s33 offen offset:1024 lds
    s_cmp_eq_u32 s40, s43
    s_cselect_b32 s40, s42, s40
    buffer_load_dwordx4 v6, s[8:11], s33 offen offset:2048 lds
    buffer_load_dwordx4 v7, s[8:11], s33 offen offset:3072 lds
    s_add_u32 s33, s33, 262144
    buffer_load_dwordx4 v[112:115], v2, s[24:27], s34 offen offset:0
    buffer_load_dwordx4 v[116:119], v2, s[24:27], s34 offen offset:1024
    s_add_u32 s34, s34, 8192
    buffer_load_dwordx4 v[120:123], v2, s[24:27], s34 offen offset:0
    buffer_load_dwordx4 v[124:127], v2, s[24:27], s34 offen offset:1024
    s_add_u32 s34, s34, 8192
    buffer_load_dwordx4 v[128:131], v2, s[24:27], s34 offen offset:0
    buffer_load_dwordx4 v[132:135], v2, s[24:27], s34 offen offset:1024
    s_add_u32 s34, s34, 8192
    buffer_load_dwordx4 v[136:139], v2, s[24:27], s34 offen offset:0
    buffer_load_dwordx4 v[140:143], v2, s[24:27], s34 offen offset:1024
    s_add_u32 s34, s34, 8192
    s_mov_b32 m0, s40
    s_add_u32 s40, s40, 16384
    buffer_load_dwordx4 v4, s[8:11], s33 offen offset:0 lds
    buffer_load_dwordx4 v5, s[8:11], s33 offen offset:1024 lds
    s_cmp_eq_u32 s40, s43
    s_cselect_b32 s40, s42, s40
    buffer_load_dwordx4 v6, s[8:11], s33 offen offset:2048 lds
    buffer_load_dwordx4 v7, s[8:11], s33 offen offset:3072 lds
    s_add_u32 s33, s33, 262144
    buffer_load_dwordx4 v[144:147], v2, s[24:27], s34 offen offset:0
    buffer_load_dwordx4 v[148:151], v2, s[24:27], s34 offen offset:1024
    s_add_u32 s34, s34, 8192
    buffer_load_dwordx4 v[152:155], v2, s[24:27], s34 offen offset:0
    buffer_load_dwordx4 v[156:159], v2, s[24:27], s34 offen offset:1024
    s_add_u32 s34, s34, 8192
    buffer_load_dwordx4 v[160:163], v2, s[24:27], s34 offen offset:0
    buffer_load_dwordx4 v[164:167], v2, s[24:27], s34 offen offset:1024
    s_add_u32 s34, s34, 8192
    buffer_load_dwordx4 v[168:171], v2, s[24:27], s34 offen offset:0
    buffer_load_dwordx4 v[172:175], v2, s[24:27], s34 offen offset:1024
    s_add_u32 s34, s34, 8192
    s_waitcnt vmcnt(36)
    v_add_u32 v13, 1, v13
    ds_write_b32 v14, v13
L_gw0:
    ds_read_b32 v15, v0
    s_waitcnt lgkmcnt(0)
    v_cmp_ge_u32 vcc, s37, v15
    s_cbranch_vccnz L_gw0
    s_add_u32 s37, s37, 1
    ds_read_b64_tr_b16 v[48:49], v8 offset:0
    ds_read_b64_tr_b16 v[50:51], v8 offset:2048
    ds_read_b64_tr_b16 v[52:53], v9 offset:0
    ds_read_b64_tr_b16 v[54:55], v9 offset:2048
    ds_read_b64_tr_b16 v[56:57], v10 offset:0
    ds_read_b64_tr_b16 v[58:59], v10 offset:2048
    ds_read_b64_tr_b16 v[60:61], v11 offset:0
    ds_read_b64_tr_b16 v[62:63], v11 offset:2048
    ds_read_b64_tr_b16 v[64:65], v8 offset:4096
    ds_read_b64_tr_b16 v[66:67], v8 offset:6144
    ds_read_b64_tr_b16 v[68:69], v9 offset:4096
    ds_read_b64_tr_b16 v[70:71], v9 offset:6144
    ds_read_b64_tr_b16 v[72:73], v10 offset:4096
    ds_read_b64_tr_b16 v[74:75], v10 offset:6144
    ds_read_b64_tr_b16 v[76:77], v11 offset:4096
    s_waitcnt vmcnt(32)
    v_permlane16_swap_b32 v240, v242
    v_permlane16_swap_b32 v241, v243
    v_permlane16_swap_b32 v244, v246
    v_permlane16_swap_b32 v245, v247
    v_permlane16_swap_b32 v248, v250
    v_permlane16_swap_b32 v249, v251
    v_permlane16_swap_b32 v252, v254
    v_permlane16_swap_b32 v253, v255
    s_nop 1
    v_lshlrev_b32 v16, 16, v240
    v_and_b32 v17, 0xffff0000, v240
    v_lshlrev_b32 v18, 16, v241
    v_and_b32 v19, 0xffff0000, v241
    v_lshlrev_b32 v20, 16, v242
    v_and_b32 v21, 0xffff0000, v242
    v_lshlrev_b32 v22, 16, v243
    v_and_b32 v23, 0xffff0000, v243
    v_lshlrev_b32 v24, 16, v244
    v_and_b32 v25, 0xffff0000, v244
    v_lshlrev_b32 v26, 16, v245
    v_and_b32 v27, 0xffff0000, v245
    v_lshlrev_b32 v28, 16, v246
    v_and_b32 v29, 0xffff0000, v246
    v_lshlrev_b32 v30, 16, v247
    v_and_b32 v31, 0xffff0000, v247
    v_lshlrev_b32 v32, 16, v248
    v_and_b32 v33, 0xffff0000, v248
    v_lshlrev_b32 v34, 16, v249
    v_and_b32 v35, 0xffff0000, v249
    v_lshlrev_b32 v36, 16, v250
    v_and_b32 v37, 0xffff0000, v250
    v_lshlrev_b32 v38, 16, v251
    v_and_b32 v39, 0xffff0000, v251
    v_lshlrev_b32 v40, 16, v252
    v_and_b32 v41, 0xffff0000, v252
    v_lshlrev_b32 v42, 16, v253
    v_and_b32 v43, 0xffff0000, v253
    v_lshlrev_b32 v44, 16, v254
    v_and_b32 v45, 0xffff0000, v254
    v_lshlrev_b32 v46, 16, v255
    v_and_b32 v47, 0xffff0000, v255
    s_mov_b32 s29, 0
    s_sub_u32 s37, s37, 1
L_dn_loop:
    s_waitcnt vmcnt(30) lgkmcnt(13)
    v_mfma_f32_16x16x32_bf16 v[16:19], v[48:51], v[80:83], v[16:19]
    ds_read_b64_tr_b16 v[78:79], v11 offset:6144
    v_mfma_f32_16x16x32_bf16 v[32:35], v[48:51], v[84:87], v[32:35]
    ds_read_b64_tr_b16 v[48:49], v8 offset:8192
    s_mov_b32 m0, s40
    s_add_u32 s40, s40, 16384
    s_waitcnt lgkmcnt(13)
    v_mfma_f32_16x16x32_bf16 v[20:23], v[52:55], v[80:83], v[20:23]
    ds_read_b64_tr_b16 v[50:51], v8 offset:10240
    v_add_u32 v13, 1, v13
    s_add_u32 s37, s37, 1
    buffer_load_dwordx4 v4, s[8:11], s33 offen offset:0 lds
    v_mfma_f32_16x16x32_bf16 v[36:39], v[52:55], v[84:87], v[36:39]
    ds_read_b64_tr_b16 v[52:53], v9 offset:8192
    s_waitcnt vmcnt(21)
    ds_write_b32 v14, v13
    buffer_load_dwordx4 v5, s[8:11], s33 offen offset:1024 lds
    s_cmp_eq_u32 s40, s43
    s_cselect_b32 s40, s42, s40
    s_waitcnt lgkmcnt(14)
    v_mfma_f32_16x16x32_bf16 v[24:27], v[56:59], v[80:83], v[24:27]
    ds_read_b64_tr_b16 v[54:55], v9 offset:10240
    buffer_load_dwordx4 v6, s[8:11], s33 offen offset:2048 lds
    v_mfma_f32_16x16x32_bf16 v[40:43], v[56:59], v[84:87], v[40:43]
    ds_read_b64_tr_b16 v[56:57], v10 offset:8192
    buffer_load_dwordx4 v7, s[8:11], s33 offen offset:3072 lds
    s_add_u32 s33, s33, 262144
    s_waitcnt lgkmcnt(14)
    v_mfma_f32_16x16x32_bf16 v[28:31], v[60:63], v[80:83], v[28:31]
    ds_read_b64_tr_b16 v[58:59], v10 offset:10240
    s_add_u32 s38, s38, 1
    s_cmp_eq_u32 s38, 7
    s_cselect_b32 s39, s47, s46
    s_cselect_b32 s38, 0, s38
    buffer_load_dwordx4 v[176:179], v2, s[24:27], s34 offen offset:0
    v_mfma_f32_16x16x32_bf16 v[44:47], v[60:63], v[84:87], v[44:47]
    ds_read_b64_tr_b16 v[60:61], v11 offset:8192
    buffer_load_dwordx4 v[180:183], v2, s[24:27], s34 offen offset:1024
    s_add_u32 s34, s34, 8192
    s_waitcnt lgkmcnt(14)
    v_mfma_f32_16x16x32_bf16 v[16:19], v[64:67], v[88:91], v[16:19]
    ds_read_b64_tr_b16 v[62:63], v11 offset:10240
    v_mfma_f32_16x16x32_bf16 v[32:35], v[64:67], v[92:95], v[32:35]
    ds_read_b64_tr_b16 v[64:65], v8 offset:12288
    s_waitcnt lgkmcnt(14)
    v_mfma_f32_16x16x32_bf16 v[20:23], v[68:71], v[88:91], v[20:23]
    ds_read_b64_tr_b16 v[66:67], v8 offset:14336
    v_add_u32 v8, s39, v8
    v_mfma_f32_16x16x32_bf16 v[36:39], v[68:71], v[92:95], v[36:39]
    ds_read_b64_tr_b16 v[68:69], v9 offset:12288
    ds_read_b32 v15, v0
    s_waitcnt lgkmcnt(15)
    v_mfma_f32_16x16x32_bf16 v[24:27], v[72:75], v[88:91], v[24:27]
    ds_read_b64_tr_b16 v[70:71], v9 offset:14336
    v_add_u32 v9, s39, v9
    v_mfma_f32_16x16x32_bf16 v[40:43], v[72:75], v[92:95], v[40:43]
    ds_read_b64_tr_b16 v[72:73], v10 offset:12288
    s_waitcnt lgkmcnt(15)
    v_mfma_f32_16x16x32_bf16 v[28:31], v[76:79], v[88:91], v[28:31]
    ds_read_b64_tr_b16 v[74:75], v10 offset:14336
    v_add_u32 v10, s39, v10
    buffer_load_dwordx4 v[184:187], v2, s[24:27], s34 offen offset:0
    v_mfma_f32_16x16x32_bf16 v[44:47], v[76:79], v[92:95], v[44:47]
    ds_read_b64_tr_b16 v[76:77], v11 offset:12288
    buffer_load_dwordx4 v[188:191], v2, s[24:27], s34 offen offset:1024
    s_add_u32 s34, s34, 8192
    s_waitcnt lgkmcnt(15)
    v_mfma_f32_16x16x32_bf16 v[16:19], v[48:51], v[96:99], v[16:19]
    ds_read_b64_tr_b16 v[78:79], v11 offset:14336
    v_add_u32 v11, s39, v11
    v_mfma_f32_16x16x32_bf16 v[32:35], v[48:51], v[100:103], v[32:35]
    s_waitcnt lgkmcnt(5)
    v_cmp_ge_u32 vcc, s37, v15
    s_cbranch_vccnz L_dn_slow0
L_dn_ret0:
    ds_read_b64_tr_b16 v[48:49], v8 offset:0
    v_mfma_f32_16x16x32_bf16 v[20:23], v[52:55], v[96:99], v[20:23]
    ds_read_b64_tr_b16 v[50:51], v8 offset:2048
    v_mfma_f32_16x16x32_bf16 v[36:39], v[52:55], v[100:103], v[36:39]
    ds_read_b64_tr_b16 v[52:53], v9 offset:0
    v_mfma_f32_16x16x32_bf16 v[24:27], v[56:59], v[96:99], v[24:27]
    ds_read_b64_tr_b16 v[54:55], v9 offset:2048
    v_mfma_f32_16x16x32_bf16 v[40:43], v[56:59], v[100:103], v[40:43]
    ds_read_b64_tr_b16 v[56:57], v10 offset:0
    v_mfma_f32_16x16x32_bf16 v[28:31], v[60:63], v[96:99], v[28:31]
    ds_read_b64_tr_b16 v[58:59], v10 offset:2048
    buffer_load_dwordx4 v[192:195], v2, s[24:27], s34 offen offset:0
    v_mfma_f32_16x16x32_bf16 v[44:47], v[60:63], v[100:103], v[44:47]
    ds_read_b64_tr_b16 v[60:61], v11 offset:0
    buffer_load_dwordx4 v[196:199], v2, s[24:27], s34 offen offset:1024
    s_add_u32 s34, s34, 8192
    v_mfma_f32_16x16x32_bf16 v[16:19], v[64:67], v[104:107], v[16:19]
    ds_read_b64_tr_b16 v[62:63], v11 offset:2048
    v_mfma_f32_16x16x32_bf16 v[32:35], v[64:67], v[108:111], v[32:35]
    ds_read_b64_tr_b16 v[64:65], v8 offset:4096
    s_waitcnt lgkmcnt(13)
    v_mfma_f32_16x16x32_bf16 v[20:23], v[68:71], v[104:107], v[20:23]
    ds_read_b64_tr_b16 v[66:67], v8 offset:6144
    v_mfma_f32_16x16x32_bf16 v[36:39], v[68:71], v[108:111], v[36:39]
    ds_read_b64_tr_b16 v[68:69], v9 offset:4096
    s_waitcnt lgkmcnt(13)
    v_mfma_f32_16x16x32_bf16 v[24:27], v[72:75], v[104:107], v[24:27]
    ds_read_b64_tr_b16 v[70:71], v9 offset:6144
    v_mfma_f32_16x16x32_bf16 v[40:43], v[72:75], v[108:111], v[40:43]
    ds_read_b64_tr_b16 v[72:73], v10 offset:4096
    s_waitcnt lgkmcnt(13)
    v_mfma_f32_16x16x32_bf16 v[28:31], v[76:79], v[104:107], v[28:31]
    ds_read_b64_tr_b16 v[74:75], v10 offset:6144
    buffer_load_dwordx4 v[200:203], v2, s[24:27], s34 offen offset:0
    v_mfma_f32_16x16x32_bf16 v[44:47], v[76:79], v[108:111], v[44:47]
    ds_read_b64_tr_b16 v[76:77], v11 offset:4096
    buffer_load_dwordx4 v[204:207], v2, s[24:27], s34 offen offset:1024
    s_add_u32 s34, s34, 8192
    s_waitcnt vmcnt(30) lgkmcnt(13)
    v_mfma_f32_16x16x32_bf16 v[16:19], v[48:51], v[112:115], v[16:19]
    ds_read_b64_tr_b16 v[78:79], v11 offset:6144
    v_mfma_f32_16x16x32_bf16 v[32:35], v[48:51], v[116:119], v[32:35]
    ds_read_b64_tr_b16 v[48:49], v8 offset:8192
    s_mov_b32 m0, s40
    s_add_u32 s40, s40, 16384
    s_waitcnt lgkmcnt(13)
    v_mfma_f32_16x16x32_bf16 v[20:23], v[52:55], v[112:115], v[20:23]
    ds_read_b64_tr_b16 v[50:51], v8 offset:10240
    v_add_u32 v13, 1, v13
    s_add_u32 s37, s37, 1
    buffer_load_dwordx4 v4, s[8:11], s33 offen offset:0 lds
    v_mfma_f32_16x16x32_bf16 v[36:39], v[52:55], v[116:119], v[36:39]
    ds_read_b64_tr_b16 v[52:53], v9 offset:8192
    s_waitcnt vmcnt(21)
    ds_write_b32 v14, v13
    buffer_load_dwordx4 v5, s[8:11], s33 offen offset:1024 lds
    s_cmp_eq_u32 s40, s43
    s_cselect_b32 s40, s42, s40
    s_waitcnt lgkmcnt(14)
    v_mfma_f32_16x16x32_bf16 v[24:27], v[56:59], v[112:115], v[24:27]
    ds_read_b64_tr_b16 v[54:55], v9 offset:10240
    buffer_load_dwordx4 v6, s[8:11], s33 offen offset:2048 lds
    v_mfma_f32_16x16x32_bf16 v[40:43], v[56:59], v[116:119], v[40:43]
    ds_read_b64_tr_b16 v[56:57], v10 offset:8192
    buffer_load_dwordx4 v7, s[8:11], s33 offen offset:3072 lds
    s_add_u32 s33, s33, 262144
    s_waitcnt lgkmcnt(14)
    v_mfma_f32_16x16x32_bf16 v[28:31], v[60:63], v[112:115], v[28:31]
    ds_read_b64_tr_b16 v[58:59], v10 offset:10240
    s_add_u32 s38, s38, 1
    s_cmp_eq_u32 s38, 7
    s_cselect_b32 s39, s47, s46
    s_cselect_b32 s38, 0, s38
    buffer_load_dwordx4 v[208:211], v2, s[24:27], s34 offen offset:0
    v_mfma_f32_16x16x32_bf16 v[44:47], v[60:63], v[116:119], v[44:47]
    ds_read_b64_tr_b16 v[60:61], v11 offset:8192
    buffer_load_dwordx4 v[212:215], v2, s[24:27], s34 offen offset:1024
    s_add_u32 s34, s34, 8192
    s_waitcnt lgkmcnt(14)
    v_mfma_f32_16x16x32_bf16 v[16:19], v[64:67], v[120:123], v[16:19]
    ds_read_b64_tr_b16 v[62:63], v11 offset:10240
    v_mfma_f32_16x16x32_bf16 v[32:35], v[64:67], v[124:127], v[32:35]
    ds_read_b64_tr_b16 v[64:65], v8 offset:12288
    s_waitcnt lgkmcnt(14)
    v_mfma_f32_16x16x32_bf16 v[20:23], v[68:71], v[120:123], v[20:23]
    ds_read_b64_tr_b16 v[66:67], v8 offset:14336
    v_add_u32 v8, s39, v8
    v_mfma_f32_16x16x32_bf16 v[36:39], v[68:71], v[124:127], v[36:39]
    ds_read_b64_tr_b16 v[68:69], v9 offset:12288
    ds_read_b32 v15, v0
    s_waitcnt lgkmcnt(15)
    v_mfma_f32_16x16x32_bf16 v[24:27], v[72:75], v[120:123], v[24:27]
    ds_read_b64_tr_b16 v[70:71], v9 offset:14336
    v_add_u32 v9, s39, v9
    v_mfma_f32_16x16x32_bf16 v[40:43], v[72:75], v[124:127], v[40:43]
    ds_read_b64_tr_b16 v[72:73], v10 offset:12288
    s_waitcnt lgkmcnt(15)
    v_mfma_f32_16x16x32_bf16 v[28:31], v[76:79], v[120:123], v[28:31]
    ds_read_b64_tr_b16 v[74:75], v10 offset:14336
    v_add_u32 v10, s39, v10
    buffer_load_dwordx4 v[216:219], v2, s[24:27], s34 offen offset:0
    v_mfma_f32_16x16x32_bf16 v[44:47], v[76:79], v[124:127], v[44:47]
    ds_read_b64_tr_b16 v[76:77], v11 offset:12288
    buffer_load_dwordx4 v[220:223], v2, s[24:27], s34 offen offset:1024
    s_add_u32 s34, s34, 8192
    s_waitcnt lgkmcnt(15)
    v_mfma_f32_16x16x32_bf16 v[16:19], v[48:51], v[128:131], v[16:19]
    ds_read_b64_tr_b16 v[78:79], v11 offset:14336
    v_add_u32 v11, s39, v11
    v_mfma_f32_16x16x32_bf16 v[32:35], v[48:51], v[132:135], v[32:35]
    s_waitcnt lgkmcnt(5)
    v_cmp_ge_u32 vcc, s37, v15
    s_cbranch_vccnz L_dn_slow1
L_dn_ret1:
    ds_read_b64_tr_b16 v[48:49], v8 offset:0
    v_mfma_f32_16x16x32_bf16 v[20:23], v[52:55], v[128:131], v[20:23]
    ds_read_b64_tr_b16 v[50:51], v8 offset:2048
    v_mfma_f32_16x16x32_bf16 v[36:39], v[52:55], v[132:135], v[36:39]
    ds_read_b64_tr_b16 v[52:53], v9 offset:0
    v_mfma_f32_16x16x32_bf16 v[24:27], v[56:59], v[128:131], v[24:27]
    ds_read_b64_tr_b16 v[54:55], v9 offset:2048
    v_mfma_f32_16x16x32_bf16 v[40:43], v[56:59], v[132:135], v[40:43]
    ds_read_b64_tr_b16 v[56:57], v10 offset:0
    v_mfma_f32_16x16x32_bf16 v[28:31], v[60:63], v[128:131], v[28:31]
    ds_read_b64_tr_b16 v[58:59], v10 offset:2048
    buffer_load_dwordx4 v[224:227], v2, s[24:27], s34 offen offset:0
    v_mfma_f32_16x16x32_bf16 v[44:47], v[60:63], v[132:135], v[44:47]
    ds_read_b64_tr_b16 v[60:61], v11 offset:0
    buffer_load_dwordx4 v[228:231], v2, s[24:27], s34 offen offset:1024
    s_add_u32 s34, s34, 8192
    v_mfma_f32_16x16x32_bf16 v[16:19], v[64:67], v[136:139], v[16:19]
    ds_read_b64_tr_b16 v[62:63], v11 offset:2048
    v_mfma_f32_16x16x32_bf16 v[32:35], v[64:67], v[140:143], v[32:35]
    ds_read_b64_tr_b16 v[64:65], v8 offset:4096
    s_waitcnt lgkmcnt(13)
    v_mfma_f32_16x16x32_bf16 v[20:23], v[68:71], v[136:139], v[20:23]
    ds_read_b64_tr_b16 v[66:67], v8 offset:6144
    v_mfma_f32_16x16x32_bf16 v[36:39], v[68:71], v[140:143], v[36:39]
    ds_read_b64_tr_b16 v[68:69], v9 offset:4096
    s_waitcnt lgkmcnt(13)
    v_mfma_f32_16x16x32_bf16 v[24:27], v[72:75], v[136:139], v[24:27]
    ds_read_b64_tr_b16 v[70:71], v9 offset:6144
    v_mfma_f32_16x16x32_bf16 v[40:43], v[72:75], v[140:143], v[40:43]
    ds_read_b64_tr_b16 v[72:73], v10 offset:4096
    s_waitcnt lgkmcnt(13)
    v_mfma_f32_16x16x32_bf16 v[28:31], v[76:79], v[136:139], v[28:31]
    ds_read_b64_tr_b16 v[74:75], v10 offset:6144
    buffer_load_dwordx4 v[232:235], v2, s[24:27], s34 offen offset:0
    v_mfma_f32_16x16x32_bf16 v[44:47], v[76:79], v[140:143], v[44:47]
    ds_read_b64_tr_b16 v[76:77], v11 offset:4096
    buffer_load_dwordx4 v[236:239], v2, s[24:27], s34 offen offset:1024
    s_add_u32 s34, s34, 8192
    s_waitcnt vmcnt(30) lgkmcnt(13)
    v_mfma_f32_16x16x32_bf16 v[16:19], v[48:51], v[144:147], v[16:19]
    ds_read_b64_tr_b16 v[78:79], v11 offset:6144
    v_mfma_f32_16x16x32_bf16 v[32:35], v[48:51], v[148:151], v[32:35]
    ds_read_b64_tr_b16 v[48:49], v8 offset:8192
    s_mov_b32 m0, s40
    s_add_u32 s40, s40, 16384
    s_waitcnt lgkmcnt(13)
    v_mfma_f32_16x16x32_bf16 v[20:23], v[52:55], v[144:147], v[20:23]
    ds_read_b64_tr_b16 v[50:51], v8 offset:10240
    v_add_u32 v13, 1, v13
    s_add_u32 s37, s37, 1
    buffer_load_dwordx4 v4, s[8:11], s33 offen offset:0 lds
    v_mfma_f32_16x16x32_bf16 v[36:39], v[52:55], v[148:151], v[36:39]
    ds_read_b64_tr_b16 v[52:53], v9 offset:8192
    s_waitcnt vmcnt(21)
    ds_write_b32 v14, v13
    buffer_load_dwordx4 v5, s[8:11], s33 offen offset:1024 lds
    s_cmp_eq_u32 s40, s43
    s_cselect_b32 s40, s42, s40
    s_waitcnt lgkmcnt(14)
    v_mfma_f32_16x16x32_bf16 v[24:27], v[56:59], v[144:147], v[24:27]
    ds_read_b64_tr_b16 v[54:55], v9 offset:10240
    buffer_load_dwordx4 v6, s[8:11], s33 offen offset:2048 lds
    v_mfma_f32_16x16x32_bf16 v[40:43], v[56:59], v[148:151], v[40:43]
    ds_read_b64_tr_b16 v[56:57], v10 offset:8192
    buffer_load_dwordx4 v7, s[8:11], s33 offen offset:3072 lds
    s_add_u32 s33, s33, 262144
    s_waitcnt lgkmcnt(14)
    v_mfma_f32_16x16x32_bf16 v[28:31], v[60:63], v[144:147], v[28:31]
    ds_read_b64_tr_b16 v[58:59], v10 offset:10240
    s_add_u32 s38, s38, 1
    s_cmp_eq_u32 s38, 7
    s_cselect_b32 s39, s47, s46
    s_cselect_b32 s38, 0, s38
    buffer_load_dwordx4 v[80:83], v2, s[24:27], s34 offen offset:0
    v_mfma_f32_16x16x32_bf16 v[44:47], v[60:63], v[148:151], v[44:47]
    ds_read_b64_tr_b16 v[60:61], v11 offset:8192
    buffer_load_dwordx4 v[84:87], v2, s[24:27], s34 offen offset:1024
    s_add_u32 s34, s34, 8192
    s_waitcnt lgkmcnt(14)
    v_mfma_f32_16x16x32_bf16 v[16:19], v[64:67], v[152:155], v[16:19]
    ds_read_b64_tr_b16 v[62:63], v11 offset:10240
    v_mfma_f32_16x16x32_bf16 v[32:35], v[64:67], v[156:159], v[32:35]
    ds_read_b64_tr_b16 v[64:65], v8 offset:12288
    s_waitcnt lgkmcnt(14)
    v_mfma_f32_16x16x32_bf16 v[20:23], v[68:71], v[152:155], v[20:23]
    ds_read_b64_tr_b16 v[66:67], v8 offset:14336
    v_add_u32 v8, s39, v8
    v_mfma_f32_16x16x32_bf16 v[36:39], v[68:71], v[156:159], v[36:39]
    ds_read_b64_tr_b16 v[68:69], v9 offset:12288
    ds_read_b32 v15, v0
    s_waitcnt lgkmcnt(15)
    v_mfma_f32_16x16x32_bf16 v[24:27], v[72:75], v[152:155], v[24:27]
    ds_read_b64_tr_b16 v[70:71], v9 offset:14336
    v_add_u32 v9, s39, v9
    v_mfma_f32_16x16x32_bf16 v[40:43], v[72:75], v[156:159], v[40:43]
    ds_read_b64_tr_b16 v[72:73], v10 offset:12288
    s_waitcnt lgkmcnt(15)
    v_mfma_f32_16x16x32_bf16 v[28:31], v[76:79], v[152:155], v[28:31]
    ds_read_b64_tr_b16 v[74:75], v10 offset:14336
    v_add_u32 v10, s39, v10
    buffer_load_dwordx4 v[88:91], v2, s[24:27], s34 offen offset:0
    v_mfma_f32_16x16x32_bf16 v[44:47], v[76:79], v[156:159], v[44:47]
    ds_read_b64_tr_b16 v[76:77], v11 offset:12288
    buffer_load_dwordx4 v[92:95], v2, s[24:27], s34 offen offset:1024
    s_add_u32 s34, s34, 8192
    s_waitcnt lgkmcnt(15)
    v_mfma_f32_16x16x32_bf16 v[16:19], v[48:51], v[160:163], v[16:19]
    ds_read_b64_tr_b16 v[78:79], v11 offset:14336
    v_add_u32 v11, s39, v11
    v_mfma_f32_16x16x32_bf16 v[32:35], v[48:51], v[164:167], v[32:35]
    s_waitcnt lgkmcnt(5)
    v_cmp_ge_u32 vcc, s37, v15
    s_cbranch_vccnz L_dn_slow2
L_dn_ret2:
    ds_read_b64_tr_b16 v[48:49], v8 offset:0
    v_mfma_f32_16x16x32_bf16 v[20:23], v[52:55], v[160:163], v[20:23]
    ds_read_b64_tr_b16 v[50:51], v8 offset:2048
    v_mfma_f32_16x16x32_bf16 v[36:39], v[52:55], v[164:167], v[36:39]
    ds_read_b64_tr_b16 v[52:53], v9 offset:0
    v_mfma_f32_16x16x32_bf16 v[24:27], v[56:59], v[160:163], v[24:27]
    ds_read_b64_tr_b16 v[54:55], v9 offset:2048
    v_mfma_f32_16x16x32_bf16 v[40:43], v[56:59], v[164:167], v[40:43]
    ds_read_b64_tr_b16 v[56:57], v10 offset:0
    v_mfma_f32_16x16x32_bf16 v[28:31], v[60:63], v[160:163], v[28:31]
    ds_read_b64_tr_b16 v[58:59], v10 offset:2048
    buffer_load_dwordx4 v[96:99], v2, s[24:27], s34 offen offset:0
    v_mfma_f32_16x16x32_bf16 v[44:47], v[60:63], v[164:167], v[44:47]
    ds_read_b64_tr_b16 v[60:61], v11 offset:0
    buffer_load_dwordx4 v[100:103], v2, s[24:27], s34 offen offset:1024
    s_add_u32 s34, s34, 8192
    v_mfma_f32_16x16x32_bf16 v[16:19], v[64:67], v[168:171], v[16:19]
    ds_read_b64_tr_b16 v[62:63], v11 offset:2048
    v_mfma_f32_16x16x32_bf16 v[32:35], v[64:67], v[172:175], v[32:35]
    ds_read_b64_tr_b16 v[64:65], v8 offset:4096
    s_waitcnt lgkmcnt(13)
    v_mfma_f32_16x16x32_bf16 v[20:23], v[68:71], v[168:171], v[20:23]
    ds_read_b64_tr_b16 v[66:67], v8 offset:6144
    v_mfma_f32_16x16x32_bf16 v[36:39], v[68:71], v[172:175], v[36:39]
    ds_read_b64_tr_b16 v[68:69], v9 offset:4096
    s_waitcnt lgkmcnt(13)
    v_mfma_f32_16x16x32_bf16 v[24:27], v[72:75], v[168:171], v[24:27]
    ds_read_b64_tr_b16 v[70:71], v9 offset:6144
    v_mfma_f32_16x16x32_bf16 v[40:43], v[72:75], v[172:175], v[40:43]
    ds_read_b64_tr_b16 v[72:73], v10 offset:4096
    s_waitcnt lgkmcnt(13)
    v_mfma_f32_16x16x32_bf16 v[28:31], v[76:79], v[168:171], v[28:31]
    ds_read_b64_tr_b16 v[74:75], v10 offset:6144
    buffer_load_dwordx4 v[104:107], v2, s[24:27], s34 offen offset:0
    v_mfma_f32_16x16x32_bf16 v[44:47], v[76:79], v[172:175], v[44:47]
    ds_read_b64_tr_b16 v[76:77], v11 offset:4096
    buffer_load_dwordx4 v[108:111], v2, s[24:27], s34 offen offset:1024
    s_add_u32 s34, s34, 8192
    s_waitcnt vmcnt(30) lgkmcnt(13)
    v_mfma_f32_16x16x32_bf16 v[16:19], v[48:51], v[176:179], v[16:19]
    ds_read_b64_tr_b16 v[78:79], v11 offset:6144
    v_mfma_f32_16x16x32_bf16 v[32:35], v[48:51], v[180:183], v[32:35]
    ds_read_b64_tr_b16 v[48:49], v8 offset:8192
    s_mov_b32 m0, s40
    s_add_u32 s40, s40, 16384
    s_waitcnt lgkmcnt(13)
    v_mfma_f32_16x16x32_bf16 v[20:23], v[52:55], v[176:179], v[20:23]
    ds_read_b64_tr_b16 v[50:51], v8 offset:10240
    v_add_u32 v13, 1, v13
    s_add_u32 s37, s37, 1
    buffer_load_dwordx4 v4, s[8:11], s33 offen offset:0 lds
    v_mfma_f32_16x16x32_bf16 v[36:39], v[52:55], v[180:183], v[36:39]
    ds_read_b64_tr_b16 v[52:53], v9 offset:8192
    s_waitcnt vmcnt(21)
    ds_write_b32 v14, v13
    buffer_load_dwordx4 v5, s[8:11], s33 offen offset:1024 lds
    s_cmp_eq_u32 s40, s43
    s_cselect_b32 s40, s42, s40
    s_waitcnt lgkmcnt(14)
    v_mfma_f32_16x16x32_bf16 v[24:27], v[56:59], v[176:179], v[24:27]
    ds_read_b64_tr_b16 v[54:55], v9 offset:10240
    buffer_load_dwordx4 v6, s[8:11], s33 offen offset:2048 lds
    v_mfma_f32_16x16x32_bf16 v[40:43], v[56:59], v[180:183], v[40:43]
    ds_read_b64_tr_b16 v[56:57], v10 offset:8192
    buffer_load_dwordx4 v7, s[8:11], s33 offen offset:3072 lds
    s_add_u32 s33, s33, 262144
    s_waitcnt lgkmcnt(14)
    v_mfma_f32_16x16x32_bf16 v[28:31], v[60:63], v[176:179], v[28:31]
    ds_read_b64_tr_b16 v[58:59], v10 offset:10240
    s_add_u32 s38, s38, 1
    s_cmp_eq_u32 s38, 7
    s_cselect_b32 s39, s47, s46
    s_cselect_b32 s38, 0, s38
    buffer_load_dwordx4 v[112:115], v2, s[24:27], s34 offen offset:0
    v_mfma_f32_16x16x32_bf16 v[44:47], v[60:63], v[180:183], v[44:47]
    ds_read_b64_tr_b16 v[60:61], v11 offset:8192
    buffer_load_dwordx4 v[116:119], v2, s[24:27], s34 offen offset:1024
    s_add_u32 s34, s34, 8192
    s_waitcnt lgkmcnt(14)
    v_mfma_f32_16x16x32_bf16 v[16:19], v[64:67], v[184:187], v[16:19]
    ds_read_b64_tr_b16 v[62:63], v11 offset:10240
    v_mfma_f32_16x16x32_bf16 v[32:35], v[64:67], v[188:191], v[32:35]
    ds_read_b64_tr_b16 v[64:65], v8 offset:12288
    s_waitcnt lgkmcnt(14)
    v_mfma_f32_16x16x32_bf16 v[20:23], v[68:71], v[184:187], v[20:23]
    ds_read_b64_tr_b16 v[66:67], v8 offset:14336
    v_add_u32 v8, s39, v8
    v_mfma_f32_16x16x32_bf16 v[36:39], v[68:71], v[188:191], v[36:39]
    ds_read_b64_tr_b16 v[68:69], v9 offset:12288
    ds_read_b32 v15, v0
    s_waitcnt lgkmcnt(15)
    v_mfma_f32_16x16x32_bf16 v[24:27], v[72:75], v[184:187], v[24:27]
    ds_read_b64_tr_b16 v[70:71], v9 offset:14336
    v_add_u32 v9, s39, v9
    v_mfma_f32_16x16x32_bf16 v[40:43], v[72:75], v[188:191], v[40:43]
    ds_read_b64_tr_b16 v[72:73], v10 offset:12288
    s_waitcnt lgkmcnt(15)
    v_mfma_f32_16x16x32_bf16 v[28:31], v[76:79], v[184:187], v[28:31]
    ds_read_b64_tr_b16 v[74:75], v10 offset:14336
    v_add_u32 v10, s39, v10
    buffer_load_dwordx4 v[120:123], v2, s[24:27], s34 offen offset:0
    v_mfma_f32_16x16x32_bf16 v[44:47], v[76:79], v[188:191], v[44:47]
    ds_read_b64_tr_b16 v[76:77], v11 offset:12288
    buffer_load_dwordx4 v[124:127], v2, s[24:27], s34 offen offset:1024
    s_add_u32 s34, s34, 8192
    s_waitcnt lgkmcnt(15)
    v_mfma_f32_16x16x32_bf16 v[16:19], v[48:51], v[192:195], v[16:19]
    ds_read_b64_tr_b16 v[78:79], v11 offset:14336
    v_add_u32 v11, s39, v11
    v_mfma_f32_16x16x32_bf16 v[32:35], v[48:51], v[196:199], v[32:35]
    s_waitcnt lgkmcnt(5)
    v_cmp_ge_u32 vcc, s37, v15
    s_cbranch_vccnz L_dn_slow3
L_dn_ret3:
    ds_read_b64_tr_b16 v[48:49], v8 offset:0
    v_mfma_f32_16x16x32_bf16 v[20:23], v[52:55], v[192:195], v[20:23]
    ds_read_b64_tr_b16 v[50:51], v8 offset:2048
    v_mfma_f32_16x16x32_bf16 v[36:39], v[52:55], v[196:199], v[36:39]
    ds_read_b64_tr_b16 v[52:53], v9 offset:0
    v_mfma_f32_16x16x32_bf16 v[24:27], v[56:59], v[192:195], v[24:27]
    ds_read_b64_tr_b16 v[54:55], v9 offset:2048
    v_mfma_f32_16x16x32_bf16 v[40:43], v[56:59], v[196:199], v[40:43]
    ds_read_b64_tr_b16 v[56:57], v10 offset:0
    v_mfma_f32_16x16x32_bf16 v[28:31], v[60:63], v[192:195], v[28:31]
    ds_read_b64_tr_b16 v[58:59], v10 offset:2048
    buffer_load_dwordx4 v[128:131], v2, s[24:27], s34 offen offset:0
    v_mfma_f32_16x16x32_bf16 v[44:47], v[60:63], v[196:199], v[44:47]
    ds_read_b64_tr_b16 v[60:61], v11 offset:0
    buffer_load_dwordx4 v[132:135], v2, s[24:27], s34 offen offset:1024
    s_add_u32 s34, s34, 8192
    v_mfma_f32_16x16x32_bf16 v[16:19], v[64:67], v[200:203], v[16:19]
    ds_read_b64_tr_b16 v[62:63], v11 offset:2048
    v_mfma_f32_16x16x32_bf16 v[32:35], v[64:67], v[204:207], v[32:35]
    ds_read_b64_tr_b16 v[64:65], v8 offset:4096
    s_waitcnt lgkmcnt(13)
    v_mfma_f32_16x16x32_bf16 v[20:23], v[68:71], v[200:203], v[20:23]
    ds_read_b64_tr_b16 v[66:67], v8 offset:6144
    v_mfma_f32_16x16x32_bf16 v[36:39], v[68:71], v[204:207], v[36:39]
    ds_read_b64_tr_b16 v[68:69], v9 offset:4096
    s_waitcnt lgkmcnt(13)
    v_mfma_f32_16x16x32_bf16 v[24:27], v[72:75], v[200:203], v[24:27]
    ds_read_b64_tr_b16 v[70:71], v9 offset:6144
    v_mfma_f32_16x16x32_bf16 v[40:43], v[72:75], v[204:207], v[40:43]
    ds_read_b64_tr_b16 v[72:73], v10 offset:4096
    s_waitcnt lgkmcnt(13)
    v_mfma_f32_16x16x32_bf16 v[28:31], v[76:79], v[200:203], v[28:31]
    ds_read_b64_tr_b16 v[74:75], v10 offset:6144
    buffer_load_dwordx4 v[136:139], v2, s[24:27], s34 offen offset:0
    v_mfma_f32_16x16x32_bf16 v[44:47], v[76:79], v[204:207], v[44:47]
    ds_read_b64_tr_b16 v[76:77], v11 offset:4096
    buffer_load_dwordx4 v[140:143], v2, s[24:27], s34 offen offset:1024
    s_add_u32 s34, s34, 8192
    s_waitcnt vmcnt(30) lgkmcnt(13)
    v_mfma_f32_16x16x32_bf16 v[16:19], v[48:51], v[208:211], v[16:19]
    ds_read_b64_tr_b16 v[78:79], v11 offset:6144
    v_mfma_f32_16x16x32_bf16 v[32:35], v[48:51], v[212:215], v[32:35]
    ds_read_b64_tr_b16 v[48:49], v8 offset:8192
    s_mov_b32 m0, s40
    s_add_u32 s40, s40, 16384
    s_waitcnt lgkmcnt(13)
    v_mfma_f32_16x16x32_bf16 v[20:23], v[52:55], v[208:211], v[20:23]
    ds_read_b64_tr_b16 v[50:51], v8 offset:10240
    v_add_u32 v13, 1, v13
    s_add_u32 s37, s37, 1
    buffer_load_dwordx4 v4, s[8:11], s33 offen offset:0 lds
    v_mfma_f32_16x16x32_bf16 v[36:39], v[52:55], v[212:215], v[36:39]
    ds_read_b64_tr_b16 v[52:53], v9 offset:8192
    s_waitcnt vmcnt(21)
    ds_write_b32 v14, v13
    buffer_load_dwordx4 v5, s[8:11], s33 offen offset:1024 lds
    s_cmp_eq_u32 s40, s43
    s_cselect_b32 s40, s42, s40
    s_waitcnt lgkmcnt(14)
    v_mfma_f32_16x16x32_bf16 v[24:27], v[56:59], v[208:211], v[24:27]
    ds_read_b64_tr_b16 v[54:55], v9 offset:10240
    buffer_load_dwordx4 v6, s[8:11], s33 offen offset:2048 lds
    v_mfma_f32_16x16x32_bf16 v[40:43], v[56:59], v[212:215], v[40:43]
    ds_read_b64_tr_b16 v[56:57], v10 offset:8192
    buffer_load_dwordx4 v7, s[8:11], s33 offen offset:3072 lds
    s_add_u32 s33, s33, 262144
    s_waitcnt lgkmcnt(14)
    v_mfma_f32_16x16x32_bf16 v[28:31], v[60:63], v[208:211], v[28:31]
    ds_read_b64_tr_b16 v[58:59], v10 offset:10240
    s_add_u32 s38, s38, 1
    s_cmp_eq_u32 s38, 7
    s_cselect_b32 s39, s47, s46
    s_cselect_b32 s38, 0, s38
    buffer_load_dwordx4 v[144:147], v2, s[24:27], s34 offen offset:0
    v_mfma_f32_16x16x32_bf16 v[44:47], v[60:63], v[212:215], v[44:47]
    ds_read_b64_tr_b16 v[60:61], v11 offset:8192
    buffer_load_dwordx4 v[148:151], v2, s[24:27], s34 offen offset:1024
    s_add_u32 s34, s34, 8192
    s_waitcnt lgkmcnt(14)
    v_mfma_f32_16x16x32_bf16 v[16:19], v[64:67], v[216:219], v[16:19]
    ds_read_b64_tr_b16 v[62:63], v11 offset:10240
    v_mfma_f32_16x16x32_bf16 v[32:35], v[64:67], v[220:223], v[32:35]
    ds_read_b64_tr_b16 v[64:65], v8 offset:12288
    s_waitcnt lgkmcnt(14)
    v_mfma_f32_16x16x32_bf16 v[20:23], v[68:71], v[216:219], v[20:23]
    ds_read_b64_tr_b16 v[66:67], v8 offset:14336
    v_add_u32 v8, s39, v8
    v_mfma_f32_16x16x32_bf16 v[36:39], v[68:71], v[220:223], v[36:39]
    ds_read_b64_tr_b16 v[68:69], v9 offset:12288
    ds_read_b32 v15, v0
    s_waitcnt lgkmcnt(15)
    v_mfma_f32_16x16x32_bf16 v[24:27], v[72:75], v[216:219], v[24:27]
    ds_read_b64_tr_b16 v[70:71], v9 offset:14336
    v_add_u32 v9, s39, v9
    v_mfma_f32_16x16x32_bf16 v[40:43], v[72:75], v[220:223], v[40:43]
    ds_read_b64_tr_b16 v[72:73], v10 offset:12288
    s_waitcnt lgkmcnt(15)
    v_mfma_f32_16x16x32_bf16 v[28:31], v[76:79], v[216:219], v[28:31]
    ds_read_b64_tr_b16 v[74:75], v10 offset:14336
    v_add_u32 v10, s39, v10
    buffer_load_dwordx4 v[152:155], v2, s[24:27], s34 offen offset:0
    v_mfma_f32_16x16x32_bf16 v[44:47], v[76:79], v[220:223], v[44:47]
    ds_read_b64_tr_b16 v[76:77], v11 offset:12288
    buffer_load_dwordx4 v[156:159], v2, s[24:27], s34 offen offset:1024
    s_add_u32 s34, s34, 8192
    s_waitcnt lgkmcnt(15)
    v_mfma_f32_16x16x32_bf16 v[16:19], v[48:51], v[224:227], v[16:19]
    ds_read_b64_tr_b16 v[78:79], v11 offset:14336
    v_add_u32 v11, s39, v11
    v_mfma_f32_16x16x32_bf16 v[32:35], v[48:51], v[228:231], v[32:35]
    s_waitcnt lgkmcnt(5)
    v_cmp_ge_u32 vcc, s37, v15
    s_cbranch_vccnz L_dn_slow4
L_dn_ret4:
    ds_read_b64_tr_b16 v[48:49], v8 offset:0
    v_mfma_f32_16x16x32_bf16 v[20:23], v[52:55], v[224:227], v[20:23]
    ds_read_b64_tr_b16 v[50:51], v8 offset:2048
    v_mfma_f32_16x16x32_bf16 v[36:39], v[52:55], v[228:231], v[36:39]
    ds_read_b64_tr_b16 v[52:53], v9 offset:0
    v_mfma_f32_16x16x32_bf16 v[24:27], v[56:59], v[224:227], v[24:27]
    ds_read_b64_tr_b16 v[54:55], v9 offset:2048
    v_mfma_f32_16x16x32_bf16 v[40:43], v[56:59], v[228:231], v[40:43]
    ds_read_b64_tr_b16 v[56:57], v10 offset:0
    v_mfma_f32_16x16x32_bf16 v[28:31], v[60:63], v[224:227], v[28:31]
    ds_read_b64_tr_b16 v[58:59], v10 offset:2048
    buffer_load_dwordx4 v[160:163], v2, s[24:27], s34 offen offset:0
    v_mfma_f32_16x16x32_bf16 v[44:47], v[60:63], v[228:231], v[44:47]
    ds_read_b64_tr_b16 v[60:61], v11 offset:0
    buffer_load_dwordx4 v[164:167], v2, s[24:27], s34 offen offset:1024
    s_add_u32 s34, s34, 8192
    v_mfma_f32_16x16x32_bf16 v[16:19], v[64:67], v[232:235], v[16:19]
    ds_read_b64_tr_b16 v[62:63], v11 offset:2048
    v_mfma_f32_16x16x32_bf16 v[32:35], v[64:67], v[236:239], v[32:35]
    ds_read_b64_tr_b16 v[64:65], v8 offset:4096
    s_waitcnt lgkmcnt(13)
    v_mfma_f32_16x16x32_bf16 v[20:23], v[68:71], v[232:235], v[20:23]
    ds_read_b64_tr_b16 v[66:67], v8 offset:6144
    v_mfma_f32_16x16x32_bf16 v[36:39], v[68:71], v[236:239], v[36:39]
    ds_read_b64_tr_b16 v[68:69], v9 offset:4096
    s_waitcnt lgkmcnt(13)
    v_mfma_f32_16x16x32_bf16 v[24:27], v[72:75], v[232:235], v[24:27]
    ds_read_b64_tr_b16 v[70:71], v9 offset:6144
    v_mfma_f32_16x16x32_bf16 v[40:43], v[72:75], v[236:239], v[40:43]
    ds_read_b64_tr_b16 v[72:73], v10 offset:4096
    s_waitcnt lgkmcnt(13)
    v_mfma_f32_16x16x32_bf16 v[28:31], v[76:79], v[232:235], v[28:31]
    ds_read_b64_tr_b16 v[74:75], v10 offset:6144
    buffer_load_dwordx4 v[168:171], v2, s[24:27], s34 offen offset:0
    v_mfma_f32_16x16x32_bf16 v[44:47], v[76:79], v[236:239], v[44:47]
    ds_read_b64_tr_b16 v[76:77], v11 offset:4096
    buffer_load_dwordx4 v[172:175], v2, s[24:27], s34 offen offset:1024
    s_add_u32 s34, s34, 8192
    s_cmp_eq_u32 s29, 4
    s_cbranch_scc1 L_dn_tail
    s_add_u32 s29, s29, 1
    s_branch L_dn_loop
L_dn_slow0:
    ds_read_b32 v15, v0
    s_waitcnt lgkmcnt(0)
    v_cmp_ge_u32 vcc, s37, v15
    s_cbranch_vccnz L_dn_slow0
    s_branch L_dn_ret0
L_dn_slow1:
    ds_read_b32 v15, v0
    s_waitcnt lgkmcnt(0)
    v_cmp_ge_u32 vcc, s37, v15
    s_cbranch_vccnz L_dn_slow1
    s_branch L_dn_ret1
L_dn_slow2:
    ds_read_b32 v15, v0
    s_waitcnt lgkmcnt(0)
    v_cmp_ge_u32 vcc, s37, v15
    s_cbranch_vccnz L_dn_slow2
    s_branch L_dn_ret2
L_dn_slow3:
    ds_read_b32 v15, v0
    s_waitcnt lgkmcnt(0)
    v_cmp_ge_u32 vcc, s37, v15
    s_cbranch_vccnz L_dn_slow3
    s_branch L_dn_ret3
L_dn_slow4:
    ds_read_b32 v15, v0
    s_waitcnt lgkmcnt(0)
    v_cmp_ge_u32 vcc, s37, v15
    s_cbranch_vccnz L_dn_slow4
    s_branch L_dn_ret4
L_dn_slow25:
    ds_read_b32 v15, v0
    s_waitcnt lgkmcnt(0)
    v_cmp_ge_u32 vcc, s37, v15
    s_cbranch_vccnz L_dn_slow25
    s_branch L_dn_ret25
L_dn_slow26:
    ds_read_b32 v15, v0
    s_waitcnt lgkmcnt(0)
    v_cmp_ge_u32 vcc, s37, v15
    s_cbranch_vccnz L_dn_slow26
    s_branch L_dn_ret26
L_dn_slow27:
    ds_read_b32 v15, v0
    s_waitcnt lgkmcnt(0)
    v_cmp_ge_u32 vcc, s37, v15
    s_cbranch_vccnz L_dn_slow27
    s_branch L_dn_ret27
L_dn_slow28:
    ds_read_b32 v15, v0
    s_waitcnt lgkmcnt(0)
    v_cmp_ge_u32 vcc, s37, v15
    s_cbranch_vccnz L_dn_slow28
    s_branch L_dn_ret28
L_dn_slow29:
    ds_read_b32 v15, v0
    s_waitcnt lgkmcnt(0)
    v_cmp_ge_u32 vcc, s37, v15
    s_cbranch_vccnz L_dn_slow29
    s_branch L_dn_ret29
L_dn_slow30:
    ds_read_b32 v15, v0
    s_waitcnt lgkmcnt(0)
    v_cmp_ge_u32 vcc, s37, v15
    s_cbranch_vccnz L_dn_slow30
    s_branch L_dn_ret30
L_dn_slow31:
    ds_read_b32 v15, v0
    s_waitcnt lgkmcnt(0)
    v_cmp_ge_u32 vcc, s37, v15
    s_cbranch_vccnz L_dn_slow31
    s_branch L_dn_ret31
L_dn_slow32:
    ds_read_b32 v15, v0
    s_waitcnt lgkmcnt(0)
    v_cmp_ge_u32 vcc, s37, v15
    s_cbranch_vccnz L_dn_slow32
    s_branch L_dn_ret32
L_dn_slow33:
    ds_read_b32 v15, v0
    s_waitcnt lgkmcnt(0)
    v_cmp_ge_u32 vcc, s37, v15
    s_cbranch_vccnz L_dn_slow33
    s_branch L_dn_ret33
L_dn_slow34:
    ds_read_b32 v15, v0
    s_waitcnt lgkmcnt(0)
    v_cmp_ge_u32 vcc, s37, v15
    s_cbranch_vccnz L_dn_slow34
    s_branch L_dn_ret34
L_flag:
L_kvw:
    v_add_u32 v1, -32, v0
    ds_read_b32 v1, v1
    s_waitcnt lgkmcnt(0)
    v_cmp_gt_u32 vcc, 64, v1
    s_cbranch_vccz L_kvd
    s_sleep 1
    s_branch L_kvw
L_kvd:
    s_sub_u32 s59, s42, 40960
    s_mov_b32 m0, s59
    s_nop 1
    buffer_load_dwordx4 v4, s[8:11], s33 offen offset:0 lds
    buffer_load_dwordx4 v5, s[8:11], s33 offen offset:1024 lds
    buffer_load_dwordx4 v6, s[8:11], s33 offen offset:2048 lds
    buffer_load_dwordx4 v7, s[8:11], s33 offen offset:3072 lds
    s_add_u32 s33, s33, 262144
    s_sub_u32 s59, s42, 24576
    s_mov_b32 m0, s59
    s_nop 1
    buffer_load_dwordx4 v4, s[8:11], s33 offen offset:0 lds
    buffer_load_dwordx4 v5, s[8:11], s33 offen offset:1024 lds
    buffer_load_dwordx4 v6, s[8:11], s33 offen offset:2048 lds
    buffer_load_dwordx4 v7, s[8:11], s33 offen offset:3072 lds
    s_add_u32 s33, s33, 262144
L_flagl:
    ds_read_b32 v1, v12
    s_waitcnt lgkmcnt(0)
    v_readfirstlane_b32 s59, v1
    s_cmp_lg_u32 s59, 0
    s_cbranch_scc1 L_flagd
    s_sleep 1
    s_branch L_flagl
L_flagd:
    s_branch L_flag_ret
L_dn_tail:
    s_waitcnt vmcnt(30) lgkmcnt(13)
    v_mfma_f32_16x16x32_bf16 v[16:19], v[48:51], v[80:83], v[16:19]
    ds_read_b64_tr_b16 v[78:79], v11 offset:6144
    v_mfma_f32_16x16x32_bf16 v[32:35], v[48:51], v[84:87], v[32:35]
    ds_read_b64_tr_b16 v[48:49], v8 offset:8192
    s_mov_b32 s8, s52
    s_mov_b32 s9, s53
    s_mov_b32 s10, 2097152
    s_mov_b32 s33, s61
    s_mov_b32 m0, s40
    s_add_u32 s40, s40, 16384
    s_waitcnt lgkmcnt(13)
    v_mfma_f32_16x16x32_bf16 v[20:23], v[52:55], v[80:83], v[20:23]
    ds_read_b64_tr_b16 v[50:51], v8 offset:10240
    v_add_u32 v13, 1, v13
    s_add_u32 s37, s37, 1
    buffer_load_dwordx4 v4, s[8:11], s33 offen offset:0 lds
    v_mfma_f32_16x16x32_bf16 v[36:39], v[52:55], v[84:87], v[36:39]
    ds_read_b64_tr_b16 v[52:53], v9 offset:8192
    s_waitcnt vmcnt(21)
    ds_write_b32 v14, v13
    buffer_load_dwordx4 v5, s[8:11], s33 offen offset:1024 lds
    s_cmp_eq_u32 s40, s43
    s_cselect_b32 s40, s42, s40
    s_waitcnt lgkmcnt(14)
    v_mfma_f32_16x16x32_bf16 v[24:27], v[56:59], v[80:83], v[24:27]
    ds_read_b64_tr_b16 v[54:55], v9 offset:10240
    buffer_load_dwordx4 v6, s[8:11], s33 offen offset:2048 lds
    v_mfma_f32_16x16x32_bf16 v[40:43], v[56:59], v[84:87], v[40:43]
    ds_read_b64_tr_b16 v[56:57], v10 offset:8192
    buffer_load_dwordx4 v7, s[8:11], s33 offen offset:3072 lds
    s_add_u32 s33, s33, 262144
    s_waitcnt lgkmcnt(14)
    v_mfma_f32_16x16x32_bf16 v[28:31], v[60:63], v[80:83], v[28:31]
    ds_read_b64_tr_b16 v[58:59], v10 offset:10240
    s_add_u32 s38, s38, 1
    s_cmp_eq_u32 s38, 7
    s_cselect_b32 s39, s47, s46
    s_cselect_b32 s38, 0, s38
    v_mfma_f32_16x16x32_bf16 v[44:47], v[60:63], v[84:87], v[44:47]
    ds_read_b64_tr_b16 v[60:61], v11 offset:8192
    s_waitcnt lgkmcnt(14)
    v_mfma_f32_16x16x32_bf16 v[16:19], v[64:67], v[88:91], v[16:19]
    ds_read_b64_tr_b16 v[62:63], v11 offset:10240
    v_mfma_f32_16x16x32_bf16 v[32:35], v[64:67], v[92:95], v[32:35]
    ds_read_b64_tr_b16 v[64:65], v8 offset:12288
    s_mov_b32 m0, s40
    s_add_u32 s40, s40, 16384
    s_waitcnt lgkmcnt(14)
    v_mfma_f32_16x16x32_bf16 v[20:23], v[68:71], v[88:91], v[20:23]
    ds_read_b64_tr_b16 v[66:67], v8 offset:14336
    v_add_u32 v8, s39, v8
    buffer_load_dwordx4 v4, s[8:11], s33 offen offset:0 lds
    v_mfma_f32_16x16x32_bf16 v[36:39], v[68:71], v[92:95], v[36:39]
    ds_read_b64_tr_b16 v[68:69], v9 offset:12288
    ds_read_b32 v15, v0
    buffer_load_dwordx4 v5, s[8:11], s33 offen offset:1024 lds
    s_cmp_eq_u32 s40, s43
    s_cselect_b32 s40, s42, s40
    s_waitcnt lgkmcnt(15)
    v_mfma_f32_16x16x32_bf16 v[24:27], v[72:75], v[88:91], v[24:27]
    ds_read_b64_tr_b16 v[70:71], v9 offset:14336
    v_add_u32 v9, s39, v9
    buffer_load_dwordx4 v6, s[8:11], s33 offen offset:2048 lds
    v_mfma_f32_16x16x32_bf16 v[40:43], v[72:75], v[92:95], v[40:43]
    ds_read_b64_tr_b16 v[72:73], v10 offset:12288
    buffer_load_dwordx4 v7, s[8:11], s33 offen offset:3072 lds
    s_add_u32 s33, s33, 262144
    s_waitcnt lgkmcnt(15)
    v_mfma_f32_16x16x32_bf16 v[28:31], v[76:79], v[88:91], v[28:31]
    ds_read_b64_tr_b16 v[74:75], v10 offset:14336
    v_add_u32 v10, s39, v10
    v_mfma_f32_16x16x32_bf16 v[44:47], v[76:79], v[92:95], v[44:47]
    ds_read_b64_tr_b16 v[76:77], v11 offset:12288
    s_waitcnt lgkmcnt(15)
    v_mfma_f32_16x16x32_bf16 v[16:19], v[48:51], v[96:99], v[16:19]
    ds_read_b64_tr_b16 v[78:79], v11 offset:14336
    v_add_u32 v11, s39, v11
    v_mfma_f32_16x16x32_bf16 v[32:35], v[48:51], v[100:103], v[32:35]
    s_waitcnt lgkmcnt(5)
    v_cmp_ge_u32 vcc, s37, v15
    s_cbranch_vccnz L_dn_slow25
L_dn_ret25:
    ds_read_b64_tr_b16 v[48:49], v8 offset:0
    s_mov_b32 m0, s40
    s_add_u32 s40, s40, 16384
    v_mfma_f32_16x16x32_bf16 v[20:23], v[52:55], v[96:99], v[20:23]
    ds_read_b64_tr_b16 v[50:51], v8 offset:2048
    buffer_load_dwordx4 v4, s[8:11], s33 offen offset:0 lds
    v_mfma_f32_16x16x32_bf16 v[36:39], v[52:55], v[100:103], v[36:39]
    ds_read_b64_tr_b16 v[52:53], v9 offset:0
    buffer_load_dwordx4 v5, s[8:11], s33 offen offset:1024 lds
    s_cmp_eq_u32 s40, s43
    s_cselect_b32 s40, s42, s40
    v_mfma_f32_16x16x32_bf16 v[24:27], v[56:59], v[96:99], v[24:27]
    ds_read_b64_tr_b16 v[54:55], v9 offset:2048
    buffer_load_dwordx4 v6, s[8:11], s33 offen offset:2048 lds
    v_mfma_f32_16x16x32_bf16 v[40:43], v[56:59], v[100:103], v[40:43]
    ds_read_b64_tr_b16 v[56:57], v10 offset:0
    buffer_load_dwordx4 v7, s[8:11], s33 offen offset:3072 lds
    s_add_u32 s33, s33, 262144
    v_mfma_f32_16x16x32_bf16 v[28:31], v[60:63], v[96:99], v[28:31]
    ds_read_b64_tr_b16 v[58:59], v10 offset:2048
    v_mfma_f32_16x16x32_bf16 v[44:47], v[60:63], v[100:103], v[44:47]
    ds_read_b64_tr_b16 v[60:61], v11 offset:0
    v_mfma_f32_16x16x32_bf16 v[16:19], v[64:67], v[104:107], v[16:19]
    ds_read_b64_tr_b16 v[62:63], v11 offset:2048
    v_mfma_f32_16x16x32_bf16 v[32:35], v[64:67], v[108:111], v[32:35]
    ds_read_b64_tr_b16 v[64:65], v8 offset:4096
    s_mov_b32 m0, s40
    s_add_u32 s40, s40, 16384
    s_waitcnt lgkmcnt(13)
    v_mfma_f32_16x16x32_bf16 v[20:23], v[68:71], v[104:107], v[20:23]
    ds_read_b64_tr_b16 v[66:67], v8 offset:6144
    buffer_load_dwordx4 v4, s[8:11], s33 offen offset:0 lds
    v_mfma_f32_16x16x32_bf16 v[36:39], v[68:71], v[108:111], v[36:39]
    ds_read_b64_tr_b16 v[68:69], v9 offset:4096
    buffer_load_dwordx4 v5, s[8:11], s33 offen offset:1024 lds
    s_cmp_eq_u32 s40, s43
    s_cselect_b32 s40, s42, s40
    s_waitcnt lgkmcnt(13)
    v_mfma_f32_16x16x32_bf16 v[24:27], v[72:75], v[104:107], v[24:27]
    ds_read_b64_tr_b16 v[70:71], v9 offset:6144
    buffer_load_dwordx4 v6, s[8:11], s33 offen offset:2048 lds
    v_mfma_f32_16x16x32_bf16 v[40:43], v[72:75], v[108:111], v[40:43]
    ds_read_b64_tr_b16 v[72:73], v10 offset:4096
    buffer_load_dwordx4 v7, s[8:11], s33 offen offset:3072 lds
    s_add_u32 s33, s33, 262144
    s_waitcnt lgkmcnt(13)
    v_mfma_f32_16x16x32_bf16 v[28:31], v[76:79], v[104:107], v[28:31]
    ds_read_b64_tr_b16 v[74:75], v10 offset:6144
    v_mfma_f32_16x16x32_bf16 v[44:47], v[76:79], v[108:111], v[44:47]
    ds_read_b64_tr_b16 v[76:77], v11 offset:4096
    s_waitcnt vmcnt(34) lgkmcnt(13)
    v_mfma_f32_16x16x32_bf16 v[16:19], v[48:51], v[112:115], v[16:19]
    ds_read_b64_tr_b16 v[78:79], v11 offset:6144
    v_mfma_f32_16x16x32_bf16 v[32:35], v[48:51], v[116:119], v[32:35]
    ds_read_b64_tr_b16 v[48:49], v8 offset:8192
    s_waitcnt lgkmcnt(13)
    v_mfma_f32_16x16x32_bf16 v[20:23], v[52:55], v[112:115], v[20:23]
    ds_read_b64_tr_b16 v[50:51], v8 offset:10240
    v_add_u32 v13, 1, v13
    s_add_u32 s37, s37, 1
    v_mfma_f32_16x16x32_bf16 v[36:39], v[52:55], v[116:119], v[36:39]
    ds_read_b64_tr_b16 v[52:53], v9 offset:8192
    s_waitcnt vmcnt(24)
    ds_write_b32 v14, v13
    s_waitcnt lgkmcnt(14)
    v_mfma_f32_16x16x32_bf16 v[24:27], v[56:59], v[112:115], v[24:27]
    ds_read_b64_tr_b16 v[54:55], v9 offset:10240
    v_mfma_f32_16x16x32_bf16 v[40:43], v[56:59], v[116:119], v[40:43]
    ds_read_b64_tr_b16 v[56:57], v10 offset:8192
    s_waitcnt lgkmcnt(14)
    v_mfma_f32_16x16x32_bf16 v[28:31], v[60:63], v[112:115], v[28:31]
    ds_read_b64_tr_b16 v[58:59], v10 offset:10240
    s_add_u32 s38, s38, 1
    s_cmp_eq_u32 s38, 7
    s_cselect_b32 s39, s47, s46
    s_cselect_b32 s38, 0, s38
    v_mfma_f32_16x16x32_bf16 v[44:47], v[60:63], v[116:119], v[44:47]
    ds_read_b64_tr_b16 v[60:61], v11 offset:8192
    s_waitcnt lgkmcnt(14)
    v_mfma_f32_16x16x32_bf16 v[16:19], v[64:67], v[120:123], v[16:19]
    ds_read_b64_tr_b16 v[62:63], v11 offset:10240
    v_mfma_f32_16x16x32_bf16 v[32:35], v[64:67], v[124:127], v[32:35]
    ds_read_b64_tr_b16 v[64:65], v8 offset:12288
    s_waitcnt lgkmcnt(14)
    v_mfma_f32_16x16x32_bf16 v[20:23], v[68:71], v[120:123], v[20:23]
    ds_read_b64_tr_b16 v[66:67], v8 offset:14336
    v_add_u32 v8, s39, v8
    v_mfma_f32_16x16x32_bf16 v[36:39], v[68:71], v[124:127], v[36:39]
    ds_read_b64_tr_b16 v[68:69], v9 offset:12288
    ds_read_b32 v15, v0
    s_waitcnt lgkmcnt(15)
    v_mfma_f32_16x16x32_bf16 v[24:27], v[72:75], v[120:123], v[24:27]
    ds_read_b64_tr_b16 v[70:71], v9 offset:14336
    v_add_u32 v9, s39, v9
    v_mfma_f32_16x16x32_bf16 v[40:43], v[72:75], v[124:127], v[40:43]
    ds_read_b64_tr_b16 v[72:73], v10 offset:12288
    s_waitcnt lgkmcnt(15)
    v_mfma_f32_16x16x32_bf16 v[28:31], v[76:79], v[120:123], v[28:31]
    ds_read_b64_tr_b16 v[74:75], v10 offset:14336
    v_add_u32 v10, s39, v10
    v_mfma_f32_16x16x32_bf16 v[44:47], v[76:79], v[124:127], v[44:47]
    ds_read_b64_tr_b16 v[76:77], v11 offset:12288
    s_waitcnt lgkmcnt(15)
    v_mfma_f32_16x16x32_bf16 v[16:19], v[48:51], v[128:131], v[16:19]
    ds_read_b64_tr_b16 v[78:79], v11 offset:14336
    v_add_u32 v11, s39, v11
    v_mfma_f32_16x16x32_bf16 v[32:35], v[48:51], v[132:135], v[32:35]
    s_waitcnt lgkmcnt(5)
    v_cmp_ge_u32 vcc, s37, v15
    s_cbranch_vccnz L_dn_slow26
L_dn_ret26:
    ds_read_b64_tr_b16 v[48:49], v8 offset:0
    v_mfma_f32_16x16x32_bf16 v[20:23], v[52:55], v[128:131], v[20:23]
    ds_read_b64_tr_b16 v[50:51], v8 offset:2048
    v_mfma_f32_16x16x32_bf16 v[36:39], v[52:55], v[132:135], v[36:39]
    ds_read_b64_tr_b16 v[52:53], v9 offset:0
    v_mfma_f32_16x16x32_bf16 v[24:27], v[56:59], v[128:131], v[24:27]
    ds_read_b64_tr_b16 v[54:55], v9 offset:2048
    v_mfma_f32_16x16x32_bf16 v[40:43], v[56:59], v[132:135], v[40:43]
    ds_read_b64_tr_b16 v[56:57], v10 offset:0
    v_mfma_f32_16x16x32_bf16 v[28:31], v[60:63], v[128:131], v[28:31]
    ds_read_b64_tr_b16 v[58:59], v10 offset:2048
    v_mfma_f32_16x16x32_bf16 v[44:47], v[60:63], v[132:135], v[44:47]
    ds_read_b64_tr_b16 v[60:61], v11 offset:0
    v_mfma_f32_16x16x32_bf16 v[16:19], v[64:67], v[136:139], v[16:19]
    ds_read_b64_tr_b16 v[62:63], v11 offset:2048
    v_mfma_f32_16x16x32_bf16 v[32:35], v[64:67], v[140:143], v[32:35]
    ds_read_b64_tr_b16 v[64:65], v8 offset:4096
    s_mov_b32 m0, s40
    s_add_u32 s40, s40, 16384
    s_waitcnt lgkmcnt(13)
    v_mfma_f32_16x16x32_bf16 v[20:23], v[68:71], v[136:139], v[20:23]
    ds_read_b64_tr_b16 v[66:67], v8 offset:6144
    buffer_load_dwordx4 v4, s[8:11], s33 offen offset:0 lds
    v_mfma_f32_16x16x32_bf16 v[36:39], v[68:71], v[140:143], v[36:39]
    ds_read_b64_tr_b16 v[68:69], v9 offset:4096
    buffer_load_dwordx4 v5, s[8:11], s33 offen offset:1024 lds
    s_cmp_eq_u32 s40, s43
    s_cselect_b32 s40, s42, s40
    s_waitcnt lgkmcnt(13)
    v_mfma_f32_16x16x32_bf16 v[24:27], v[72:75], v[136:139], v[24:27]
    ds_read_b64_tr_b16 v[70:71], v9 offset:6144
    buffer_load_dwordx4 v6, s[8:11], s33 offen offset:2048 lds
    v_mfma_f32_16x16x32_bf16 v[40:43], v[72:75], v[140:143], v[40:43]
    ds_read_b64_tr_b16 v[72:73], v10 offset:4096
    buffer_load_dwordx4 v7, s[8:11], s33 offen offset:3072 lds
    s_add_u32 s33, s33, 262144
    s_waitcnt lgkmcnt(13)
    v_mfma_f32_16x16x32_bf16 v[28:31], v[76:79], v[136:139], v[28:31]
    ds_read_b64_tr_b16 v[74:75], v10 offset:6144
    v_mfma_f32_16x16x32_bf16 v[44:47], v[76:79], v[140:143], v[44:47]
    ds_read_b64_tr_b16 v[76:77], v11 offset:4096
    s_waitcnt vmcnt(26) lgkmcnt(13)
    v_mfma_f32_16x16x32_bf16 v[16:19], v[48:51], v[144:147], v[16:19]
    s_branch L_flag
L_flag_ret:
    ds_read_b64_tr_b16 v[78:79], v11 offset:6144
    buffer_load_dwordx4 v[176:179], v2, s[24:27], s34 offen offset:0
    v_mfma_f32_16x16x32_bf16 v[32:35], v[48:51], v[148:151], v[32:35]
    ds_read_b64_tr_b16 v[48:49], v8 offset:8192
    buffer_load_dwordx4 v[180:183], v2, s[24:27], s34 offen offset:1024
    s_add_u32 s34, s34, 8192
    s_waitcnt lgkmcnt(13)
    v_mfma_f32_16x16x32_bf16 v[20:23], v[52:55], v[144:147], v[20:23]
    ds_read_b64_tr_b16 v[50:51], v8 offset:10240
    v_add_u32 v13, 1, v13
    s_add_u32 s37, s37, 1
    buffer_load_dwordx4 v[184:187], v2, s[24:27], s34 offen offset:0
    v_mfma_f32_16x16x32_bf16 v[36:39], v[52:55], v[148:151], v[36:39]
    ds_read_b64_tr_b16 v[52:53], v9 offset:8192
    s_waitcnt vmcnt(27)
    ds_write_b32 v14, v13
    buffer_load_dwordx4 v[188:191], v2, s[24:27], s34 offen offset:1024
    s_add_u32 s34, s34, 8192
    s_waitcnt lgkmcnt(14)
    v_mfma_f32_16x16x32_bf16 v[24:27], v[56:59], v[144:147], v[24:27]
    ds_read_b64_tr_b16 v[54:55], v9 offset:10240
    buffer_load_dwordx4 v[192:195], v2, s[24:27], s34 offen offset:0
    v_mfma_f32_16x16x32_bf16 v[40:43], v[56:59], v[148:151], v[40:43]
    ds_read_b64_tr_b16 v[56:57], v10 offset:8192
    buffer_load_dwordx4 v[196:199], v2, s[24:27], s34 offen offset:1024
    s_add_u32 s34, s34, 8192
    s_waitcnt lgkmcnt(14)
    v_mfma_f32_16x16x32_bf16 v[28:31], v[60:63], v[144:147], v[28:31]
    ds_read_b64_tr_b16 v[58:59], v10 offset:10240
    s_add_u32 s38, s38, 1
    s_cmp_eq_u32 s38, 7
    s_cselect_b32 s39, s47, s46
    s_cselect_b32 s38, 0, s38
    buffer_load_dwordx4 v[200:203], v2, s[24:27], s34 offen offset:0
    v_mfma_f32_16x16x32_bf16 v[44:47], v[60:63], v[148:151], v[44:47]
    ds_read_b64_tr_b16 v[60:61], v11 offset:8192
    buffer_load_dwordx4 v[204:207], v2, s[24:27], s34 offen offset:1024
    s_add_u32 s34, s34, 8192
    s_waitcnt lgkmcnt(14)
    v_mfma_f32_16x16x32_bf16 v[16:19], v[64:67], v[152:155], v[16:19]
    ds_read_b64_tr_b16 v[62:63], v11 offset:10240
    buffer_load_dwordx4 v[208:211], v2, s[24:27], s34 offen offset:0
    v_mfma_f32_16x16x32_bf16 v[32:35], v[64:67], v[156:159], v[32:35]
    ds_read_b64_tr_b16 v[64:65], v8 offset:12288
    buffer_load_dwordx4 v[212:215], v2, s[24:27], s34 offen offset:1024
    s_add_u32 s34, s34, 8192
    s_waitcnt lgkmcnt(14)
    v_mfma_f32_16x16x32_bf16 v[20:23], v[68:71], v[152:155], v[20:23]
    ds_read_b64_tr_b16 v[66:67], v8 offset:14336
    v_add_u32 v8, s39, v8
    buffer_load_dwordx4 v[216:219], v2, s[24:27], s34 offen offset:0
    v_mfma_f32_16x16x32_bf16 v[36:39], v[68:71], v[156:159], v[36:39]
    ds_read_b64_tr_b16 v[68:69], v9 offset:12288
    ds_read_b32 v15, v0
    buffer_load_dwordx4 v[220:223], v2, s[24:27], s34 offen offset:1024
    s_add_u32 s34, s34, 8192
    s_waitcnt lgkmcnt(15)
    v_mfma_f32_16x16x32_bf16 v[24:27], v[72:75], v[152:155], v[24:27]
    ds_read_b64_tr_b16 v[70:71], v9 offset:14336
    v_add_u32 v9, s39, v9
    v_mfma_f32_16x16x32_bf16 v[40:43], v[72:75], v[156:159], v[40:43]
    ds_read_b64_tr_b16 v[72:73], v10 offset:12288
    s_waitcnt lgkmcnt(15)
    v_mfma_f32_16x16x32_bf16 v[28:31], v[76:79], v[152:155], v[28:31]
    ds_read_b64_tr_b16 v[74:75], v10 offset:14336
    v_add_u32 v10, s39, v10
    v_mfma_f32_16x16x32_bf16 v[44:47], v[76:79], v[156:159], v[44:47]
    ds_read_b64_tr_b16 v[76:77], v11 offset:12288
    s_waitcnt lgkmcnt(15)
    v_mfma_f32_16x16x32_bf16 v[16:19], v[48:51], v[160:163], v[16:19]
    ds_read_b64_tr_b16 v[78:79], v11 offset:14336
    v_add_u32 v11, s39, v11
    v_mfma_f32_16x16x32_bf16 v[32:35], v[48:51], v[164:167], v[32:35]
    s_waitcnt lgkmcnt(5)
    v_cmp_ge_u32 vcc, s37, v15
    s_cbranch_vccnz L_dn_slow27
L_dn_ret27:
    ds_read_b64_tr_b16 v[48:49], v8 offset:0
    v_mfma_f32_16x16x32_bf16 v[20:23], v[52:55], v[160:163], v[20:23]
    ds_read_b64_tr_b16 v[50:51], v8 offset:2048
    v_mfma_f32_16x16x32_bf16 v[36:39], v[52:55], v[164:167], v[36:39]
    ds_read_b64_tr_b16 v[52:53], v9 offset:0
    v_mfma_f32_16x16x32_bf16 v[24:27], v[56:59], v[160:163], v[24:27]
    ds_read_b64_tr_b16 v[54:55], v9 offset:2048
    v_mfma_f32_16x16x32_bf16 v[40:43], v[56:59], v[164:167], v[40:43]
    ds_read_b64_tr_b16 v[56:57], v10 offset:0
    v_mfma_f32_16x16x32_bf16 v[28:31], v[60:63], v[160:163], v[28:31]
    ds_read_b64_tr_b16 v[58:59], v10 offset:2048
    v_mfma_f32_16x16x32_bf16 v[44:47], v[60:63], v[164:167], v[44:47]
    ds_read_b64_tr_b16 v[60:61], v11 offset:0
    v_mfma_f32_16x16x32_bf16 v[16:19], v[64:67], v[168:171], v[16:19]
    ds_read_b64_tr_b16 v[62:63], v11 offset:2048
    v_mfma_f32_16x16x32_bf16 v[32:35], v[64:67], v[172:175], v[32:35]
    ds_read_b64_tr_b16 v[64:65], v8 offset:4096
    s_mov_b32 m0, s40
    s_add_u32 s40, s40, 16384
    s_waitcnt lgkmcnt(13)
    v_mfma_f32_16x16x32_bf16 v[20:23], v[68:71], v[168:171], v[20:23]
    ds_read_b64_tr_b16 v[66:67], v8 offset:6144
    buffer_load_dwordx4 v4, s[8:11], s33 offen offset:0 lds
    v_mfma_f32_16x16x32_bf16 v[36:39], v[68:71], v[172:175], v[36:39]
    ds_read_b64_tr_b16 v[68:69], v9 offset:4096
    buffer_load_dwordx4 v5, s[8:11], s33 offen offset:1024 lds
    s_cmp_eq_u32 s40, s43
    s_cselect_b32 s40, s42, s40
    s_waitcnt lgkmcnt(13)
    v_mfma_f32_16x16x32_bf16 v[24:27], v[72:75], v[168:171], v[24:27]
    ds_read_b64_tr_b16 v[70:71], v9 offset:6144
    buffer_load_dwordx4 v6, s[8:11], s33 offen offset:2048 lds
    v_mfma_f32_16x16x32_bf16 v[40:43], v[72:75], v[172:175], v[40:43]
    ds_read_b64_tr_b16 v[72:73], v10 offset:4096
    buffer_load_dwordx4 v7, s[8:11], s33 offen offset:3072 lds
    s_add_u32 s33, s33, 262144
    s_waitcnt lgkmcnt(13)
    v_mfma_f32_16x16x32_bf16 v[28:31], v[76:79], v[168:171], v[28:31]
    ds_read_b64_tr_b16 v[74:75], v10 offset:6144
    v_mfma_f32_16x16x32_bf16 v[44:47], v[76:79], v[172:175], v[44:47]
    ds_read_b64_tr_b16 v[76:77], v11 offset:4096
    s_waitcnt vmcnt(14) lgkmcnt(13)
    v_mfma_f32_16x16x32_bf16 v[16:19], v[48:51], v[176:179], v[16:19]
    ds_read_b64_tr_b16 v[78:79], v11 offset:6144
    v_mfma_f32_16x16x32_bf16 v[32:35], v[48:51], v[180:183], v[32:35]
    ds_read_b64_tr_b16 v[48:49], v8 offset:8192
    s_waitcnt lgkmcnt(13)
    v_mfma_f32_16x16x32_bf16 v[20:23], v[52:55], v[176:179], v[20:23]
    ds_read_b64_tr_b16 v[50:51], v8 offset:10240
    v_add_u32 v13, 1, v13
    s_add_u32 s37, s37, 1
    v_mfma_f32_16x16x32_bf16 v[36:39], v[52:55], v[180:183], v[36:39]
    ds_read_b64_tr_b16 v[52:53], v9 offset:8192
    ds_write_b32 v14, v13
    s_waitcnt lgkmcnt(14)
    v_mfma_f32_16x16x32_bf16 v[24:27], v[56:59], v[176:179], v[24:27]
    ds_read_b64_tr_b16 v[54:55], v9 offset:10240
    v_mfma_f32_16x16x32_bf16 v[40:43], v[56:59], v[180:183], v[40:43]
    ds_read_b64_tr_b16 v[56:57], v10 offset:8192
    s_waitcnt lgkmcnt(14)
    v_mfma_f32_16x16x32_bf16 v[28:31], v[60:63], v[176:179], v[28:31]
    ds_read_b64_tr_b16 v[58:59], v10 offset:10240
    s_add_u32 s38, s38, 1
    s_cmp_eq_u32 s38, 7
    s_cselect_b32 s39, s47, s46
    s_cselect_b32 s38, 0, s38
    buffer_load_dwordx4 v[224:227], v2, s[24:27], s34 offen offset:0
    v_mfma_f32_16x16x32_bf16 v[44:47], v[60:63], v[180:183], v[44:47]
    ds_read_b64_tr_b16 v[60:61], v11 offset:8192
    buffer_load_dwordx4 v[228:231], v2, s[24:27], s34 offen offset:1024
    s_add_u32 s34, s34, 8192
    s_waitcnt vmcnt(14) lgkmcnt(14)
    v_mfma_f32_16x16x32_bf16 v[16:19], v[64:67], v[184:187], v[16:19]
    ds_read_b64_tr_b16 v[62:63], v11 offset:10240
    v_mfma_f32_16x16x32_bf16 v[32:35], v[64:67], v[188:191], v[32:35]
    ds_read_b64_tr_b16 v[64:65], v8 offset:12288
    s_waitcnt lgkmcnt(14)
    v_mfma_f32_16x16x32_bf16 v[20:23], v[68:71], v[184:187], v[20:23]
    ds_read_b64_tr_b16 v[66:67], v8 offset:14336
    v_add_u32 v8, s39, v8
    v_mfma_f32_16x16x32_bf16 v[36:39], v[68:71], v[188:191], v[36:39]
    ds_read_b64_tr_b16 v[68:69], v9 offset:12288
    ds_read_b32 v15, v0
    s_waitcnt lgkmcnt(15)
    v_mfma_f32_16x16x32_bf16 v[24:27], v[72:75], v[184:187], v[24:27]
    ds_read_b64_tr_b16 v[70:71], v9 offset:14336
    v_add_u32 v9, s39, v9
    v_mfma_f32_16x16x32_bf16 v[40:43], v[72:75], v[188:191], v[40:43]
    ds_read_b64_tr_b16 v[72:73], v10 offset:12288
    s_waitcnt lgkmcnt(15)
    v_mfma_f32_16x16x32_bf16 v[28:31], v[76:79], v[184:187], v[28:31]
    ds_read_b64_tr_b16 v[74:75], v10 offset:14336
    v_add_u32 v10, s39, v10
    buffer_load_dwordx4 v[232:235], v2, s[24:27], s34 offen offset:0
    v_mfma_f32_16x16x32_bf16 v[44:47], v[76:79], v[188:191], v[44:47]
    ds_read_b64_tr_b16 v[76:77], v11 offset:12288
    buffer_load_dwordx4 v[236:239], v2, s[24:27], s34 offen offset:1024
    s_add_u32 s34, s34, 8192
    s_waitcnt vmcnt(14) lgkmcnt(15)
    v_mfma_f32_16x16x32_bf16 v[16:19], v[48:51], v[192:195], v[16:19]
    ds_read_b64_tr_b16 v[78:79], v11 offset:14336
    v_add_u32 v11, s39, v11
    v_mfma_f32_16x16x32_bf16 v[32:35], v[48:51], v[196:199], v[32:35]
    s_waitcnt lgkmcnt(5)
    v_cmp_ge_u32 vcc, s37, v15
    s_cbranch_vccnz L_dn_slow28
L_dn_ret28:
    ds_read_b64_tr_b16 v[48:49], v8 offset:0
    v_mfma_f32_16x16x32_bf16 v[20:23], v[52:55], v[192:195], v[20:23]
    ds_read_b64_tr_b16 v[50:51], v8 offset:2048
    v_mfma_f32_16x16x32_bf16 v[36:39], v[52:55], v[196:199], v[36:39]
    ds_read_b64_tr_b16 v[52:53], v9 offset:0
    v_mfma_f32_16x16x32_bf16 v[24:27], v[56:59], v[192:195], v[24:27]
    ds_read_b64_tr_b16 v[54:55], v9 offset:2048
    v_mfma_f32_16x16x32_bf16 v[40:43], v[56:59], v[196:199], v[40:43]
    ds_read_b64_tr_b16 v[56:57], v10 offset:0
    v_mfma_f32_16x16x32_bf16 v[28:31], v[60:63], v[192:195], v[28:31]
    ds_read_b64_tr_b16 v[58:59], v10 offset:2048
    buffer_load_dwordx4 v[80:83], v2, s[24:27], s34 offen offset:0
    v_mfma_f32_16x16x32_bf16 v[44:47], v[60:63], v[196:199], v[44:47]
    ds_read_b64_tr_b16 v[60:61], v11 offset:0
    buffer_load_dwordx4 v[84:87], v2, s[24:27], s34 offen offset:1024
    s_add_u32 s34, s34, 8192
    s_waitcnt vmcnt(14)
    v_mfma_f32_16x16x32_bf16 v[16:19], v[64:67], v[200:203], v[16:19]
    ds_read_b64_tr_b16 v[62:63], v11 offset:2048
    v_mfma_f32_16x16x32_bf16 v[32:35], v[64:67], v[204:207], v[32:35]
    ds_read_b64_tr_b16 v[64:65], v8 offset:4096
    s_waitcnt lgkmcnt(13)
    v_mfma_f32_16x16x32_bf16 v[20:23], v[68:71], v[200:203], v[20:23]
    ds_read_b64_tr_b16 v[66:67], v8 offset:6144
    v_mfma_f32_16x16x32_bf16 v[36:39], v[68:71], v[204:207], v[36:39]
    ds_read_b64_tr_b16 v[68:69], v9 offset:4096
    s_waitcnt lgkmcnt(13)
    v_mfma_f32_16x16x32_bf16 v[24:27], v[72:75], v[200:203], v[24:27]
    ds_read_b64_tr_b16 v[70:71], v9 offset:6144
    v_mfma_f32_16x16x32_bf16 v[40:43], v[72:75], v[204:207], v[40:43]
    ds_read_b64_tr_b16 v[72:73], v10 offset:4096
    s_waitcnt lgkmcnt(13)
    v_mfma_f32_16x16x32_bf16 v[28:31], v[76:79], v[200:203], v[28:31]
    ds_read_b64_tr_b16 v[74:75], v10 offset:6144
    buffer_load_dwordx4 v[88:91], v2, s[24:27], s34 offen offset:0
    v_mfma_f32_16x16x32_bf16 v[44:47], v[76:79], v[204:207], v[44:47]
    ds_read_b64_tr_b16 v[76:77], v11 offset:4096
    buffer_load_dwordx4 v[92:95], v2, s[24:27], s34 offen offset:1024
    s_add_u32 s34, s34, 8192
    s_waitcnt vmcnt(14) lgkmcnt(13)
    v_mfma_f32_16x16x32_bf16 v[16:19], v[48:51], v[208:211], v[16:19]
    ds_read_b64_tr_b16 v[78:79], v11 offset:6144
    v_mfma_f32_16x16x32_bf16 v[32:35], v[48:51], v[212:215], v[32:35]
    ds_read_b64_tr_b16 v[48:49], v8 offset:8192
    s_waitcnt lgkmcnt(13)
    v_mfma_f32_16x16x32_bf16 v[20:23], v[52:55], v[208:211], v[20:23]
    ds_read_b64_tr_b16 v[50:51], v8 offset:10240
    v_add_u32 v13, 1, v13
    s_add_u32 s37, s37, 1
    v_mfma_f32_16x16x32_bf16 v[36:39], v[52:55], v[212:215], v[36:39]
    ds_read_b64_tr_b16 v[52:53], v9 offset:8192
    ds_write_b32 v14, v13
    s_waitcnt lgkmcnt(14)
    v_mfma_f32_16x16x32_bf16 v[24:27], v[56:59], v[208:211], v[24:27]
    ds_read_b64_tr_b16 v[54:55], v9 offset:10240
    v_mfma_f32_16x16x32_bf16 v[40:43], v[56:59], v[212:215], v[40:43]
    ds_read_b64_tr_b16 v[56:57], v10 offset:8192
    s_waitcnt lgkmcnt(14)
    v_mfma_f32_16x16x32_bf16 v[28:31], v[60:63], v[208:211], v[28:31]
    ds_read_b64_tr_b16 v[58:59], v10 offset:10240
    s_add_u32 s38, s38, 1
    s_cmp_eq_u32 s38, 7
    s_cselect_b32 s39, s47, s46
    s_cselect_b32 s38, 0, s38
    buffer_load_dwordx4 v[96:99], v2, s[24:27], s34 offen offset:0
    v_mfma_f32_16x16x32_bf16 v[44:47], v[60:63], v[212:215], v[44:47]
    ds_read_b64_tr_b16 v[60:61], v11 offset:8192
    buffer_load_dwordx4 v[100:103], v2, s[24:27], s34 offen offset:1024
    s_add_u32 s34, s34, 8192
    s_waitcnt vmcnt(14) lgkmcnt(14)
    v_mfma_f32_16x16x32_bf16 v[16:19], v[64:67], v[216:219], v[16:19]
    ds_read_b64_tr_b16 v[62:63], v11 offset:10240
    v_mfma_f32_16x16x32_bf16 v[32:35], v[64:67], v[220:223], v[32:35]
    ds_read_b64_tr_b16 v[64:65], v8 offset:12288
    s_waitcnt lgkmcnt(14)
    v_mfma_f32_16x16x32_bf16 v[20:23], v[68:71], v[216:219], v[20:23]
    ds_read_b64_tr_b16 v[66:67], v8 offset:14336
    v_add_u32 v8, s39, v8
    v_mfma_f32_16x16x32_bf16 v[36:39], v[68:71], v[220:223], v[36:39]
    ds_read_b64_tr_b16 v[68:69], v9 offset:12288
    ds_read_b32 v15, v0
    s_waitcnt lgkmcnt(15)
    v_mfma_f32_16x16x32_bf16 v[24:27], v[72:75], v[216:219], v[24:27]
    ds_read_b64_tr_b16 v[70:71], v9 offset:14336
    v_add_u32 v9, s39, v9
    v_mfma_f32_16x16x32_bf16 v[40:43], v[72:75], v[220:223], v[40:43]
    ds_read_b64_tr_b16 v[72:73], v10 offset:12288
    s_waitcnt lgkmcnt(15)
    v_mfma_f32_16x16x32_bf16 v[28:31], v[76:79], v[216:219], v[28:31]
    ds_read_b64_tr_b16 v[74:75], v10 offset:14336
    v_add_u32 v10, s39, v10
    buffer_load_dwordx4 v[104:107], v2, s[24:27], s34 offen offset:0
    v_mfma_f32_16x16x32_bf16 v[44:47], v[76:79], v[220:223], v[44:47]
    ds_read_b64_tr_b16 v[76:77], v11 offset:12288
    buffer_load_dwordx4 v[108:111], v2, s[24:27], s34 offen offset:1024
    s_add_u32 s34, s34, 8192
    s_waitcnt vmcnt(10) lgkmcnt(15)
    v_mfma_f32_16x16x32_bf16 v[16:19], v[48:51], v[224:227], v[16:19]
    ds_read_b64_tr_b16 v[78:79], v11 offset:14336
    v_add_u32 v11, s39, v11
    v_mfma_f32_16x16x32_bf16 v[32:35], v[48:51], v[228:231], v[32:35]
    s_waitcnt lgkmcnt(5)
    v_cmp_ge_u32 vcc, s37, v15
    s_cbranch_vccnz L_dn_slow29
L_dn_ret29:
    ds_read_b64_tr_b16 v[48:49], v8 offset:0
    v_mfma_f32_16x16x32_bf16 v[20:23], v[52:55], v[224:227], v[20:23]
    ds_read_b64_tr_b16 v[50:51], v8 offset:2048
    v_mfma_f32_16x16x32_bf16 v[36:39], v[52:55], v[228:231], v[36:39]
    ds_read_b64_tr_b16 v[52:53], v9 offset:0
    v_mfma_f32_16x16x32_bf16 v[24:27], v[56:59], v[224:227], v[24:27]
    ds_read_b64_tr_b16 v[54:55], v9 offset:2048
    v_mfma_f32_16x16x32_bf16 v[40:43], v[56:59], v[228:231], v[40:43]
    ds_read_b64_tr_b16 v[56:57], v10 offset:0
    v_mfma_f32_16x16x32_bf16 v[28:31], v[60:63], v[224:227], v[28:31]
    ds_read_b64_tr_b16 v[58:59], v10 offset:2048
    buffer_load_dwordx4 v[112:115], v2, s[24:27], s34 offen offset:0
    v_mfma_f32_16x16x32_bf16 v[44:47], v[60:63], v[228:231], v[44:47]
    ds_read_b64_tr_b16 v[60:61], v11 offset:0
    buffer_load_dwordx4 v[116:119], v2, s[24:27], s34 offen offset:1024
    s_add_u32 s34, s34, 8192
    s_waitcnt vmcnt(10)
    v_mfma_f32_16x16x32_bf16 v[16:19], v[64:67], v[232:235], v[16:19]
    ds_read_b64_tr_b16 v[62:63], v11 offset:2048
    v_mfma_f32_16x16x32_bf16 v[32:35], v[64:67], v[236:239], v[32:35]
    ds_read_b64_tr_b16 v[64:65], v8 offset:4096
    s_waitcnt lgkmcnt(13)
    v_mfma_f32_16x16x32_bf16 v[20:23], v[68:71], v[232:235], v[20:23]
    ds_read_b64_tr_b16 v[66:67], v8 offset:6144
    v_mfma_f32_16x16x32_bf16 v[36:39], v[68:71], v[236:239], v[36:39]
    ds_read_b64_tr_b16 v[68:69], v9 offset:4096
    s_waitcnt lgkmcnt(13)
    v_mfma_f32_16x16x32_bf16 v[24:27], v[72:75], v[232:235], v[24:27]
    ds_read_b64_tr_b16 v[70:71], v9 offset:6144
    v_mfma_f32_16x16x32_bf16 v[40:43], v[72:75], v[236:239], v[40:43]
    ds_read_b64_tr_b16 v[72:73], v10 offset:4096
    s_waitcnt lgkmcnt(13)
    v_mfma_f32_16x16x32_bf16 v[28:31], v[76:79], v[232:235], v[28:31]
    ds_read_b64_tr_b16 v[74:75], v10 offset:6144
    buffer_load_dwordx4 v[120:123], v2, s[24:27], s34 offen offset:0
    v_mfma_f32_16x16x32_bf16 v[44:47], v[76:79], v[236:239], v[44:47]
    ds_read_b64_tr_b16 v[76:77], v11 offset:4096
    buffer_load_dwordx4 v[124:127], v2, s[24:27], s34 offen offset:1024
    s_add_u32 s34, s34, 8192
    s_waitcnt vmcnt(10) lgkmcnt(13)
    v_mfma_f32_16x16x32_bf16 v[16:19], v[48:51], v[80:83], v[16:19]
    ds_read_b64_tr_b16 v[78:79], v11 offset:6144
    v_mfma_f32_16x16x32_bf16 v[32:35], v[48:51], v[84:87], v[32:35]
    ds_read_b64_tr_b16 v[48:49], v8 offset:8192
    s_waitcnt lgkmcnt(13)
    v_mfma_f32_16x16x32_bf16 v[20:23], v[52:55], v[80:83], v[20:23]
    ds_read_b64_tr_b16 v[50:51], v8 offset:10240
    v_add_u32 v13, 1, v13
    s_add_u32 s37, s37, 1
    v_mfma_f32_16x16x32_bf16 v[36:39], v[52:55], v[84:87], v[36:39]
    ds_read_b64_tr_b16 v[52:53], v9 offset:8192
    ds_write_b32 v14, v13
    s_waitcnt lgkmcnt(14)
    v_mfma_f32_16x16x32_bf16 v[24:27], v[56:59], v[80:83], v[24:27]
    ds_read_b64_tr_b16 v[54:55], v9 offset:10240
    v_mfma_f32_16x16x32_bf16 v[40:43], v[56:59], v[84:87], v[40:43]
    ds_read_b64_tr_b16 v[56:57], v10 offset:8192
    s_waitcnt lgkmcnt(14)
    v_mfma_f32_16x16x32_bf16 v[28:31], v[60:63], v[80:83], v[28:31]
    ds_read_b64_tr_b16 v[58:59], v10 offset:10240
    s_add_u32 s38, s38, 1
    s_cmp_eq_u32 s38, 7
    s_cselect_b32 s39, s47, s46
    s_cselect_b32 s38, 0, s38
    buffer_load_dwordx4 v[128:131], v2, s[24:27], s34 offen offset:0
    v_mfma_f32_16x16x32_bf16 v[44:47], v[60:63], v[84:87], v[44:47]
    ds_read_b64_tr_b16 v[60:61], v11 offset:8192
    buffer_load_dwordx4 v[132:135], v2, s[24:27], s34 offen offset:1024
    s_add_u32 s34, s34, 8192
    s_waitcnt vmcnt(10) lgkmcnt(14)
    v_mfma_f32_16x16x32_bf16 v[16:19], v[64:67], v[88:91], v[16:19]
    ds_read_b64_tr_b16 v[62:63], v11 offset:10240
    v_mfma_f32_16x16x32_bf16 v[32:35], v[64:67], v[92:95], v[32:35]
    ds_read_b64_tr_b16 v[64:65], v8 offset:12288
    s_waitcnt lgkmcnt(14)
    v_mfma_f32_16x16x32_bf16 v[20:23], v[68:71], v[88:91], v[20:23]
    ds_read_b64_tr_b16 v[66:67], v8 offset:14336
    v_add_u32 v8, s39, v8
    v_mfma_f32_16x16x32_bf16 v[36:39], v[68:71], v[92:95], v[36:39]
    ds_read_b64_tr_b16 v[68:69], v9 offset:12288
    ds_read_b32 v15, v0
    s_waitcnt lgkmcnt(15)
    v_mfma_f32_16x16x32_bf16 v[24:27], v[72:75], v[88:91], v[24:27]
    ds_read_b64_tr_b16 v[70:71], v9 offset:14336
    v_add_u32 v9, s39, v9
    v_mfma_f32_16x16x32_bf16 v[40:43], v[72:75], v[92:95], v[40:43]
    ds_read_b64_tr_b16 v[72:73], v10 offset:12288
    s_waitcnt lgkmcnt(15)
    v_mfma_f32_16x16x32_bf16 v[28:31], v[76:79], v[88:91], v[28:31]
    ds_read_b64_tr_b16 v[74:75], v10 offset:14336
    v_add_u32 v10, s39, v10
    buffer_load_dwordx4 v[136:139], v2, s[24:27], s34 offen offset:0
    v_mfma_f32_16x16x32_bf16 v[44:47], v[76:79], v[92:95], v[44:47]
    ds_read_b64_tr_b16 v[76:77], v11 offset:12288
    buffer_load_dwordx4 v[140:143], v2, s[24:27], s34 offen offset:1024
    s_add_u32 s34, s34, 8192
    s_waitcnt vmcnt(10) lgkmcnt(15)
    v_mfma_f32_16x16x32_bf16 v[16:19], v[48:51], v[96:99], v[16:19]
    ds_read_b64_tr_b16 v[78:79], v11 offset:14336
    v_add_u32 v11, s39, v11
    v_mfma_f32_16x16x32_bf16 v[32:35], v[48:51], v[100:103], v[32:35]
    s_waitcnt lgkmcnt(5)
    v_cmp_ge_u32 vcc, s37, v15
    s_cbranch_vccnz L_dn_slow30
L_dn_ret30:
    ds_read_b64_tr_b16 v[48:49], v8 offset:0
    v_mfma_f32_16x16x32_bf16 v[20:23], v[52:55], v[96:99], v[20:23]
    ds_read_b64_tr_b16 v[50:51], v8 offset:2048
    v_mfma_f32_16x16x32_bf16 v[36:39], v[52:55], v[100:103], v[36:39]
    ds_read_b64_tr_b16 v[52:53], v9 offset:0
    v_mfma_f32_16x16x32_bf16 v[24:27], v[56:59], v[96:99], v[24:27]
    ds_read_b64_tr_b16 v[54:55], v9 offset:2048
    v_mfma_f32_16x16x32_bf16 v[40:43], v[56:59], v[100:103], v[40:43]
    ds_read_b64_tr_b16 v[56:57], v10 offset:0
    v_mfma_f32_16x16x32_bf16 v[28:31], v[60:63], v[96:99], v[28:31]
    ds_read_b64_tr_b16 v[58:59], v10 offset:2048
    buffer_load_dwordx4 v[144:147], v2, s[24:27], s34 offen offset:0
    v_mfma_f32_16x16x32_bf16 v[44:47], v[60:63], v[100:103], v[44:47]
    ds_read_b64_tr_b16 v[60:61], v11 offset:0
    buffer_load_dwordx4 v[148:151], v2, s[24:27], s34 offen offset:1024
    s_add_u32 s34, s34, 8192
    s_waitcnt vmcnt(10)
    v_mfma_f32_16x16x32_bf16 v[16:19], v[64:67], v[104:107], v[16:19]
    ds_read_b64_tr_b16 v[62:63], v11 offset:2048
    v_mfma_f32_16x16x32_bf16 v[32:35], v[64:67], v[108:111], v[32:35]
    ds_read_b64_tr_b16 v[64:65], v8 offset:4096
    s_waitcnt lgkmcnt(13)
    v_mfma_f32_16x16x32_bf16 v[20:23], v[68:71], v[104:107], v[20:23]
    ds_read_b64_tr_b16 v[66:67], v8 offset:6144
    v_mfma_f32_16x16x32_bf16 v[36:39], v[68:71], v[108:111], v[36:39]
    ds_read_b64_tr_b16 v[68:69], v9 offset:4096
    s_waitcnt lgkmcnt(13)
    v_mfma_f32_16x16x32_bf16 v[24:27], v[72:75], v[104:107], v[24:27]
    ds_read_b64_tr_b16 v[70:71], v9 offset:6144
    v_mfma_f32_16x16x32_bf16 v[40:43], v[72:75], v[108:111], v[40:43]
    ds_read_b64_tr_b16 v[72:73], v10 offset:4096
    s_waitcnt lgkmcnt(13)
    v_mfma_f32_16x16x32_bf16 v[28:31], v[76:79], v[104:107], v[28:31]
    ds_read_b64_tr_b16 v[74:75], v10 offset:6144
    buffer_load_dwordx4 v[152:155], v2, s[24:27], s34 offen offset:0
    v_mfma_f32_16x16x32_bf16 v[44:47], v[76:79], v[108:111], v[44:47]
    ds_read_b64_tr_b16 v[76:77], v11 offset:4096
    buffer_load_dwordx4 v[156:159], v2, s[24:27], s34 offen offset:1024
    s_add_u32 s34, s34, 8192
    s_waitcnt vmcnt(10) lgkmcnt(13)
    v_mfma_f32_16x16x32_bf16 v[16:19], v[48:51], v[112:115], v[16:19]
    ds_read_b64_tr_b16 v[78:79], v11 offset:6144
    v_mfma_f32_16x16x32_bf16 v[32:35], v[48:51], v[116:119], v[32:35]
    ds_read_b64_tr_b16 v[48:49], v8 offset:8192
    s_waitcnt lgkmcnt(13)
    v_mfma_f32_16x16x32_bf16 v[20:23], v[52:55], v[112:115], v[20:23]
    ds_read_b64_tr_b16 v[50:51], v8 offset:10240
    v_add_u32 v13, 1, v13
    s_add_u32 s37, s37, 1
    v_mfma_f32_16x16x32_bf16 v[36:39], v[52:55], v[116:119], v[36:39]
    ds_read_b64_tr_b16 v[52:53], v9 offset:8192
    ds_write_b32 v14, v13
    s_waitcnt lgkmcnt(14)
    v_mfma_f32_16x16x32_bf16 v[24:27], v[56:59], v[112:115], v[24:27]
    ds_read_b64_tr_b16 v[54:55], v9 offset:10240
    v_mfma_f32_16x16x32_bf16 v[40:43], v[56:59], v[116:119], v[40:43]
    ds_read_b64_tr_b16 v[56:57], v10 offset:8192
    s_waitcnt lgkmcnt(14)
    v_mfma_f32_16x16x32_bf16 v[28:31], v[60:63], v[112:115], v[28:31]
    ds_read_b64_tr_b16 v[58:59], v10 offset:10240
    s_add_u32 s38, s38, 1
    s_cmp_eq_u32 s38, 7
    s_cselect_b32 s39, s47, s46
    s_cselect_b32 s38, 0, s38
    buffer_load_dwordx4 v[160:163], v2, s[24:27], s34 offen offset:0
    v_mfma_f32_16x16x32_bf16 v[44:47], v[60:63], v[116:119], v[44:47]
    ds_read_b64_tr_b16 v[60:61], v11 offset:8192
    buffer_load_dwordx4 v[164:167], v2, s[24:27], s34 offen offset:1024
    s_add_u32 s34, s34, 8192
    s_waitcnt vmcnt(10) lgkmcnt(14)
    v_mfma_f32_16x16x32_bf16 v[16:19], v[64:67], v[120:123], v[16:19]
    ds_read_b64_tr_b16 v[62:63], v11 offset:10240
    v_mfma_f32_16x16x32_bf16 v[32:35], v[64:67], v[124:127], v[32:35]
    ds_read_b64_tr_b16 v[64:65], v8 offset:12288
    s_waitcnt lgkmcnt(14)
    v_mfma_f32_16x16x32_bf16 v[20:23], v[68:71], v[120:123], v[20:23]
    ds_read_b64_tr_b16 v[66:67], v8 offset:14336
    v_add_u32 v8, s39, v8
    v_mfma_f32_16x16x32_bf16 v[36:39], v[68:71], v[124:127], v[36:39]
    ds_read_b64_tr_b16 v[68:69], v9 offset:12288
    ds_read_b32 v15, v0
    s_waitcnt lgkmcnt(15)
    v_mfma_f32_16x16x32_bf16 v[24:27], v[72:75], v[120:123], v[24:27]
    ds_read_b64_tr_b16 v[70:71], v9 offset:14336
    v_add_u32 v9, s39, v9
    v_mfma_f32_16x16x32_bf16 v[40:43], v[72:75], v[124:127], v[40:43]
    ds_read_b64_tr_b16 v[72:73], v10 offset:12288
    s_waitcnt lgkmcnt(15)
    v_mfma_f32_16x16x32_bf16 v[28:31], v[76:79], v[120:123], v[28:31]
    ds_read_b64_tr_b16 v[74:75], v10 offset:14336
    v_add_u32 v10, s39, v10
    buffer_load_dwordx4 v[168:171], v2, s[24:27], s34 offen offset:0
    v_mfma_f32_16x16x32_bf16 v[44:47], v[76:79], v[124:127], v[44:47]
    ds_read_b64_tr_b16 v[76:77], v11 offset:12288
    buffer_load_dwordx4 v[172:175], v2, s[24:27], s34 offen offset:1024
    s_add_u32 s34, s34, 8192
    s_waitcnt vmcnt(10) lgkmcnt(15)
    v_mfma_f32_16x16x32_bf16 v[16:19], v[48:51], v[128:131], v[16:19]
    ds_read_b64_tr_b16 v[78:79], v11 offset:14336
    v_add_u32 v11, s39, v11
    v_mfma_f32_16x16x32_bf16 v[32:35], v[48:51], v[132:135], v[32:35]
    s_waitcnt lgkmcnt(5)
    v_cmp_ge_u32 vcc, s37, v15
    s_cbranch_vccnz L_dn_slow31
L_dn_ret31:
    ds_read_b64_tr_b16 v[48:49], v8 offset:0
    v_mfma_f32_16x16x32_bf16 v[20:23], v[52:55], v[128:131], v[20:23]
    ds_read_b64_tr_b16 v[50:51], v8 offset:2048
    v_mfma_f32_16x16x32_bf16 v[36:39], v[52:55], v[132:135], v[36:39]
    ds_read_b64_tr_b16 v[52:53], v9 offset:0
    v_mfma_f32_16x16x32_bf16 v[24:27], v[56:59], v[128:131], v[24:27]
    ds_read_b64_tr_b16 v[54:55], v9 offset:2048
    v_mfma_f32_16x16x32_bf16 v[40:43], v[56:59], v[132:135], v[40:43]
    ds_read_b64_tr_b16 v[56:57], v10 offset:0
    v_mfma_f32_16x16x32_bf16 v[28:31], v[60:63], v[128:131], v[28:31]
    ds_read_b64_tr_b16 v[58:59], v10 offset:2048
    buffer_load_dwordx4 v[176:179], v2, s[24:27], s34 offen offset:0
    v_mfma_f32_16x16x32_bf16 v[44:47], v[60:63], v[132:135], v[44:47]
    ds_read_b64_tr_b16 v[60:61], v11 offset:0
    buffer_load_dwordx4 v[180:183], v2, s[24:27], s34 offen offset:1024
    s_add_u32 s34, s34, 8192
    s_waitcnt vmcnt(10)
    v_mfma_f32_16x16x32_bf16 v[16:19], v[64:67], v[136:139], v[16:19]
    ds_read_b64_tr_b16 v[62:63], v11 offset:2048
    v_mfma_f32_16x16x32_bf16 v[32:35], v[64:67], v[140:143], v[32:35]
    ds_read_b64_tr_b16 v[64:65], v8 offset:4096
    s_waitcnt lgkmcnt(13)
    v_mfma_f32_16x16x32_bf16 v[20:23], v[68:71], v[136:139], v[20:23]
    ds_read_b64_tr_b16 v[66:67], v8 offset:6144
    v_mfma_f32_16x16x32_bf16 v[36:39], v[68:71], v[140:143], v[36:39]
    ds_read_b64_tr_b16 v[68:69], v9 offset:4096
    s_waitcnt lgkmcnt(13)
    v_mfma_f32_16x16x32_bf16 v[24:27], v[72:75], v[136:139], v[24:27]
    ds_read_b64_tr_b16 v[70:71], v9 offset:6144
    v_mfma_f32_16x16x32_bf16 v[40:43], v[72:75], v[140:143], v[40:43]
    ds_read_b64_tr_b16 v[72:73], v10 offset:4096
    s_waitcnt lgkmcnt(13)
    v_mfma_f32_16x16x32_bf16 v[28:31], v[76:79], v[136:139], v[28:31]
    ds_read_b64_tr_b16 v[74:75], v10 offset:6144
    buffer_load_dwordx4 v[184:187], v2, s[24:27], s34 offen offset:0
    v_mfma_f32_16x16x32_bf16 v[44:47], v[76:79], v[140:143], v[44:47]
    ds_read_b64_tr_b16 v[76:77], v11 offset:4096
    buffer_load_dwordx4 v[188:191], v2, s[24:27], s34 offen offset:1024
    s_add_u32 s34, s34, 8192
    s_waitcnt vmcnt(10) lgkmcnt(13)
    v_mfma_f32_16x16x32_bf16 v[16:19], v[48:51], v[144:147], v[16:19]
    ds_read_b64_tr_b16 v[78:79], v11 offset:6144
    v_mfma_f32_16x16x32_bf16 v[32:35], v[48:51], v[148:151], v[32:35]
    ds_read_b64_tr_b16 v[48:49], v8 offset:8192
    s_waitcnt lgkmcnt(13)
    v_mfma_f32_16x16x32_bf16 v[20:23], v[52:55], v[144:147], v[20:23]
    ds_read_b64_tr_b16 v[50:51], v8 offset:10240
    v_add_u32 v13, 1, v13
    s_add_u32 s37, s37, 1
    v_mfma_f32_16x16x32_bf16 v[36:39], v[52:55], v[148:151], v[36:39]
    ds_read_b64_tr_b16 v[52:53], v9 offset:8192
    ds_write_b32 v14, v13
    s_waitcnt lgkmcnt(14)
    v_mfma_f32_16x16x32_bf16 v[24:27], v[56:59], v[144:147], v[24:27]
    ds_read_b64_tr_b16 v[54:55], v9 offset:10240
    v_mfma_f32_16x16x32_bf16 v[40:43], v[56:59], v[148:151], v[40:43]
    ds_read_b64_tr_b16 v[56:57], v10 offset:8192
    s_waitcnt lgkmcnt(14)
    v_mfma_f32_16x16x32_bf16 v[28:31], v[60:63], v[144:147], v[28:31]
    ds_read_b64_tr_b16 v[58:59], v10 offset:10240
    s_mov_b32 s39, -106496
    buffer_load_dwordx4 v[192:195], v2, s[24:27], s34 offen offset:0
    v_mfma_f32_16x16x32_bf16 v[44:47], v[60:63], v[148:151], v[44:47]
    ds_read_b64_tr_b16 v[60:61], v11 offset:8192
    buffer_load_dwordx4 v[196:199], v2, s[24:27], s34 offen offset:1024
    s_add_u32 s34, s34, 8192
    s_waitcnt vmcnt(10) lgkmcnt(14)
    v_mfma_f32_16x16x32_bf16 v[16:19], v[64:67], v[152:155], v[16:19]
    ds_read_b64_tr_b16 v[62:63], v11 offset:10240
    v_mfma_f32_16x16x32_bf16 v[32:35], v[64:67], v[156:159], v[32:35]
    ds_read_b64_tr_b16 v[64:65], v8 offset:12288
    s_waitcnt lgkmcnt(14)
    v_mfma_f32_16x16x32_bf16 v[20:23], v[68:71], v[152:155], v[20:23]
    ds_read_b64_tr_b16 v[66:67], v8 offset:14336
    v_add_u32 v8, s39, v8
    v_mfma_f32_16x16x32_bf16 v[36:39], v[68:71], v[156:159], v[36:39]
    ds_read_b64_tr_b16 v[68:69], v9 offset:12288
    ds_read_b32 v15, v0
    s_waitcnt lgkmcnt(15)
    v_mfma_f32_16x16x32_bf16 v[24:27], v[72:75], v[152:155], v[24:27]
    ds_read_b64_tr_b16 v[70:71], v9 offset:14336
    v_add_u32 v9, s39, v9
    v_mfma_f32_16x16x32_bf16 v[40:43], v[72:75], v[156:159], v[40:43]
    ds_read_b64_tr_b16 v[72:73], v10 offset:12288
    s_waitcnt lgkmcnt(15)
    v_mfma_f32_16x16x32_bf16 v[28:31], v[76:79], v[152:155], v[28:31]
    ds_read_b64_tr_b16 v[74:75], v10 offset:14336
    v_add_u32 v10, s39, v10
    buffer_load_dwordx4 v[200:203], v2, s[24:27], s34 offen offset:0
    v_mfma_f32_16x16x32_bf16 v[44:47], v[76:79], v[156:159], v[44:47]
    ds_read_b64_tr_b16 v[76:77], v11 offset:12288
    buffer_load_dwordx4 v[204:207], v2, s[24:27], s34 offen offset:1024
    s_add_u32 s34, s34, 8192
    s_waitcnt vmcnt(10) lgkmcnt(15)
    v_mfma_f32_16x16x32_bf16 v[16:19], v[48:51], v[160:163], v[16:19]
    ds_read_b64_tr_b16 v[78:79], v11 offset:14336
    v_add_u32 v11, s39, v11
    v_mfma_f32_16x16x32_bf16 v[32:35], v[48:51], v[164:167], v[32:35]
    s_waitcnt lgkmcnt(5)
    v_cmp_ge_u32 vcc, s37, v15
    s_cbranch_vccnz L_dn_slow32
L_dn_ret32:
    ds_read_b64_tr_b16 v[48:49], v8 offset:0
    v_mfma_f32_16x16x32_bf16 v[20:23], v[52:55], v[160:163], v[20:23]
    ds_read_b64_tr_b16 v[50:51], v8 offset:2048
    v_mfma_f32_16x16x32_bf16 v[36:39], v[52:55], v[164:167], v[36:39]
    ds_read_b64_tr_b16 v[52:53], v9 offset:0
    v_mfma_f32_16x16x32_bf16 v[24:27], v[56:59], v[160:163], v[24:27]
    ds_read_b64_tr_b16 v[54:55], v9 offset:2048
    v_mfma_f32_16x16x32_bf16 v[40:43], v[56:59], v[164:167], v[40:43]
    ds_read_b64_tr_b16 v[56:57], v10 offset:0
    v_mfma_f32_16x16x32_bf16 v[28:31], v[60:63], v[160:163], v[28:31]
    ds_read_b64_tr_b16 v[58:59], v10 offset:2048
    buffer_load_dwordx4 v[208:211], v2, s[24:27], s34 offen offset:0
    v_mfma_f32_16x16x32_bf16 v[44:47], v[60:63], v[164:167], v[44:47]
    ds_read_b64_tr_b16 v[60:61], v11 offset:0
    buffer_load_dwordx4 v[212:215], v2, s[24:27], s34 offen offset:1024
    s_add_u32 s34, s34, 8192
    s_waitcnt vmcnt(10)
    v_mfma_f32_16x16x32_bf16 v[16:19], v[64:67], v[168:171], v[16:19]
    ds_read_b64_tr_b16 v[62:63], v11 offset:2048
    v_mfma_f32_16x16x32_bf16 v[32:35], v[64:67], v[172:175], v[32:35]
    ds_read_b64_tr_b16 v[64:65], v8 offset:4096
    s_waitcnt lgkmcnt(13)
    v_mfma_f32_16x16x32_bf16 v[20:23], v[68:71], v[168:171], v[20:23]
    ds_read_b64_tr_b16 v[66:67], v8 offset:6144
    v_mfma_f32_16x16x32_bf16 v[36:39], v[68:71], v[172:175], v[36:39]
    ds_read_b64_tr_b16 v[68:69], v9 offset:4096
    s_waitcnt lgkmcnt(13)
    v_mfma_f32_16x16x32_bf16 v[24:27], v[72:75], v[168:171], v[24:27]
    ds_read_b64_tr_b16 v[70:71], v9 offset:6144
    v_mfma_f32_16x16x32_bf16 v[40:43], v[72:75], v[172:175], v[40:43]
    ds_read_b64_tr_b16 v[72:73], v10 offset:4096
    s_waitcnt lgkmcnt(13)
    v_mfma_f32_16x16x32_bf16 v[28:31], v[76:79], v[168:171], v[28:31]
    ds_read_b64_tr_b16 v[74:75], v10 offset:6144
    buffer_load_dwordx4 v[216:219], v2, s[24:27], s34 offen offset:0
    v_mfma_f32_16x16x32_bf16 v[44:47], v[76:79], v[172:175], v[44:47]
    ds_read_b64_tr_b16 v[76:77], v11 offset:4096
    buffer_load_dwordx4 v[220:223], v2, s[24:27], s34 offen offset:1024
    s_add_u32 s34, s34, 8192
    s_waitcnt vmcnt(10) lgkmcnt(13)
    v_mfma_f32_16x16x32_bf16 v[16:19], v[48:51], v[176:179], v[16:19]
    ds_read_b64_tr_b16 v[78:79], v11 offset:6144
    v_mfma_f32_16x16x32_bf16 v[32:35], v[48:51], v[180:183], v[32:35]
    ds_read_b64_tr_b16 v[48:49], v8 offset:8192
    s_waitcnt lgkmcnt(13)
    v_mfma_f32_16x16x32_bf16 v[20:23], v[52:55], v[176:179], v[20:23]
    ds_read_b64_tr_b16 v[50:51], v8 offset:10240
    v_add_u32 v13, 1, v13
    s_add_u32 s37, s37, 1
    v_mfma_f32_16x16x32_bf16 v[36:39], v[52:55], v[180:183], v[36:39]
    ds_read_b64_tr_b16 v[52:53], v9 offset:8192
    ds_write_b32 v14, v13
    s_waitcnt lgkmcnt(14)
    v_mfma_f32_16x16x32_bf16 v[24:27], v[56:59], v[176:179], v[24:27]
    ds_read_b64_tr_b16 v[54:55], v9 offset:10240
    v_mfma_f32_16x16x32_bf16 v[40:43], v[56:59], v[180:183], v[40:43]
    ds_read_b64_tr_b16 v[56:57], v10 offset:8192
    s_waitcnt lgkmcnt(14)
    v_mfma_f32_16x16x32_bf16 v[28:31], v[60:63], v[176:179], v[28:31]
    ds_read_b64_tr_b16 v[58:59], v10 offset:10240
    s_mov_b32 s39, 16384
    buffer_load_dwordx4 v[224:227], v2, s[24:27], s34 offen offset:0
    v_mfma_f32_16x16x32_bf16 v[44:47], v[60:63], v[180:183], v[44:47]
    ds_read_b64_tr_b16 v[60:61], v11 offset:8192
    buffer_load_dwordx4 v[228:231], v2, s[24:27], s34 offen offset:1024
    s_add_u32 s34, s34, 8192
    s_waitcnt vmcnt(10) lgkmcnt(14)
    v_mfma_f32_16x16x32_bf16 v[16:19], v[64:67], v[184:187], v[16:19]
    ds_read_b64_tr_b16 v[62:63], v11 offset:10240
    v_mfma_f32_16x16x32_bf16 v[32:35], v[64:67], v[188:191], v[32:35]
    ds_read_b64_tr_b16 v[64:65], v8 offset:12288
    s_waitcnt lgkmcnt(14)
    v_mfma_f32_16x16x32_bf16 v[20:23], v[68:71], v[184:187], v[20:23]
    ds_read_b64_tr_b16 v[66:67], v8 offset:14336
    v_add_u32 v8, s39, v8
    v_mfma_f32_16x16x32_bf16 v[36:39], v[68:71], v[188:191], v[36:39]
    ds_read_b64_tr_b16 v[68:69], v9 offset:12288
    ds_read_b32 v15, v0
    s_waitcnt lgkmcnt(15)
    v_mfma_f32_16x16x32_bf16 v[24:27], v[72:75], v[184:187], v[24:27]
    ds_read_b64_tr_b16 v[70:71], v9 offset:14336
    v_add_u32 v9, s39, v9
    v_mfma_f32_16x16x32_bf16 v[40:43], v[72:75], v[188:191], v[40:43]
    ds_read_b64_tr_b16 v[72:73], v10 offset:12288
    s_waitcnt lgkmcnt(15)
    v_mfma_f32_16x16x32_bf16 v[28:31], v[76:79], v[184:187], v[28:31]
    ds_read_b64_tr_b16 v[74:75], v10 offset:14336
    v_add_u32 v10, s39, v10
    buffer_load_dwordx4 v[232:235], v2, s[24:27], s34 offen offset:0
    v_mfma_f32_16x16x32_bf16 v[44:47], v[76:79], v[188:191], v[44:47]
    ds_read_b64_tr_b16 v[76:77], v11 offset:12288
    buffer_load_dwordx4 v[236:239], v2, s[24:27], s34 offen offset:1024
    s_add_u32 s34, s34, 8192
    s_waitcnt vmcnt(10) lgkmcnt(15)
    v_mfma_f32_16x16x32_bf16 v[16:19], v[48:51], v[192:195], v[16:19]
    ds_read_b64_tr_b16 v[78:79], v11 offset:14336
    v_add_u32 v11, s39, v11
    v_mfma_f32_16x16x32_bf16 v[32:35], v[48:51], v[196:199], v[32:35]
    s_waitcnt lgkmcnt(5)
    v_cmp_ge_u32 vcc, s37, v15
    s_cbranch_vccnz L_dn_slow33
L_dn_ret33:
    ds_read_b64_tr_b16 v[48:49], v8 offset:0
    v_mfma_f32_16x16x32_bf16 v[20:23], v[52:55], v[192:195], v[20:23]
    ds_read_b64_tr_b16 v[50:51], v8 offset:2048
    v_mfma_f32_16x16x32_bf16 v[36:39], v[52:55], v[196:199], v[36:39]
    ds_read_b64_tr_b16 v[52:53], v9 offset:0
    v_mfma_f32_16x16x32_bf16 v[24:27], v[56:59], v[192:195], v[24:27]
    ds_read_b64_tr_b16 v[54:55], v9 offset:2048
    v_mfma_f32_16x16x32_bf16 v[40:43], v[56:59], v[196:199], v[40:43]
    ds_read_b64_tr_b16 v[56:57], v10 offset:0
    v_mfma_f32_16x16x32_bf16 v[28:31], v[60:63], v[192:195], v[28:31]
    ds_read_b64_tr_b16 v[58:59], v10 offset:2048
    buffer_load_dwordx4 v[80:83], v2, s[24:27], s34 offen offset:0
    v_mfma_f32_16x16x32_bf16 v[44:47], v[60:63], v[196:199], v[44:47]
    ds_read_b64_tr_b16 v[60:61], v11 offset:0
    buffer_load_dwordx4 v[84:87], v2, s[24:27], s34 offen offset:1024
    s_add_u32 s34, s34, 8192
    s_waitcnt vmcnt(10)
    v_mfma_f32_16x16x32_bf16 v[16:19], v[64:67], v[200:203], v[16:19]
    ds_read_b64_tr_b16 v[62:63], v11 offset:2048
    v_mfma_f32_16x16x32_bf16 v[32:35], v[64:67], v[204:207], v[32:35]
    ds_read_b64_tr_b16 v[64:65], v8 offset:4096
    s_waitcnt lgkmcnt(13)
    v_mfma_f32_16x16x32_bf16 v[20:23], v[68:71], v[200:203], v[20:23]
    ds_read_b64_tr_b16 v[66:67], v8 offset:6144
    v_mfma_f32_16x16x32_bf16 v[36:39], v[68:71], v[204:207], v[36:39]
    ds_read_b64_tr_b16 v[68:69], v9 offset:4096
    s_waitcnt lgkmcnt(13)
    v_mfma_f32_16x16x32_bf16 v[24:27], v[72:75], v[200:203], v[24:27]
    ds_read_b64_tr_b16 v[70:71], v9 offset:6144
    v_mfma_f32_16x16x32_bf16 v[40:43], v[72:75], v[204:207], v[40:43]
    ds_read_b64_tr_b16 v[72:73], v10 offset:4096
    s_waitcnt lgkmcnt(13)
    v_mfma_f32_16x16x32_bf16 v[28:31], v[76:79], v[200:203], v[28:31]
    ds_read_b64_tr_b16 v[74:75], v10 offset:6144
    buffer_load_dwordx4 v[88:91], v2, s[24:27], s34 offen offset:0
    v_mfma_f32_16x16x32_bf16 v[44:47], v[76:79], v[204:207], v[44:47]
    ds_read_b64_tr_b16 v[76:77], v11 offset:4096
    buffer_load_dwordx4 v[92:95], v2, s[24:27], s34 offen offset:1024
    s_add_u32 s34, s34, 8192
    s_waitcnt vmcnt(10) lgkmcnt(13)
    v_mfma_f32_16x16x32_bf16 v[16:19], v[48:51], v[208:211], v[16:19]
    ds_read_b64_tr_b16 v[78:79], v11 offset:6144
    v_mfma_f32_16x16x32_bf16 v[32:35], v[48:51], v[212:215], v[32:35]
    ds_read_b64_tr_b16 v[48:49], v8 offset:8192
    s_waitcnt lgkmcnt(13)
    v_mfma_f32_16x16x32_bf16 v[20:23], v[52:55], v[208:211], v[20:23]
    ds_read_b64_tr_b16 v[50:51], v8 offset:10240
    v_add_u32 v13, 1, v13
    s_add_u32 s37, s37, 1
    v_mfma_f32_16x16x32_bf16 v[36:39], v[52:55], v[212:215], v[36:39]
    ds_read_b64_tr_b16 v[52:53], v9 offset:8192
    ds_write_b32 v14, v13
    s_waitcnt lgkmcnt(14)
    v_mfma_f32_16x16x32_bf16 v[24:27], v[56:59], v[208:211], v[24:27]
    ds_read_b64_tr_b16 v[54:55], v9 offset:10240
    v_mfma_f32_16x16x32_bf16 v[40:43], v[56:59], v[212:215], v[40:43]
    ds_read_b64_tr_b16 v[56:57], v10 offset:8192
    s_waitcnt lgkmcnt(14)
    v_mfma_f32_16x16x32_bf16 v[28:31], v[60:63], v[208:211], v[28:31]
    ds_read_b64_tr_b16 v[58:59], v10 offset:10240
    s_mov_b32 s39, 106496
    buffer_load_dwordx4 v[96:99], v2, s[24:27], s34 offen offset:0
    v_mfma_f32_16x16x32_bf16 v[44:47], v[60:63], v[212:215], v[44:47]
    ds_read_b64_tr_b16 v[60:61], v11 offset:8192
    buffer_load_dwordx4 v[100:103], v2, s[24:27], s34 offen offset:1024
    s_add_u32 s34, s34, 8192
    s_waitcnt vmcnt(10) lgkmcnt(14)
    v_mfma_f32_16x16x32_bf16 v[16:19], v[64:67], v[216:219], v[16:19]
    ds_read_b64_tr_b16 v[62:63], v11 offset:10240
    v_mfma_f32_16x16x32_bf16 v[32:35], v[64:67], v[220:223], v[32:35]
    ds_read_b64_tr_b16 v[64:65], v8 offset:12288
    s_waitcnt lgkmcnt(14)
    v_mfma_f32_16x16x32_bf16 v[20:23], v[68:71], v[216:219], v[20:23]
    ds_read_b64_tr_b16 v[66:67], v8 offset:14336
    v_add_u32 v8, s39, v8
    v_mfma_f32_16x16x32_bf16 v[36:39], v[68:71], v[220:223], v[36:39]
    ds_read_b64_tr_b16 v[68:69], v9 offset:12288
    ds_read_b32 v15, v0
    s_waitcnt lgkmcnt(15)
    v_mfma_f32_16x16x32_bf16 v[24:27], v[72:75], v[216:219], v[24:27]
    ds_read_b64_tr_b16 v[70:71], v9 offset:14336
    v_add_u32 v9, s39, v9
    v_mfma_f32_16x16x32_bf16 v[40:43], v[72:75], v[220:223], v[40:43]
    ds_read_b64_tr_b16 v[72:73], v10 offset:12288
    s_waitcnt lgkmcnt(15)
    v_mfma_f32_16x16x32_bf16 v[28:31], v[76:79], v[216:219], v[28:31]
    ds_read_b64_tr_b16 v[74:75], v10 offset:14336
    v_add_u32 v10, s39, v10
    buffer_load_dwordx4 v[104:107], v2, s[24:27], s34 offen offset:0
    v_mfma_f32_16x16x32_bf16 v[44:47], v[76:79], v[220:223], v[44:47]
    ds_read_b64_tr_b16 v[76:77], v11 offset:12288
    buffer_load_dwordx4 v[108:111], v2, s[24:27], s34 offen offset:1024
    s_add_u32 s34, s34, 8192
    s_waitcnt vmcnt(10) lgkmcnt(15)
    v_mfma_f32_16x16x32_bf16 v[16:19], v[48:51], v[224:227], v[16:19]
    ds_read_b64_tr_b16 v[78:79], v11 offset:14336
    v_add_u32 v11, s39, v11
    v_mfma_f32_16x16x32_bf16 v[32:35], v[48:51], v[228:231], v[32:35]
    s_waitcnt lgkmcnt(5)
    v_cmp_ge_u32 vcc, s37, v15
    s_cbranch_vccnz L_dn_slow34
L_dn_ret34:
    ds_read_b64_tr_b16 v[48:49], v8 offset:0
    v_mfma_f32_16x16x32_bf16 v[20:23], v[52:55], v[224:227], v[20:23]
    ds_read_b64_tr_b16 v[50:51], v8 offset:2048
    v_mfma_f32_16x16x32_bf16 v[36:39], v[52:55], v[228:231], v[36:39]
    ds_read_b64_tr_b16 v[52:53], v9 offset:0
    v_mfma_f32_16x16x32_bf16 v[24:27], v[56:59], v[224:227], v[24:27]
    ds_read_b64_tr_b16 v[54:55], v9 offset:2048
    v_mfma_f32_16x16x32_bf16 v[40:43], v[56:59], v[228:231], v[40:43]
    ds_read_b64_tr_b16 v[56:57], v10 offset:0
    v_mfma_f32_16x16x32_bf16 v[28:31], v[60:63], v[224:227], v[28:31]
    ds_read_b64_tr_b16 v[58:59], v10 offset:2048
    v_mfma_f32_16x16x32_bf16 v[44:47], v[60:63], v[228:231], v[44:47]
    ds_read_b64_tr_b16 v[60:61], v11 offset:0
    s_waitcnt vmcnt(8)
    v_mfma_f32_16x16x32_bf16 v[16:19], v[64:67], v[232:235], v[16:19]
    ds_read_b64_tr_b16 v[62:63], v11 offset:2048
    v_mfma_f32_16x16x32_bf16 v[32:35], v[64:67], v[236:239], v[32:35]
    ds_read_b64_tr_b16 v[64:65], v8 offset:4096
    s_waitcnt lgkmcnt(13)
    v_mfma_f32_16x16x32_bf16 v[20:23], v[68:71], v[232:235], v[20:23]
    ds_read_b64_tr_b16 v[66:67], v8 offset:6144
    v_mfma_f32_16x16x32_bf16 v[36:39], v[68:71], v[236:239], v[36:39]
    ds_read_b64_tr_b16 v[68:69], v9 offset:4096
    s_waitcnt lgkmcnt(13)
    v_mfma_f32_16x16x32_bf16 v[24:27], v[72:75], v[232:235], v[24:27]
    ds_read_b64_tr_b16 v[70:71], v9 offset:6144
    v_mfma_f32_16x16x32_bf16 v[40:43], v[72:75], v[236:239], v[40:43]
    ds_read_b64_tr_b16 v[72:73], v10 offset:4096
    s_waitcnt lgkmcnt(13)
    v_mfma_f32_16x16x32_bf16 v[28:31], v[76:79], v[232:235], v[28:31]
    ds_read_b64_tr_b16 v[74:75], v10 offset:6144
    v_mfma_f32_16x16x32_bf16 v[44:47], v[76:79], v[236:239], v[44:47]
    ds_read_b64_tr_b16 v[76:77], v11 offset:4096
    s_waitcnt vmcnt(6) lgkmcnt(13)
    v_mfma_f32_16x16x32_bf16 v[16:19], v[48:51], v[80:83], v[16:19]
    ds_read_b64_tr_b16 v[78:79], v11 offset:6144
    v_mfma_f32_16x16x32_bf16 v[32:35], v[48:51], v[84:87], v[32:35]
    ds_read_b64_tr_b16 v[48:49], v8 offset:8192
    s_waitcnt lgkmcnt(13)
    v_mfma_f32_16x16x32_bf16 v[20:23], v[52:55], v[80:83], v[20:23]
    ds_read_b64_tr_b16 v[50:51], v8 offset:10240
    v_mfma_f32_16x16x32_bf16 v[36:39], v[52:55], v[84:87], v[36:39]
    ds_read_b64_tr_b16 v[52:53], v9 offset:8192
    s_waitcnt lgkmcnt(13)
    v_mfma_f32_16x16x32_bf16 v[24:27], v[56:59], v[80:83], v[24:27]
    ds_read_b64_tr_b16 v[54:55], v9 offset:10240
    v_mfma_f32_16x16x32_bf16 v[40:43], v[56:59], v[84:87], v[40:43]
    ds_read_b64_tr_b16 v[56:57], v10 offset:8192
    s_waitcnt lgkmcnt(13)
    v_mfma_f32_16x16x32_bf16 v[28:31], v[60:63], v[80:83], v[28:31]
    ds_read_b64_tr_b16 v[58:59], v10 offset:10240
    v_mfma_f32_16x16x32_bf16 v[44:47], v[60:63], v[84:87], v[44:47]
    ds_read_b64_tr_b16 v[60:61], v11 offset:8192
    s_waitcnt vmcnt(4) lgkmcnt(13)
    v_mfma_f32_16x16x32_bf16 v[16:19], v[64:67], v[88:91], v[16:19]
    ds_read_b64_tr_b16 v[62:63], v11 offset:10240
    v_mfma_f32_16x16x32_bf16 v[32:35], v[64:67], v[92:95], v[32:35]
    ds_read_b64_tr_b16 v[64:65], v8 offset:12288
    s_waitcnt lgkmcnt(13)
    v_mfma_f32_16x16x32_bf16 v[20:23], v[68:71], v[88:91], v[20:23]
    ds_read_b64_tr_b16 v[66:67], v8 offset:14336
    v_mfma_f32_16x16x32_bf16 v[36:39], v[68:71], v[92:95], v[36:39]
    ds_read_b64_tr_b16 v[68:69], v9 offset:12288
    s_waitcnt lgkmcnt(13)
    v_mfma_f32_16x16x32_bf16 v[24:27], v[72:75], v[88:91], v[24:27]
    ds_read_b64_tr_b16 v[70:71], v9 offset:14336
    v_mfma_f32_16x16x32_bf16 v[40:43], v[72:75], v[92:95], v[40:43]
    ds_read_b64_tr_b16 v[72:73], v10 offset:12288
    s_waitcnt lgkmcnt(13)
    v_mfma_f32_16x16x32_bf16 v[28:31], v[76:79], v[88:91], v[28:31]
    ds_read_b64_tr_b16 v[74:75], v10 offset:14336
    v_mfma_f32_16x16x32_bf16 v[44:47], v[76:79], v[92:95], v[44:47]
    ds_read_b64_tr_b16 v[76:77], v11 offset:12288
    s_waitcnt vmcnt(2) lgkmcnt(13)
    v_mfma_f32_16x16x32_bf16 v[16:19], v[48:51], v[96:99], v[16:19]
    ds_read_b64_tr_b16 v[78:79], v11 offset:14336
    v_mfma_f32_16x16x32_bf16 v[32:35], v[48:51], v[100:103], v[32:35]
    s_waitcnt lgkmcnt(12)
    v_mfma_f32_16x16x32_bf16 v[20:23], v[52:55], v[96:99], v[20:23]
    v_mfma_f32_16x16x32_bf16 v[36:39], v[52:55], v[100:103], v[36:39]
    s_waitcnt lgkmcnt(10)
    v_mfma_f32_16x16x32_bf16 v[24:27], v[56:59], v[96:99], v[24:27]
    v_mfma_f32_16x16x32_bf16 v[40:43], v[56:59], v[100:103], v[40:43]
    s_waitcnt lgkmcnt(8)
    v_mfma_f32_16x16x32_bf16 v[28:31], v[60:63], v[96:99], v[28:31]
    v_mfma_f32_16x16x32_bf16 v[44:47], v[60:63], v[100:103], v[44:47]
    s_waitcnt vmcnt(0) lgkmcnt(6)
    v_mfma_f32_16x16x32_bf16 v[16:19], v[64:67], v[104:107], v[16:19]
    v_mfma_f32_16x16x32_bf16 v[32:35], v[64:67], v[108:111], v[32:35]
    s_waitcnt lgkmcnt(4)
    v_mfma_f32_16x16x32_bf16 v[20:23], v[68:71], v[104:107], v[20:23]
    v_mfma_f32_16x16x32_bf16 v[36:39], v[68:71], v[108:111], v[36:39]
    s_waitcnt lgkmcnt(2)
    v_mfma_f32_16x16x32_bf16 v[24:27], v[72:75], v[104:107], v[24:27]
    v_mfma_f32_16x16x32_bf16 v[40:43], v[72:75], v[108:111], v[40:43]
    s_waitcnt lgkmcnt(0)
    v_mfma_f32_16x16x32_bf16 v[28:31], v[76:79], v[104:107], v[28:31]
    v_mfma_f32_16x16x32_bf16 v[44:47], v[76:79], v[108:111], v[44:47]
    s_nop 7
    v_cvt_pk_bf16_f32 v240, v16, v17
    v_cvt_pk_bf16_f32 v241, v18, v19
    v_cvt_pk_bf16_f32 v242, v20, v21
    v_cvt_pk_bf16_f32 v243, v22, v23
    v_cvt_pk_bf16_f32 v244, v24, v25
    v_cvt_pk_bf16_f32 v245, v26, v27
    v_cvt_pk_bf16_f32 v246, v28, v29
    v_cvt_pk_bf16_f32 v247, v30, v31
    v_cvt_pk_bf16_f32 v248, v32, v33
    v_cvt_pk_bf16_f32 v249, v34, v35
    v_cvt_pk_bf16_f32 v250, v36, v37
    v_cvt_pk_bf16_f32 v251, v38, v39
    v_cvt_pk_bf16_f32 v252, v40, v41
    v_cvt_pk_bf16_f32 v253, v42, v43
    v_cvt_pk_bf16_f32 v254, v44, v45
    v_cvt_pk_bf16_f32 v255, v46, v47
    s_nop 0
    v_permlane16_swap_b32 v240, v242
    v_permlane16_swap_b32 v241, v243
    v_permlane16_swap_b32 v244, v246
    v_permlane16_swap_b32 v245, v247
    v_permlane16_swap_b32 v248, v250
    v_permlane16_swap_b32 v249, v251
    v_permlane16_swap_b32 v252, v254
    v_permlane16_swap_b32 v253, v255
    s_nop 1
    buffer_store_dwordx4 v[240:243], v3, s[20:23], s64 offen offset:0 sc1
    buffer_store_dwordx4 v[244:247], v3, s[20:23], s64 offen offset:64 sc1
    buffer_store_dwordx4 v[248:251], v3, s[20:23], s65 offen offset:0 sc1
    buffer_store_dwordx4 v[252:255], v3, s[20:23], s65 offen offset:64 sc1
    s_endpgm
L_s3_end:
    s_endpgm
.section .rodata,"a"
.p2align 6
.amdhsa_kernel g1_kernel
  .amdhsa_next_free_vgpr 512
  .amdhsa_next_free_sgpr 102
  .amdhsa_accum_offset 256
  .amdhsa_group_segment_fixed_size 0
  .amdhsa_kernarg_size 80
  .amdhsa_user_sgpr_count 2
  .amdhsa_user_sgpr_kernarg_segment_ptr 1
  .amdhsa_system_sgpr_workgroup_id_x 1
.end_amdhsa_kernel
.p2align 6
.amdhsa_kernel s3_kernel
  .amdhsa_next_free_vgpr 256
  .amdhsa_next_free_sgpr 102
  .amdhsa_accum_offset 256
  .amdhsa_group_segment_fixed_size 0
  .amdhsa_kernarg_size 80
  .amdhsa_user_sgpr_count 2
  .amdhsa_user_sgpr_kernarg_segment_ptr 1
  .amdhsa_system_sgpr_workgroup_id_x 1
.end_amdhsa_kernel
```
